```python
import torch

def _softmax(x, axis=-1):
    return torch.softmax(x, dim=axis)
def _gelu(x):
    return torch.nn.functional.gelu(x, approximate="tanh")
def _silu(x):
    return torch.nn.functional.silu(x)
def _sigmoid(x):
    return torch.sigmoid(x)
def _layernorm(x, axis=-1, eps=1e-5):
    m = x.mean(dim=axis, keepdim=True)
    v = x.var(dim=axis, keepdim=True, unbiased=False)
    return (x - m) / torch.sqrt(v + eps)
def _scatter_add(tgt, idx, src, axis=0):
    return tgt.clone().index_add_(axis, idx, src)
def _segment_sum(src, seg, n):
    out = torch.zeros((n,) + src.shape[1:], dtype=src.dtype)
    return out.index_add_(0, seg, src)
def _pad(x, pw):
    flat = tuple(v for pair in reversed(pw) for v in pair)
    return torch.nn.functional.pad(x, flat)

kernel_name = 'sequential_preLN__ssm_conv_s4d__glu_gated_geglu__prompt'

def setup_inputs():

    _w = (lambda a: (lambda t: t.to(torch.bfloat16) if t.is_floating_point() else t)(torch.as_tensor(a)))
    def _A_setup():
        Bsz, L, D, N = 1, 2048, 512, 128
        return {
            "u": _w((lambda *s: torch.randn(*s, dtype=torch.bfloat16) * 0.05)(Bsz, L, D)),
            "log_A_real": _w((lambda *s: torch.randn(*s, dtype=torch.bfloat16) * 6.4)(D, N) * 0.5),
            "A_imag": _w((lambda *s: torch.randn(*s, dtype=torch.bfloat16) * 0.05)(D, N) * 3.14),
            "C_real": _w((lambda *s: torch.randn(*s, dtype=torch.bfloat16) * 0.05)(D, N) / N ** 0.5),
            "C_imag": _w((lambda *s: torch.randn(*s, dtype=torch.bfloat16) * 0.05)(D, N) / N ** 0.5),
            "log_dt": _w((lambda *s: torch.randn(*s, dtype=torch.bfloat16) * 0.05)(D) * 0.5 - 4.0),
            "D_skip": _w((lambda *s: torch.randn(*s, dtype=torch.bfloat16) * 0.05)(D)),
        }
    _A_in = _A_setup()

    def _B_setup():
        B, S, Dm, Df = 1, 2048, 512, 1376
        return {
            "x": _w((lambda *s: torch.randn(*s, dtype=torch.bfloat16) * 0.05)(B, S, Dm)),
            "w_gate": _w((lambda *s: torch.randn(*s, dtype=torch.bfloat16) * 0.4)(Dm, Df) * (Dm ** -0.5)),
            "w_up": _w((lambda *s: torch.randn(*s, dtype=torch.bfloat16) * 0.4)(Dm, Df) * (Dm ** -0.5)),
            "w_down": _w((lambda *s: torch.randn(*s, dtype=torch.bfloat16) * 0.4)(Df, Dm) * (Df ** -0.5)),
        }
    _B_in = _B_setup()

    return {
        "A_u": _A_in["u"],
        "A_log_A_real": _A_in["log_A_real"],
        "A_A_imag": _A_in["A_imag"],
        "A_C_real": _A_in["C_real"],
        "A_C_imag": _A_in["C_imag"],
        "A_log_dt": _A_in["log_dt"],
        "A_D_skip": _A_in["D_skip"],
        "B_x": _B_in["x"],
        "B_w_gate": _B_in["w_gate"],
        "B_w_up": _B_in["w_up"],
        "B_w_down": _B_in["w_down"],
    }

def reference(A_u, A_log_A_real, A_A_imag, A_C_real, A_C_imag, A_log_dt, A_D_skip, B_x, B_w_gate, B_w_up, B_w_down):
    def _A_ref(u, log_A_real, A_imag, C_real, C_imag, log_dt, D_skip):
        L = u.shape[1]
        dt = torch.exp(log_dt)
        A = -torch.exp(log_A_real) + 1j * A_imag
        C = (C_real + 1j * C_imag) * dt[:, None]
        pos = (lambda x, dt: x.to(dt))(torch.arange(L), log_dt.dtype)
        P = torch.exp((A * dt[:, None])[:, :, None] * pos[None, None, :])
        K = 2.0 * torch.einsum("dn,dnl->dl", C, P).real
        L2 = 2 * L
        u_t = (lambda x, *d: x.permute(*d))(u, 0, 2, 1)
        Kf = (lambda x, *a, **k: torch.fft.rfft(x.float(), *a, **k))(K, L2)
        Uf = (lambda x, *a, **k: torch.fft.rfft(x.float(), *a, **k))(u_t, L2)
        y = (lambda x, *a, **k: torch.fft.irfft(x, *a, **k).to(torch.bfloat16))(Uf * Kf[None, :, :], L2)[:, :, :L]
        y = (lambda x, *d: x.permute(*d))(y, 0, 2, 1)
        return y + u * D_skip[None, None, :]

    def _B_ref(x, w_gate, w_up, w_down):
        g = torch.einsum("bsd,df->bsf", x, w_gate)
        u = torch.einsum("bsd,df->bsf", x, w_up)
        h = _gelu(g) * u
        return torch.einsum("bsf,fd->bsd", h, w_down)

    x = A_u
    h = x + _A_ref(_layernorm(x, axis=-1), A_log_A_real, A_A_imag, A_C_real, A_C_imag, A_log_dt, A_D_skip)
    h2 = h + _B_ref(_layernorm(h, axis=-1), B_w_gate, B_w_up, B_w_down)
    return h2
```

```asm
; @launch grid=(256,1,1) block=(512,1,1) lds=163840
.amdgcn_target "amdgcn-amd-amdhsa--gfx950"
.text
.globl sequential_preLN__ssm_conv_s4d__glu_gated_geglu__prompt_kernel
.p2align 8
.type sequential_preLN__ssm_conv_s4d__glu_gated_geglu__prompt_kernel,@function
sequential_preLN__ssm_conv_s4d__glu_gated_geglu__prompt_kernel:
    s_cmp_ge_u32 s2, 256
    s_cbranch_scc1 m_end
    s_load_dwordx16 s[4:19], s[0:1], 0
    s_load_dwordx2 s[30:31], s[0:1], 104
    s_load_dwordx8 s[20:27], s[0:1], 64
    s_getpc_b64 s[44:45]
ka_pf:
    v_lshlrev_b32 v56, 7, v0
    v_lshrrev_b32 v2, 6, v0
    v_and_b32 v1, 63, v0
    v_readfirstlane_b32 s36, v2
    s_lshr_b32 s40, s2, 3
    s_cmp_lg_u32 s36, 0
    s_cbranch_scc1 ka_nopf
    s_mov_b32 exec_hi, 0xff
    global_load_dword v203, v56, s[44:45] offset:512
    s_mov_b32 exec_hi, -1
ka_nopf:
    s_and_b32 s39, s2, 7
    s_lshl_b32 s38, s39, 5
    s_add_u32 s38, s38, s40
    s_and_b32 s37, s36, 1
    s_lshr_b32 s51, s36, 1
    s_and_b32 s41, s51, 1
    v_and_b32 v18, 31, v1
    v_lshrrev_b32 v19, 5, v1
    s_lshl_b32 s39, s39, 7
    s_lshl_b32 s40, s40, 16
    s_add_u32 s39, s39, s40
    s_lshl_b32 s40, s51, 14
    s_add_u32 s39, s39, s40
    s_lshl_b32 s40, s37, 6
    s_add_u32 s39, s39, s40
    v_lshrrev_b32 v56, 2, v1
    v_and_b32 v57, 3, v1
    v_lshlrev_b32 v58, 10, v56
    v_lshl_add_u32 v58, v57, 4, v58
    v_add_u32 v58, s39, v58
    s_lshl_b32 s39, s38, 13
    v_lshl_add_u32 v17, v0, 4, s39
    s_lshl_b32 s39, s38, 9
    v_lshl_add_u32 v2, v1, 3, s39
    s_lshl_b32 s40, s38, 2
    s_cmp_eq_u32 s37, 0
    s_waitcnt lgkmcnt(0)
    s_cselect_b64 s[62:63], s[6:7], s[8:9]
    s_cselect_b64 s[60:61], s[10:11], s[12:13]
    s_cmp_eq_u32 s41, 0
    s_cselect_b64 s[62:63], s[62:63], s[60:61]
    s_cmp_ge_u32 s36, 4
    s_cbranch_scc1 ka_nop
    global_load_dwordx2 v[12:13], v2, s[62:63]
ka_nop:
    s_load_dword s58, s[30:31], 32768
    s_load_dword s43, s[14:15], s40
    s_load_dword s50, s[16:17], s40
    global_load_dwordx4 v[8:11], v58, s[4:5]
    global_load_dwordx4 v[4:7], v17, s[4:5]
    s_mov_b32 s42, 0x3f803f80
    s_mov_b32 s90, 0x3b000000
    v_mov_b32 v65, 0x9000
    global_load_dword v202, v65, s[30:31]
    s_mul_i32 s39, s36, 1280
    s_add_u32 s39, s39, 72704
    v_mul_u32_u24 v36, 80, v56
    v_lshl_add_u32 v36, v57, 4, v36
    v_add_u32 v36, s39, v36
    v_and_b32 v56, 7, v1
    v_lshrrev_b32 v57, 3, v1
    v_mul_u32_u24 v37, 160, v56
    v_lshl_add_u32 v37, v57, 2, v37
    v_add_u32 v37, s39, v37
    s_and_b32 s39, s2, 7
    s_lshl_b32 s39, s39, 19
    s_lshl_b32 s40, s37, 18
    s_add_u32 s39, s39, s40
    s_lshr_b32 s40, s2, 3
    s_lshl_b32 s40, s40, 9
    s_add_u32 s39, s39, s40
    s_lshl_b32 s40, s51, 7
    s_add_u32 s39, s39, s40
    s_add_u32 s39, s39, 23068672
    v_lshlrev_b32 v38, 14, v57
    v_lshl_add_u32 v38, v56, 4, v38
    v_add_u32 v38, s39, v38
    v_add_u32 v39, 131072, v38
    s_lshl_b32 s39, s38, 6
    v_lshl_add_u32 v40, v1, 3, s39
    v_lshlrev_b32 v53, 5, v0
    s_lshl_b32 s39, s38, 14
    s_add_u32 s39, s39, 23068672
    v_add_u32 v52, s39, v53
    s_mul_i32 s39, s37, 34816
    s_lshl_b32 s40, s41, 8
    s_add_u32 s39, s39, s40
    v_lshl_add_u32 v17, v1, 2, s39
    v_mov_b32 v64, 0
    v_mov_b32 v65, 0
    s_and_b32 s39, s36, 3
    s_mul_i32 s39, s39, 1152
    s_add_u32 s39, s39, 140736
    v_lshl_add_u32 v66, v1, 3, s39
    ds_write_b64 v66, v[64:65]
    s_mov_b64 exec, 0x7f
    s_mul_i32 s39, s36, 4160
    s_add_u32 s39, s39, 111552
    v_lshl_add_u32 v66, v1, 3, s39
    ds_write_b64 v66, v[64:65]
    v_mov_b32 v66, 163824
    ds_write_b64 v66, v[64:65]
    ds_write_b64 v66, v[64:65] offset:8
    v_mov_b32 v66, 82976
    ds_write_b32 v66, v64
    s_mov_b64 exec, -1
    s_lshl_b32 s39, s36, 9
    s_add_u32 s39, s39, 83008
    v_lshl_add_u32 v67, v1, 3, s39
    s_lshl_b32 s39, s37, 8
    s_lshl_b32 s40, s41, 7
    s_add_u32 s39, s39, s40
    s_add_u32 s39, s39, 83008
    v_lshl_add_u32 v68, v1, 1, s39
    s_waitcnt lgkmcnt(0)
    s_mul_i32 s34, s58, 0x9e3779b1
    s_add_u32 s34, s34, 0x7f4a7c15
    s_lshl_b32 s39, s43, 16
    s_and_b32 s40, s43, 0xffff0000
    s_cmp_eq_u32 s37, 0
    s_cselect_b32 s43, s39, s40
    v_mov_b32 v16, s43
    v_mov_b32 v21, s34
    v_mov_b32 v23, s34
    v_mov_b32 v25, s34
    v_mov_b32 v27, s34
    v_mul_f32 v64, 0x3fb8a000, v16
    v_rndne_f32 v65, v64
    v_sub_f32 v64, v64, v65
    v_fmamk_f32 v64, v16, 0x39a3b296, v64
    v_cvt_i32_f32 v65, v65
    v_exp_f32 v64, v64
    s_nop 0
    v_ldexp_f32 v16, v64, v65
    v_cvt_pk_bf16_f32 v16, v16, v16
    v_and_b32 v16, 0xffff0000, v16
    s_cmp_ge_u32 s36, 4
    s_cbranch_scc1 ka_nop2
    s_waitcnt vmcnt(3)
    ds_write_b64 v67, v[12:13]
ka_nop2:
    s_waitcnt lgkmcnt(0)
    s_barrier
    ds_read_u16 v12, v68
    ds_read_u16 v13, v68 offset:512
    ds_read_u16 v14, v68 offset:1024
    ds_read_u16 v15, v68 offset:1536
    s_waitcnt lgkmcnt(0)
    v_lshlrev_b32 v12, 16, v12
    v_lshlrev_b32 v13, 16, v13
    v_mul_f32 v84, 0x3fb8a000, v12
    v_rndne_f32 v85, v84
    v_sub_f32 v84, v84, v85
    v_fmamk_f32 v84, v12, 0x39a3b296, v84
    v_cvt_i32_f32 v85, v85
    v_exp_f32 v84, v84
    s_nop 0
    v_ldexp_f32 v12, v84, v85
    v_cvt_pk_bf16_f32 v12, v12, v12
    v_and_b32 v12, 0xffff0000, v12
    v_mul_f32 v13, v13, v16
    v_mul_f32 v12, v12, v16
    v_mul_f32 v12, 0xbfb8aa3b, v12
    s_cmp_ge_u32 s36, 4
    s_cbranch_scc1 ka_frole
    v_mul_f32 v13, 0xbe22f983, v13
    v_exp_f32 v72, v12
    v_fract_f32 v73, v13
    v_cos_f32 v56, v73
    v_sin_f32 v57, v73
    v_mul_f32 v56, v72, v56
    v_mul_f32 v57, v72, v57
    v_mul_f32 v74, 0x43800000, v12
    v_mul_f32 v75, 0x43800000, v13
    v_exp_f32 v74, v74
    v_fract_f32 v75, v75
    v_cos_f32 v64, v75
    v_sin_f32 v65, v75
    v_mul_f32 v64, v74, v64
    v_mul_f32 v65, v74, v65
    s_waitcnt vmcnt(2)
    ds_write_b128 v36, v[8:11]
    ds_read_b32 v20, v37
    ds_read_b32 v22, v37 offset:80
    ds_read_b32 v24, v37 offset:32
    ds_read_b32 v26, v37 offset:112
    s_waitcnt vmcnt(1)
    v_dot2_f32_bf16 v2, v4, s42, 0
    v_dot2_f32_bf16 v3, v4, v4, 0
    v_dot2_f32_bf16 v2, v5, s42, v2
    v_dot2_f32_bf16 v3, v5, v5, v3
    v_dot2_f32_bf16 v2, v6, s42, v2
    v_dot2_f32_bf16 v3, v6, v6, v3
    v_dot2_f32_bf16 v2, v7, s42, v2
    v_dot2_f32_bf16 v3, v7, v7, v3
    s_nop 1
    v_add_f32_dpp v2, v2, v2 row_shr:1 row_mask:0xf bank_mask:0xf bound_ctrl:0
    v_add_f32_dpp v3, v3, v3 row_shr:1 row_mask:0xf bank_mask:0xf bound_ctrl:0
    s_waitcnt lgkmcnt(0)
    global_store_dwordx4 v38, v[20:23], s[30:31] sc0 sc1
    global_store_dwordx4 v39, v[24:27], s[30:31] sc0 sc1
    v_add_f32_dpp v2, v2, v2 row_shr:2 row_mask:0xf bank_mask:0xf bound_ctrl:0
    v_add_f32_dpp v3, v3, v3 row_shr:2 row_mask:0xf bank_mask:0xf bound_ctrl:0
    s_nop 0
    v_add_f32_dpp v2, v2, v2 row_shr:4 row_mask:0xf bank_mask:0xf bound_ctrl:0
    v_add_f32_dpp v3, v3, v3 row_shr:4 row_mask:0xf bank_mask:0xf bound_ctrl:0
    s_nop 0
    v_add_f32_dpp v2, v2, v2 row_shr:8 row_mask:0xf bank_mask:0xf bound_ctrl:0
    v_add_f32_dpp v3, v3, v3 row_shr:8 row_mask:0xf bank_mask:0xf bound_ctrl:0
    s_nop 0
    v_add_f32_dpp v2, v2, v2 row_bcast:15 row_mask:0xa bank_mask:0xf
    v_add_f32_dpp v3, v3, v3 row_bcast:15 row_mask:0xa bank_mask:0xf
    s_nop 0
    v_add_f32_dpp v2, v2, v2 row_bcast:31 row_mask:0xc bank_mask:0xf
    v_add_f32_dpp v3, v3, v3 row_bcast:31 row_mask:0xc bank_mask:0xf
    v_mul_f32 v2, 0x3b000000, v2
    v_mul_f32 v41, v2, v2
    v_fma_f32 v3, v3, s90, -v41
    v_max_f32 v3, 0, v3
    v_cvt_pk_bf16_f32 v3, v3, v3
    v_and_b32 v3, 0xffff0000, v3
    v_add_f32 v3, 0x3727c5ac, v3
    v_cvt_pk_bf16_f32 v3, v3, v3
    v_and_b32 v3, 0xffff0000, v3
    v_sqrt_f32 v3, v3
    s_nop 0
    v_cvt_pk_bf16_f32 v2, v2, v3
    s_lshl_b32 s39, s36, 2
    s_add_u32 s39, s39, 82944
    v_mov_b32 v41, s39
    v_mov_b32 v42, 82976
    v_mov_b32 v43, 1
    s_mov_b32 exec_lo, 0
    s_mov_b32 exec_hi, 0x80000000
    ds_write_b32 v41, v2
    ds_add_rtn_u32 v43, v42, v43
    s_mov_b64 exec, -1
    v_lshlrev_b32 v41, 2, v1
    v_add_u32 v41, 82944, v41
    v_mov_b32 v3, s34
    s_waitcnt lgkmcnt(0)
    v_readlane_b32 s39, v43, 63
    s_nop 0
    s_cmp_lg_u32 s39, 7
    s_cbranch_scc1 ka_pe
    s_mov_b64 exec, 0xff
    ds_read_b32 v2, v41
    s_waitcnt lgkmcnt(0)
    global_store_dwordx2 v40, v[2:3], s[30:31] offset:0 sc0 sc1
    s_mov_b64 exec, -1
    s_mul_i32 s39, s2, 5504
    v_lshl_add_u32 v41, v1, 7, s39
    s_mov_b32 exec_hi, 0x7ff
    global_load_dword v203, v41, s[20:21]
    global_load_dword v203, v41, s[22:23]
    global_load_dword v203, v41, s[24:25]
    s_mov_b32 exec_hi, -1
ka_pe:
    v_lshlrev_b32 v14, 16, v14
    v_lshlrev_b32 v15, 16, v15
    v_mul_f32 v68, v14, v16
    v_mul_f32 v69, v15, v16
    v_add_f32 v68, v68, v68
    v_mul_f32 v69, -2.0, v69
    v_pk_mul_f32 v[72:73], v[56:57], v[56:57] op_sel:[0,0] op_sel_hi:[0,1]
    v_pk_fma_f32 v[58:59], v[56:57], v[56:57], v[72:73] op_sel:[1,1,0] op_sel_hi:[1,0,1] neg_lo:[1,0,0]
    v_pk_mul_f32 v[74:75], v[68:69], v[64:65] op_sel:[0,0] op_sel_hi:[0,1]
    v_pk_fma_f32 v[66:67], v[68:69], v[64:65], v[74:75] op_sel:[1,1,0] op_sel_hi:[1,0,1] neg_lo:[1,0,0]
    v_cvt_pk_bf16_f32 v76, v68, v69
    ds_write_b32 v17, v76 offset:0
    v_pk_mul_f32 v[80:81], v[58:59], v[58:59] op_sel:[0,0] op_sel_hi:[0,1]
    v_pk_fma_f32 v[60:61], v[58:59], v[58:59], v[80:81] op_sel:[1,1,0] op_sel_hi:[1,0,1] neg_lo:[1,0,0]
    v_cvt_pk_bf16_f32 v77, v66, v67
    ds_write_b32 v17, v77 offset:4352
    v_pk_mul_f32 v[72:73], v[68:69], v[56:57] op_sel:[0,0] op_sel_hi:[0,1]
    v_pk_fma_f32 v[68:69], v[68:69], v[56:57], v[72:73] op_sel:[1,1,0] op_sel_hi:[1,0,1] neg_lo:[1,0,0]
    v_pk_mul_f32 v[74:75], v[66:67], v[58:59] op_sel:[0,0] op_sel_hi:[0,1]
    v_pk_fma_f32 v[70:71], v[66:67], v[58:59], v[74:75] op_sel:[1,1,0] op_sel_hi:[1,0,1] neg_lo:[1,0,0]
    v_pk_mul_f32 v[80:81], v[66:67], v[64:65] op_sel:[0,0] op_sel_hi:[0,1]
    v_pk_fma_f32 v[66:67], v[66:67], v[64:65], v[80:81] op_sel:[1,1,0] op_sel_hi:[1,0,1] neg_lo:[1,0,0]
    v_cvt_pk_bf16_f32 v78, v70, v71
    ds_write_b32 v17, v78 offset:4896
    v_cvt_pk_bf16_f32 v79, v68, v69
    ds_write_b32 v17, v79 offset:544
    v_pk_mul_f32 v[74:75], v[70:71], v[58:59] op_sel:[0,0] op_sel_hi:[0,1]
    v_pk_fma_f32 v[70:71], v[70:71], v[58:59], v[74:75] op_sel:[1,1,0] op_sel_hi:[1,0,1] neg_lo:[1,0,0]
    v_cvt_pk_bf16_f32 v76, v66, v67
    ds_write_b32 v17, v76 offset:6528
    v_pk_mul_f32 v[80:81], v[66:67], v[60:61] op_sel:[0,0] op_sel_hi:[0,1]
    v_pk_fma_f32 v[82:83], v[66:67], v[60:61], v[80:81] op_sel:[1,1,0] op_sel_hi:[1,0,1] neg_lo:[1,0,0]
    v_pk_mul_f32 v[72:73], v[68:69], v[56:57] op_sel:[0,0] op_sel_hi:[0,1]
    v_pk_fma_f32 v[68:69], v[68:69], v[56:57], v[72:73] op_sel:[1,1,0] op_sel_hi:[1,0,1] neg_lo:[1,0,0]
    v_cvt_pk_bf16_f32 v77, v70, v71
    ds_write_b32 v17, v77 offset:5440
    v_pk_mul_f32 v[74:75], v[70:71], v[58:59] op_sel:[0,0] op_sel_hi:[0,1]
    v_pk_fma_f32 v[70:71], v[70:71], v[58:59], v[74:75] op_sel:[1,1,0] op_sel_hi:[1,0,1] neg_lo:[1,0,0]
    v_pk_mul_f32 v[80:81], v[66:67], v[64:65] op_sel:[0,0] op_sel_hi:[0,1]
    v_pk_fma_f32 v[66:67], v[66:67], v[64:65], v[80:81] op_sel:[1,1,0] op_sel_hi:[1,0,1] neg_lo:[1,0,0]
    v_cvt_pk_bf16_f32 v78, v68, v69
    ds_write_b32 v17, v78 offset:1088
    v_cvt_pk_bf16_f32 v79, v82, v83
    ds_write_b32 v17, v79 offset:7072
    v_cvt_pk_bf16_f32 v76, v70, v71
    ds_write_b32 v17, v76 offset:5984
    v_cvt_pk_bf16_f32 v77, v66, v67
    ds_write_b32 v17, v77 offset:7616
    v_pk_mul_f32 v[74:75], v[66:67], v[60:61] op_sel:[0,0] op_sel_hi:[0,1]
    v_pk_fma_f32 v[82:83], v[66:67], v[60:61], v[74:75] op_sel:[1,1,0] op_sel_hi:[1,0,1] neg_lo:[1,0,0]
    v_pk_mul_f32 v[80:81], v[66:67], v[64:65] op_sel:[0,0] op_sel_hi:[0,1]
    v_pk_fma_f32 v[66:67], v[66:67], v[64:65], v[80:81] op_sel:[1,1,0] op_sel_hi:[1,0,1] neg_lo:[1,0,0]
    v_cvt_pk_bf16_f32 v78, v82, v83
    ds_write_b32 v17, v78 offset:8160
    v_pk_mul_f32 v[72:73], v[68:69], v[56:57] op_sel:[0,0] op_sel_hi:[0,1]
    v_pk_fma_f32 v[68:69], v[68:69], v[56:57], v[72:73] op_sel:[1,1,0] op_sel_hi:[1,0,1] neg_lo:[1,0,0]
    v_cvt_pk_bf16_f32 v79, v66, v67
    ds_write_b32 v17, v79 offset:8704
    v_cvt_pk_bf16_f32 v76, v68, v69
    ds_write_b32 v17, v76 offset:1632
    v_pk_mul_f32 v[74:75], v[66:67], v[64:65] op_sel:[0,0] op_sel_hi:[0,1]
    v_pk_fma_f32 v[66:67], v[66:67], v[64:65], v[74:75] op_sel:[1,1,0] op_sel_hi:[1,0,1] neg_lo:[1,0,0]
    v_pk_mul_f32 v[72:73], v[68:69], v[56:57] op_sel:[0,0] op_sel_hi:[0,1]
    v_pk_fma_f32 v[68:69], v[68:69], v[56:57], v[72:73] op_sel:[1,1,0] op_sel_hi:[1,0,1] neg_lo:[1,0,0]
    v_cvt_pk_bf16_f32 v77, v66, v67
    ds_write_b32 v17, v77 offset:10880
    v_cvt_pk_bf16_f32 v78, v68, v69
    ds_write_b32 v17, v78 offset:2176
    v_pk_mul_f32 v[80:81], v[66:67], v[64:65] op_sel:[0,0] op_sel_hi:[0,1]
    v_pk_fma_f32 v[66:67], v[66:67], v[64:65], v[80:81] op_sel:[1,1,0] op_sel_hi:[1,0,1] neg_lo:[1,0,0]
    v_pk_mul_f32 v[72:73], v[68:69], v[56:57] op_sel:[0,0] op_sel_hi:[0,1]
    v_pk_fma_f32 v[68:69], v[68:69], v[56:57], v[72:73] op_sel:[1,1,0] op_sel_hi:[1,0,1] neg_lo:[1,0,0]
    v_cvt_pk_bf16_f32 v79, v66, v67
    ds_write_b32 v17, v79 offset:13056
    v_cvt_pk_bf16_f32 v76, v68, v69
    ds_write_b32 v17, v76 offset:2720
    v_pk_mul_f32 v[74:75], v[66:67], v[64:65] op_sel:[0,0] op_sel_hi:[0,1]
    v_pk_fma_f32 v[66:67], v[66:67], v[64:65], v[74:75] op_sel:[1,1,0] op_sel_hi:[1,0,1] neg_lo:[1,0,0]
    v_pk_mul_f32 v[72:73], v[68:69], v[56:57] op_sel:[0,0] op_sel_hi:[0,1]
    v_pk_fma_f32 v[68:69], v[68:69], v[56:57], v[72:73] op_sel:[1,1,0] op_sel_hi:[1,0,1] neg_lo:[1,0,0]
    v_cvt_pk_bf16_f32 v77, v66, v67
    ds_write_b32 v17, v77 offset:15232
    v_cvt_pk_bf16_f32 v78, v68, v69
    ds_write_b32 v17, v78 offset:3264
    v_pk_mul_f32 v[80:81], v[66:67], v[64:65] op_sel:[0,0] op_sel_hi:[0,1]
    v_pk_fma_f32 v[66:67], v[66:67], v[64:65], v[80:81] op_sel:[1,1,0] op_sel_hi:[1,0,1] neg_lo:[1,0,0]
    v_pk_mul_f32 v[72:73], v[68:69], v[56:57] op_sel:[0,0] op_sel_hi:[0,1]
    v_pk_fma_f32 v[68:69], v[68:69], v[56:57], v[72:73] op_sel:[1,1,0] op_sel_hi:[1,0,1] neg_lo:[1,0,0]
    v_cvt_pk_bf16_f32 v79, v66, v67
    ds_write_b32 v17, v79 offset:9248
    v_cvt_pk_bf16_f32 v76, v68, v69
    ds_write_b32 v17, v76 offset:3808
    v_and_b32 v58, 15, v1
    v_lshrrev_b32 v59, 4, v1
    s_mul_i32 s39, s37, 34816
    v_mul_u32_u24 v56, 544, v58
    v_lshl_add_u32 v56, v59, 4, v56
    v_add_u32 v56, s39, v56
    s_mul_i32 s40, s41, 8704
    v_add_u32 v57, s40, v56
    s_lshl_b32 s39, s41, 4
    v_add_u32 v58, s39, v58
    v_lshlrev_b32 v68, 4, v58
    v_lshl_add_u32 v68, v59, 3, v68
    v_lshlrev_b32 v69, 3, v58
    v_add_u32 v69, 512, v69
    v_cmp_eq_u32 vcc, 2, v59
    s_nop 1
    v_cndmask_b32 v68, v68, v69, vcc
    v_lshlrev_b32 v69, 2, v58
    v_add_u32 v69, 768, v69
    v_cmp_eq_u32 vcc, 3, v59
    s_nop 1
    v_cndmask_b32 v68, v68, v69, vcc
    v_mov_b32 v69, 4
    v_mov_b32 v70, 128
    v_cndmask_b32 v69, v69, v70, vcc
    s_mul_i32 s39, s37, 1536
    s_add_u32 s39, s39, 69632
    v_add_u32 v68, s39, v68
    v_add_u32 v69, v68, v69
    v_lshlrev_b32 v70, 1, v58
    v_lshl_add_u32 v70, v59, 6, v70
    v_add_u32 v70, s39, v70
    s_waitcnt lgkmcnt(0)
    s_barrier
    ds_read_b128 v[88:91], v57 offset:17408
    ds_read_b128 v[92:95], v56 offset:0
    ds_read_b128 v[96:99], v56 offset:8704
    ds_read_b128 v[100:103], v57 offset:17472
    ds_read_b128 v[104:107], v56 offset:64
    ds_read_b128 v[108:111], v56 offset:8768
    ds_read_b128 v[112:115], v57 offset:17536
    ds_read_b128 v[116:119], v56 offset:128
    ds_read_b128 v[120:123], v56 offset:8832
    ds_read_b128 v[124:127], v57 offset:17600
    ds_read_b128 v[128:131], v56 offset:192
    ds_read_b128 v[132:135], v56 offset:8896
    s_waitcnt lgkmcnt(9)
    v_mfma_f32_16x16x32_bf16 v[60:63], v[92:95], v[88:91], 0
    v_mfma_f32_16x16x32_bf16 v[64:67], v[96:99], v[88:91], 0
    ds_read_b128 v[136:139], v57 offset:17664
    ds_read_b128 v[140:143], v56 offset:256
    ds_read_b128 v[144:147], v56 offset:8960
    s_waitcnt lgkmcnt(9)
    v_mfma_f32_16x16x32_bf16 v[60:63], v[104:107], v[100:103], v[60:63]
    v_mfma_f32_16x16x32_bf16 v[64:67], v[108:111], v[100:103], v[64:67]
    ds_read_b128 v[148:151], v57 offset:17728
    ds_read_b128 v[152:155], v56 offset:320
    ds_read_b128 v[156:159], v56 offset:9024
    s_waitcnt lgkmcnt(9)
    v_mfma_f32_16x16x32_bf16 v[60:63], v[116:119], v[112:115], v[60:63]
    v_mfma_f32_16x16x32_bf16 v[64:67], v[120:123], v[112:115], v[64:67]
    ds_read_b128 v[160:163], v57 offset:17792
    ds_read_b128 v[164:167], v56 offset:384
    ds_read_b128 v[168:171], v56 offset:9088
    s_waitcnt lgkmcnt(9)
    v_mfma_f32_16x16x32_bf16 v[60:63], v[128:131], v[124:127], v[60:63]
    v_mfma_f32_16x16x32_bf16 v[64:67], v[132:135], v[124:127], v[64:67]
    ds_read_b128 v[172:175], v57 offset:17856
    ds_read_b128 v[176:179], v56 offset:448
    ds_read_b128 v[180:183], v56 offset:9152
    s_waitcnt lgkmcnt(9)
    v_mfma_f32_16x16x32_bf16 v[60:63], v[140:143], v[136:139], v[60:63]
    v_mfma_f32_16x16x32_bf16 v[64:67], v[144:147], v[136:139], v[64:67]
    s_waitcnt lgkmcnt(6)
    v_mfma_f32_16x16x32_bf16 v[60:63], v[152:155], v[148:151], v[60:63]
    v_mfma_f32_16x16x32_bf16 v[64:67], v[156:159], v[148:151], v[64:67]
    s_waitcnt lgkmcnt(3)
    v_mfma_f32_16x16x32_bf16 v[60:63], v[164:167], v[160:163], v[60:63]
    v_mfma_f32_16x16x32_bf16 v[64:67], v[168:171], v[160:163], v[64:67]
    s_waitcnt lgkmcnt(0)
    v_mfma_f32_16x16x32_bf16 v[60:63], v[176:179], v[172:175], v[60:63]
    v_mfma_f32_16x16x32_bf16 v[64:67], v[180:183], v[172:175], v[64:67]
    s_nop 6
    v_cvt_pk_bf16_f32 v60, v60, v61
    v_cvt_pk_bf16_f32 v61, v62, v63
    v_cvt_pk_bf16_f32 v64, v64, v65
    ds_write_b32 v68, v60
    ds_write_b32 v69, v61
    ds_write_b16 v70, v64 offset:1024
    ds_write_b16_d16_hi v70, v64 offset:1280
    s_mov_b32 s56, 1000
    s_branch ka_tab
ka_frole:
    v_mul_f32 v13, 0x3e22f983, v13
    v_mul_f32 v72, 0x41000000, v12
    v_mul_f32 v73, 0x41000000, v13
    v_exp_f32 v72, v72
    v_fract_f32 v73, v73
    v_cos_f32 v62, v73
    v_sin_f32 v63, v73
    v_mul_f32 v62, v72, v62
    v_mul_f32 v63, v72, v63
    v_mov_b32 v79, 0x3f80
    ds_write_b32 v17, v79 offset:17408
    v_pk_mul_f32 v[72:73], v[62:63], v[62:63] op_sel:[0,0] op_sel_hi:[0,1]
    v_pk_fma_f32 v[58:59], v[62:63], v[62:63], v[72:73] op_sel:[1,1,0] op_sel_hi:[1,0,1] neg_lo:[1,0,0]
    v_cvt_pk_bf16_f32 v77, v62, v63
    ds_write_b32 v17, v77 offset:17952
    v_cvt_pk_bf16_f32 v78, v58, v59
    ds_write_b32 v17, v78 offset:18496
    v_pk_mul_f32 v[72:73], v[62:63], v[58:59] op_sel:[0,0] op_sel_hi:[0,1]
    v_pk_mul_f32 v[74:75], v[58:59], v[58:59] op_sel:[0,0] op_sel_hi:[0,1]
    v_pk_fma_f32 v[68:69], v[62:63], v[58:59], v[72:73] op_sel:[1,1,0] op_sel_hi:[1,0,1] neg_lo:[1,0,0]
    v_pk_fma_f32 v[70:71], v[58:59], v[58:59], v[74:75] op_sel:[1,1,0] op_sel_hi:[1,0,1] neg_lo:[1,0,0]
    s_waitcnt vmcnt(2)
    ds_write_b128 v36, v[8:11]
    ds_read_b32 v20, v37
    ds_read_b32 v22, v37 offset:80
    ds_read_b32 v24, v37 offset:32
    ds_read_b32 v26, v37 offset:112
    s_waitcnt vmcnt(1)
    v_dot2_f32_bf16 v2, v4, s42, 0
    v_dot2_f32_bf16 v3, v4, v4, 0
    v_dot2_f32_bf16 v2, v5, s42, v2
    v_dot2_f32_bf16 v3, v5, v5, v3
    v_dot2_f32_bf16 v2, v6, s42, v2
    v_dot2_f32_bf16 v3, v6, v6, v3
    v_dot2_f32_bf16 v2, v7, s42, v2
    v_dot2_f32_bf16 v3, v7, v7, v3
    s_nop 1
    v_add_f32_dpp v2, v2, v2 row_shr:1 row_mask:0xf bank_mask:0xf bound_ctrl:0
    v_add_f32_dpp v3, v3, v3 row_shr:1 row_mask:0xf bank_mask:0xf bound_ctrl:0
    s_waitcnt lgkmcnt(0)
    global_store_dwordx4 v38, v[20:23], s[30:31] sc0 sc1
    global_store_dwordx4 v39, v[24:27], s[30:31] sc0 sc1
    v_add_f32_dpp v2, v2, v2 row_shr:2 row_mask:0xf bank_mask:0xf bound_ctrl:0
    v_add_f32_dpp v3, v3, v3 row_shr:2 row_mask:0xf bank_mask:0xf bound_ctrl:0
    s_nop 0
    v_add_f32_dpp v2, v2, v2 row_shr:4 row_mask:0xf bank_mask:0xf bound_ctrl:0
    v_add_f32_dpp v3, v3, v3 row_shr:4 row_mask:0xf bank_mask:0xf bound_ctrl:0
    s_nop 0
    v_add_f32_dpp v2, v2, v2 row_shr:8 row_mask:0xf bank_mask:0xf bound_ctrl:0
    v_add_f32_dpp v3, v3, v3 row_shr:8 row_mask:0xf bank_mask:0xf bound_ctrl:0
    s_nop 0
    v_add_f32_dpp v2, v2, v2 row_bcast:15 row_mask:0xa bank_mask:0xf
    v_add_f32_dpp v3, v3, v3 row_bcast:15 row_mask:0xa bank_mask:0xf
    s_nop 0
    v_add_f32_dpp v2, v2, v2 row_bcast:31 row_mask:0xc bank_mask:0xf
    v_add_f32_dpp v3, v3, v3 row_bcast:31 row_mask:0xc bank_mask:0xf
    v_mul_f32 v2, 0x3b000000, v2
    v_mul_f32 v41, v2, v2
    v_fma_f32 v3, v3, s90, -v41
    v_max_f32 v3, 0, v3
    v_cvt_pk_bf16_f32 v3, v3, v3
    v_and_b32 v3, 0xffff0000, v3
    v_add_f32 v3, 0x3727c5ac, v3
    v_cvt_pk_bf16_f32 v3, v3, v3
    v_and_b32 v3, 0xffff0000, v3
    v_sqrt_f32 v3, v3
    s_nop 0
    v_cvt_pk_bf16_f32 v2, v2, v3
    s_lshl_b32 s39, s36, 2
    s_add_u32 s39, s39, 82944
    v_mov_b32 v41, s39
    v_mov_b32 v42, 82976
    v_mov_b32 v43, 1
    s_mov_b32 exec_lo, 0
    s_mov_b32 exec_hi, 0x80000000
    ds_write_b32 v41, v2
    ds_add_rtn_u32 v43, v42, v43
    s_mov_b64 exec, -1
    v_lshlrev_b32 v41, 2, v1
    v_add_u32 v41, 82944, v41
    v_mov_b32 v3, s34
    s_waitcnt lgkmcnt(0)
    v_readlane_b32 s39, v43, 63
    s_nop 0
    s_cmp_lg_u32 s39, 7
    s_cbranch_scc1 ka_pf2
    s_mov_b64 exec, 0xff
    ds_read_b32 v2, v41
    s_waitcnt lgkmcnt(0)
    global_store_dwordx2 v40, v[2:3], s[30:31] offset:0 sc0 sc1
    s_mov_b64 exec, -1
    s_mul_i32 s39, s2, 5504
    v_lshl_add_u32 v41, v1, 7, s39
    s_mov_b32 exec_hi, 0x7ff
    global_load_dword v203, v41, s[20:21]
    global_load_dword v203, v41, s[22:23]
    global_load_dword v203, v41, s[24:25]
    s_mov_b32 exec_hi, -1
ka_pf2:
    s_cmp_lg_u32 s36, 7
    s_cbranch_scc1 ka_nw7
    s_cmp_eq_u32 s37, 0
    s_cselect_b64 s[62:63], s[20:21], s[22:23]
    s_cselect_b64 s[60:61], s[24:25], s[44:45]
    s_cmp_eq_u32 s41, 0
    s_cselect_b64 s[62:63], s[62:63], s[60:61]
    s_mul_i32 s39, s2, 5504
    s_lshr_b32 s40, s2, 3
    s_lshl_b32 s40, s40, 10
    s_add_u32 s40, s40, 5632
    s_mov_b32 s56, 1409020
    s_cmp_eq_u32 s36, 7
    s_cselect_b32 s39, s40, s39
    s_cselect_b32 s40, code_end-ka_pf, s56
    s_cselect_b32 exec_lo, 0xff, -1
    s_cselect_b32 exec_hi, 0, 0x7ff
    v_lshl_add_u32 v41, v1, 7, s39
    v_min_u32 v41, s40, v41
    global_load_dword v203, v41, s[62:63]
    s_mov_b64 exec, -1
ka_nw7:
    v_pk_mul_f32 v[72:73], v[68:69], v[58:59] op_sel:[0,0] op_sel_hi:[0,1]
    v_pk_mul_f32 v[74:75], v[70:71], v[58:59] op_sel:[0,0] op_sel_hi:[0,1]
    v_cvt_pk_bf16_f32 v79, v68, v69
    ds_write_b32 v17, v79 offset:19040
    v_pk_fma_f32 v[82:83], v[68:69], v[58:59], v[72:73] op_sel:[1,1,0] op_sel_hi:[1,0,1] neg_lo:[1,0,0]
    v_pk_fma_f32 v[66:67], v[70:71], v[58:59], v[74:75] op_sel:[1,1,0] op_sel_hi:[1,0,1] neg_lo:[1,0,0]
    v_cvt_pk_bf16_f32 v76, v70, v71
    ds_write_b32 v17, v76 offset:19584
    v_pk_mul_f32 v[72:73], v[82:83], v[58:59] op_sel:[0,0] op_sel_hi:[0,1]
    v_pk_mul_f32 v[74:75], v[66:67], v[58:59] op_sel:[0,0] op_sel_hi:[0,1]
    v_cvt_pk_bf16_f32 v77, v82, v83
    ds_write_b32 v17, v77 offset:20128
    v_pk_fma_f32 v[68:69], v[82:83], v[58:59], v[72:73] op_sel:[1,1,0] op_sel_hi:[1,0,1] neg_lo:[1,0,0]
    v_pk_fma_f32 v[70:71], v[66:67], v[58:59], v[74:75] op_sel:[1,1,0] op_sel_hi:[1,0,1] neg_lo:[1,0,0]
    v_cvt_pk_bf16_f32 v78, v66, v67
    ds_write_b32 v17, v78 offset:20672
    v_pk_mul_f32 v[72:73], v[68:69], v[58:59] op_sel:[0,0] op_sel_hi:[0,1]
    v_pk_mul_f32 v[74:75], v[70:71], v[58:59] op_sel:[0,0] op_sel_hi:[0,1]
    v_cvt_pk_bf16_f32 v79, v68, v69
    ds_write_b32 v17, v79 offset:21216
    v_pk_fma_f32 v[82:83], v[68:69], v[58:59], v[72:73] op_sel:[1,1,0] op_sel_hi:[1,0,1] neg_lo:[1,0,0]
    v_pk_fma_f32 v[66:67], v[70:71], v[58:59], v[74:75] op_sel:[1,1,0] op_sel_hi:[1,0,1] neg_lo:[1,0,0]
    v_cvt_pk_bf16_f32 v76, v70, v71
    ds_write_b32 v17, v76 offset:21760
    v_pk_mul_f32 v[72:73], v[82:83], v[58:59] op_sel:[0,0] op_sel_hi:[0,1]
    v_pk_mul_f32 v[74:75], v[66:67], v[58:59] op_sel:[0,0] op_sel_hi:[0,1]
    v_cvt_pk_bf16_f32 v77, v82, v83
    ds_write_b32 v17, v77 offset:22304
    v_pk_fma_f32 v[68:69], v[82:83], v[58:59], v[72:73] op_sel:[1,1,0] op_sel_hi:[1,0,1] neg_lo:[1,0,0]
    v_pk_fma_f32 v[70:71], v[66:67], v[58:59], v[74:75] op_sel:[1,1,0] op_sel_hi:[1,0,1] neg_lo:[1,0,0]
    v_cvt_pk_bf16_f32 v78, v66, v67
    ds_write_b32 v17, v78 offset:22848
    v_pk_mul_f32 v[72:73], v[68:69], v[58:59] op_sel:[0,0] op_sel_hi:[0,1]
    v_pk_mul_f32 v[74:75], v[70:71], v[58:59] op_sel:[0,0] op_sel_hi:[0,1]
    v_cvt_pk_bf16_f32 v79, v68, v69
    ds_write_b32 v17, v79 offset:23392
    v_pk_fma_f32 v[82:83], v[68:69], v[58:59], v[72:73] op_sel:[1,1,0] op_sel_hi:[1,0,1] neg_lo:[1,0,0]
    v_pk_fma_f32 v[66:67], v[70:71], v[58:59], v[74:75] op_sel:[1,1,0] op_sel_hi:[1,0,1] neg_lo:[1,0,0]
    v_cvt_pk_bf16_f32 v76, v70, v71
    ds_write_b32 v17, v76 offset:23936
    v_pk_mul_f32 v[72:73], v[82:83], v[58:59] op_sel:[0,0] op_sel_hi:[0,1]
    v_pk_mul_f32 v[74:75], v[66:67], v[58:59] op_sel:[0,0] op_sel_hi:[0,1]
    v_cvt_pk_bf16_f32 v77, v82, v83
    ds_write_b32 v17, v77 offset:24480
    v_pk_fma_f32 v[68:69], v[82:83], v[58:59], v[72:73] op_sel:[1,1,0] op_sel_hi:[1,0,1] neg_lo:[1,0,0]
    v_pk_fma_f32 v[70:71], v[66:67], v[58:59], v[74:75] op_sel:[1,1,0] op_sel_hi:[1,0,1] neg_lo:[1,0,0]
    v_cvt_pk_bf16_f32 v78, v66, v67
    ds_write_b32 v17, v78 offset:25024
    v_pk_mul_f32 v[72:73], v[68:69], v[58:59] op_sel:[0,0] op_sel_hi:[0,1]
    v_pk_mul_f32 v[74:75], v[70:71], v[58:59] op_sel:[0,0] op_sel_hi:[0,1]
    v_cvt_pk_bf16_f32 v79, v68, v69
    ds_write_b32 v17, v79 offset:25568
    v_pk_fma_f32 v[82:83], v[68:69], v[58:59], v[72:73] op_sel:[1,1,0] op_sel_hi:[1,0,1] neg_lo:[1,0,0]
    v_pk_fma_f32 v[66:67], v[70:71], v[58:59], v[74:75] op_sel:[1,1,0] op_sel_hi:[1,0,1] neg_lo:[1,0,0]
    v_cvt_pk_bf16_f32 v76, v70, v71
    ds_write_b32 v17, v76 offset:26112
    v_pk_mul_f32 v[72:73], v[82:83], v[58:59] op_sel:[0,0] op_sel_hi:[0,1]
    v_pk_mul_f32 v[74:75], v[66:67], v[58:59] op_sel:[0,0] op_sel_hi:[0,1]
    v_cvt_pk_bf16_f32 v77, v82, v83
    ds_write_b32 v17, v77 offset:26656
    v_pk_fma_f32 v[68:69], v[82:83], v[58:59], v[72:73] op_sel:[1,1,0] op_sel_hi:[1,0,1] neg_lo:[1,0,0]
    v_pk_fma_f32 v[70:71], v[66:67], v[58:59], v[74:75] op_sel:[1,1,0] op_sel_hi:[1,0,1] neg_lo:[1,0,0]
    v_cvt_pk_bf16_f32 v78, v66, v67
    ds_write_b32 v17, v78 offset:27200
    v_pk_mul_f32 v[72:73], v[68:69], v[58:59] op_sel:[0,0] op_sel_hi:[0,1]
    v_pk_mul_f32 v[74:75], v[70:71], v[58:59] op_sel:[0,0] op_sel_hi:[0,1]
    v_cvt_pk_bf16_f32 v79, v68, v69
    ds_write_b32 v17, v79 offset:27744
    v_pk_fma_f32 v[82:83], v[68:69], v[58:59], v[72:73] op_sel:[1,1,0] op_sel_hi:[1,0,1] neg_lo:[1,0,0]
    v_pk_fma_f32 v[66:67], v[70:71], v[58:59], v[74:75] op_sel:[1,1,0] op_sel_hi:[1,0,1] neg_lo:[1,0,0]
    v_cvt_pk_bf16_f32 v76, v70, v71
    ds_write_b32 v17, v76 offset:28288
    v_pk_mul_f32 v[72:73], v[82:83], v[58:59] op_sel:[0,0] op_sel_hi:[0,1]
    v_pk_mul_f32 v[74:75], v[66:67], v[58:59] op_sel:[0,0] op_sel_hi:[0,1]
    v_cvt_pk_bf16_f32 v77, v82, v83
    ds_write_b32 v17, v77 offset:28832
    v_pk_fma_f32 v[68:69], v[82:83], v[58:59], v[72:73] op_sel:[1,1,0] op_sel_hi:[1,0,1] neg_lo:[1,0,0]
    v_pk_fma_f32 v[70:71], v[66:67], v[58:59], v[74:75] op_sel:[1,1,0] op_sel_hi:[1,0,1] neg_lo:[1,0,0]
    v_cvt_pk_bf16_f32 v78, v66, v67
    ds_write_b32 v17, v78 offset:29376
    v_pk_mul_f32 v[72:73], v[68:69], v[58:59] op_sel:[0,0] op_sel_hi:[0,1]
    v_pk_mul_f32 v[74:75], v[70:71], v[58:59] op_sel:[0,0] op_sel_hi:[0,1]
    v_cvt_pk_bf16_f32 v79, v68, v69
    ds_write_b32 v17, v79 offset:29920
    v_pk_fma_f32 v[82:83], v[68:69], v[58:59], v[72:73] op_sel:[1,1,0] op_sel_hi:[1,0,1] neg_lo:[1,0,0]
    v_pk_fma_f32 v[66:67], v[70:71], v[58:59], v[74:75] op_sel:[1,1,0] op_sel_hi:[1,0,1] neg_lo:[1,0,0]
    v_cvt_pk_bf16_f32 v76, v70, v71
    ds_write_b32 v17, v76 offset:30464
    v_pk_mul_f32 v[72:73], v[82:83], v[58:59] op_sel:[0,0] op_sel_hi:[0,1]
    v_pk_mul_f32 v[74:75], v[66:67], v[58:59] op_sel:[0,0] op_sel_hi:[0,1]
    v_cvt_pk_bf16_f32 v77, v82, v83
    ds_write_b32 v17, v77 offset:31008
    v_pk_fma_f32 v[68:69], v[82:83], v[58:59], v[72:73] op_sel:[1,1,0] op_sel_hi:[1,0,1] neg_lo:[1,0,0]
    v_pk_fma_f32 v[70:71], v[66:67], v[58:59], v[74:75] op_sel:[1,1,0] op_sel_hi:[1,0,1] neg_lo:[1,0,0]
    v_cvt_pk_bf16_f32 v78, v66, v67
    ds_write_b32 v17, v78 offset:31552
    v_pk_mul_f32 v[72:73], v[68:69], v[58:59] op_sel:[0,0] op_sel_hi:[0,1]
    v_pk_mul_f32 v[74:75], v[70:71], v[58:59] op_sel:[0,0] op_sel_hi:[0,1]
    v_cvt_pk_bf16_f32 v79, v68, v69
    ds_write_b32 v17, v79 offset:32096
    v_pk_fma_f32 v[82:83], v[68:69], v[58:59], v[72:73] op_sel:[1,1,0] op_sel_hi:[1,0,1] neg_lo:[1,0,0]
    v_pk_fma_f32 v[66:67], v[70:71], v[58:59], v[74:75] op_sel:[1,1,0] op_sel_hi:[1,0,1] neg_lo:[1,0,0]
    v_cvt_pk_bf16_f32 v76, v70, v71
    ds_write_b32 v17, v76 offset:32640
    v_pk_mul_f32 v[72:73], v[82:83], v[58:59] op_sel:[0,0] op_sel_hi:[0,1]
    v_cvt_pk_bf16_f32 v77, v82, v83
    ds_write_b32 v17, v77 offset:33184
    v_pk_fma_f32 v[68:69], v[82:83], v[58:59], v[72:73] op_sel:[1,1,0] op_sel_hi:[1,0,1] neg_lo:[1,0,0]
    v_cvt_pk_bf16_f32 v78, v66, v67
    ds_write_b32 v17, v78 offset:33728
    v_cvt_pk_bf16_f32 v79, v68, v69
    ds_write_b32 v17, v79 offset:34272
    s_waitcnt lgkmcnt(0)
    s_barrier
ka_tab:
    s_cmp_eq_u32 s51, 0
    s_cselect_b32 s52, 4, 1
    s_cselect_b32 s53, 3, 6
    s_cselect_b32 s54, 0, 768
    s_cmp_eq_u32 s51, 1
    s_cselect_b32 s52, 2, s52
    s_cselect_b32 s53, 7, s53
    s_cselect_b32 s55, 0, 128
    s_mul_i32 s55, s55, s51
    s_add_u32 s54, s54, s55
    v_lshlrev_b32 v58, s52, v18
    v_and_b32 v58, -4, v58
    v_lshlrev_b32 v59, s53, v19
    v_add_u32 v58, v58, v59
    s_mul_i32 s39, s37, 1536
    s_add_u32 s39, s39, 69632
    s_add_u32 s54, s54, s39
    v_add_u32 v58, s54, v58
    v_lshlrev_b32 v59, 3, v18
    v_lshl_add_u32 v59, v19, 2, v59
    v_add_u32 v59, s39, v59
    s_mul_i32 s39, s37, 16640
    s_add_u32 s39, s39, 107456
    v_lshlrev_b32 v63, 4, v18
    v_sub_u32 v63, s39, v63
    v_lshlrev_b32 v62, 3, v19
    v_sub_u32 v56, v63, v62
    v_lshlrev_b32 v62, 9, v19
    v_sub_u32 v57, v63, v62
    s_mov_b32 s52, 0x05040100
    s_mov_b32 s53, 0x05040302
    s_mov_b32 s54, 0x07060100
    s_mov_b32 s55, 0x07060302
    s_waitcnt lgkmcnt(0)
    s_barrier
    ds_read2_b32 v[88:89], v58 offset0:0 offset1:1
    ds_read2_b32 v[90:91], v58 offset0:2 offset1:3
    ds_read2_b32 v[92:93], v59 offset0:128 offset1:129
    global_load_dwordx4 v[20:23], v52, s[30:31]
    global_load_dwordx4 v[24:27], v52, s[30:31] offset:16
    global_load_dwordx4 v[28:31], v53, s[30:31] offset:0
    global_load_dwordx4 v[32:35], v53, s[30:31] offset:16
    s_cmp_ge_u32 s51, 2
    s_cbranch_scc1 ka_r23
    s_cmp_eq_u32 s51, 1
    s_cbranch_scc1 ka_r1
    v_cmp_eq_u32 vcc, 63, v1
    v_mov_b32 v63, 0
    s_waitcnt lgkmcnt(0)
    v_lshrrev_b32 v58, 16, v90
    v_perm_b32 v59, v90, v90, s52
    v_perm_b32 v62, v93, v93, s52
    v_cndmask_b32 v91, v91, v58, vcc
    v_cndmask_b32 v90, v90, v59, vcc
    v_cndmask_b32 v93, v93, v62, vcc
    v_perm_b32 v64, v89, v89, s53
    v_perm_b32 v65, v88, v88, s53
    ds_write_b64 v56, v[64:65] offset:16568
    v_perm_b32 v66, v89, v90, s54
    v_perm_b32 v67, v88, v89, s54
    ds_write_b64 v56, v[66:67] offset:4080
    v_perm_b32 v68, v90, v90, s53
    v_perm_b32 v69, v89, v89, s53
    ds_write_b64 v56, v[68:69] offset:8240
    v_perm_b32 v70, v90, v91, s54
    v_perm_b32 v71, v89, v90, s54
    ds_write_b64 v56, v[70:71] offset:12400
    v_perm_b32 v72, v92, v93, s54
    v_perm_b32 v73, v92, v92, s52
    ds_write_b64 v56, v[72:73] offset:16056
    v_perm_b32 v74, v93, v93, s52
    v_perm_b32 v75, v92, v92, s53
    ds_write_b64 v56, v[74:75] offset:3568
    v_perm_b32 v76, v93, v93, s52
    v_perm_b32 v77, v92, v93, s54
    ds_write_b64 v56, v[76:77] offset:7728
    v_perm_b32 v78, v93, v93, s53
    v_perm_b32 v79, v93, v93, s52
    ds_write_b64 v56, v[78:79] offset:11888
    s_mov_b64 exec, 1
    v_perm_b32 v64, v63, v88, s52
    v_perm_b32 v65, v63, v63, s52
    ds_write_b64 v56, v[64:65] offset:4088
    v_perm_b32 v66, v88, v88, s53
    v_perm_b32 v67, v63, v63, s52
    ds_write_b64 v56, v[66:67] offset:8248
    v_perm_b32 v68, v88, v89, s54
    v_perm_b32 v69, v63, v88, s52
    ds_write_b64 v56, v[68:69] offset:12408
    s_mov_b64 exec, -1
    s_branch ka_norm
ka_r1:
    s_waitcnt lgkmcnt(0)
    v_perm_b32 v70, v88, v88, s53
    v_perm_b32 v71, v88, v88, s52
    ds_write_b64 v57, v[70:71] offset:15544
    v_perm_b32 v72, v88, v88, s55
    v_perm_b32 v73, v88, v88, s52
    ds_write_b64 v57, v[72:73] offset:3056
    v_perm_b32 v74, v88, v88, s55
    v_perm_b32 v75, v88, v88, s53
    ds_write_b64 v57, v[74:75] offset:7216
    v_perm_b32 v76, v88, v89, s54
    v_perm_b32 v77, v88, v88, s55
    ds_write_b64 v57, v[76:77] offset:11376
    v_perm_b32 v78, v89, v89, s52
    v_perm_b32 v79, v88, v88, s55
    ds_write_b64 v57, v[78:79] offset:15536
    v_perm_b32 v64, v89, v89, s52
    v_perm_b32 v65, v88, v89, s54
    ds_write_b64 v57, v[64:65] offset:3048
    v_perm_b32 v66, v89, v89, s52
    v_perm_b32 v67, v89, v89, s52
    ds_write_b64 v57, v[66:67] offset:7208
    v_perm_b32 v68, v89, v89, s52
    v_perm_b32 v69, v89, v89, s52
    ds_write_b64 v57, v[68:69] offset:11368
    s_branch ka_norm
ka_r23:
    s_lshl_b32 s39, s41, 10
    v_subrev_u32 v57, s39, v57
    v_and_b32 v62, 1, v1
    v_lshlrev_b32 v62, 4, v62
    s_waitcnt lgkmcnt(0)
    v_alignbit_b32 v88, v89, v88, v62
    v_lshrrev_b32 v89, v62, v88
    v_perm_b32 v70, v88, v88, s52
    v_perm_b32 v71, v88, v88, s52
    ds_write_b64 v57, v[70:71] offset:14520
    v_perm_b32 v72, v88, v89, s52
    v_perm_b32 v73, v88, v88, s52
    ds_write_b64 v57, v[72:73] offset:2032
    v_perm_b32 v74, v89, v88, s53
    v_perm_b32 v75, v88, v88, s52
    ds_write_b64 v57, v[74:75] offset:6192
    v_perm_b32 v76, v88, v88, s55
    v_perm_b32 v77, v88, v89, s52
    ds_write_b64 v57, v[76:77] offset:10352
    v_perm_b32 v78, v88, v88, s55
    v_perm_b32 v79, v89, v88, s53
    ds_write_b64 v57, v[78:79] offset:14512
    v_perm_b32 v64, v88, v88, s55
    v_perm_b32 v65, v88, v88, s55
    ds_write_b64 v57, v[64:65] offset:2024
    v_perm_b32 v66, v88, v88, s55
    v_perm_b32 v67, v88, v88, s55
    ds_write_b64 v57, v[66:67] offset:6184
    v_perm_b32 v68, v88, v88, s55
    v_perm_b32 v69, v88, v88, s55
    ds_write_b64 v57, v[68:69] offset:10344
ka_norm:
    v_lshrrev_b32 v62, 5, v0
    v_mul_u32_u24 v62, 1152, v62
    v_lshl_add_u32 v62, v18, 3, v62
    v_add_u32 v62, 145344, v62
    v_and_b32 v94, 15, v1
    v_lshrrev_b32 v95, 4, v1
    v_and_b32 v92, 3, v1
    v_mul_u32_u24 v93, 4160, v92
    v_lshl_add_u32 v93, v95, 4, v93
    v_lshrrev_b32 v57, 2, v94
    v_lshlrev_b32 v56, 3, v57
    v_sub_u32 v93, v93, v56
    v_lshl_add_u32 v56, v92, 1, v95
    s_mul_i32 s39, s37, 16640
    s_add_u32 s39, s39, 107480
    v_add_u32 v92, s39, v93
    s_lshl_b32 s39, s41, 3
    s_add_u32 s39, s39, 14
    v_lshl_add_u32 v56, v57, 4, v56
    v_add_u32 v56, s39, v56
    s_lshl_b32 s39, s37, 8
    s_add_u32 s39, s39, 140736
    v_subrev_u32 v58, 0, v56
    v_lshrrev_b32 v59, 4, v58
    v_mul_u32_u24 v59, 896, v59
    v_lshl_add_u32 v59, v58, 4, v59
    v_add_u32 v96, s39, v59
    v_subrev_u32 v58, 4, v56
    v_lshrrev_b32 v59, 4, v58
    v_mul_u32_u24 v59, 896, v59
    v_lshl_add_u32 v59, v58, 4, v59
    v_add_u32 v97, s39, v59
    v_subrev_u32 v58, 8, v56
    v_lshrrev_b32 v59, 4, v58
    v_mul_u32_u24 v59, 896, v59
    v_lshl_add_u32 v59, v58, 4, v59
    v_add_u32 v98, s39, v59
    v_subrev_u32 v58, 12, v56
    v_lshrrev_b32 v59, 4, v58
    v_mul_u32_u24 v59, 896, v59
    v_lshl_add_u32 v59, v58, 4, v59
    v_add_u32 v99, s39, v59
    s_mov_b32 s57, 0
ka_chk:
    s_waitcnt vmcnt(0)
ka_chk2:
    v_xor_b32 v58, v21, v23
    v_xor_b32 v59, v25, v27
    v_xor_b32 v56, s34, v21
    v_or3_b32 v58, v58, v59, v56
    v_xor_b32 v59, s34, v25
    v_xor_b32 v56, s34, v29
    v_or3_b32 v58, v58, v59, v56
    v_xor_b32 v59, s34, v31
    v_xor_b32 v56, s34, v33
    v_or3_b32 v58, v58, v59, v56
    v_xor_b32 v59, s34, v35
    v_or_b32 v58, v58, v59
    v_cmp_ne_u32 vcc, 0, v58
    s_nop 0
    s_cbranch_vccnz ka_retry
ka_ok:
    v_and_b32 v57, 0xffff0000, v28
    v_rcp_f32 v57, v57
    v_lshlrev_b32 v58, 16, v20
    v_and_b32 v59, 0xffff0000, v20
    v_lshlrev_b32 v56, 16, v28
    v_sub_f32 v58, v58, v56
    v_sub_f32 v59, v59, v56
    v_cvt_pk_bf16_f32 v58, v58, v59
    v_and_b32 v59, 0xffff0000, v58
    v_lshlrev_b32 v58, 16, v58
    v_mul_f32 v80, v58, v57
    v_mul_f32 v84, v59, v57
    v_and_b32 v57, 0xffff0000, v30
    v_rcp_f32 v57, v57
    v_lshlrev_b32 v58, 16, v22
    v_and_b32 v59, 0xffff0000, v22
    v_lshlrev_b32 v56, 16, v30
    v_sub_f32 v58, v58, v56
    v_sub_f32 v59, v59, v56
    v_cvt_pk_bf16_f32 v58, v58, v59
    v_and_b32 v59, 0xffff0000, v58
    v_lshlrev_b32 v58, 16, v58
    v_mul_f32 v81, v58, v57
    v_mul_f32 v85, v59, v57
    v_and_b32 v57, 0xffff0000, v32
    v_rcp_f32 v57, v57
    v_lshlrev_b32 v58, 16, v24
    v_and_b32 v59, 0xffff0000, v24
    v_lshlrev_b32 v56, 16, v32
    v_sub_f32 v58, v58, v56
    v_sub_f32 v59, v59, v56
    v_cvt_pk_bf16_f32 v58, v58, v59
    v_and_b32 v59, 0xffff0000, v58
    v_lshlrev_b32 v58, 16, v58
    v_mul_f32 v82, v58, v57
    v_mul_f32 v86, v59, v57
    v_and_b32 v57, 0xffff0000, v34
    v_rcp_f32 v57, v57
    v_lshlrev_b32 v58, 16, v26
    v_and_b32 v59, 0xffff0000, v26
    v_lshlrev_b32 v56, 16, v34
    v_sub_f32 v58, v58, v56
    v_sub_f32 v59, v59, v56
    v_cvt_pk_bf16_f32 v58, v58, v59
    v_and_b32 v59, 0xffff0000, v58
    v_lshlrev_b32 v58, 16, v58
    v_mul_f32 v83, v58, v57
    v_mul_f32 v87, v59, v57
    v_cvt_pk_bf16_f32 v88, v80, v81
    v_cvt_pk_bf16_f32 v89, v82, v83
    v_cvt_pk_bf16_f32 v90, v84, v85
    v_cvt_pk_bf16_f32 v91, v86, v87
    ds_write_b64 v62, v[88:89]
    ds_write_b64 v62, v[90:91] offset:256
    v_perm_b32 v36, v22, v20, s52
    v_perm_b32 v37, v26, v24, s52
    v_perm_b32 v38, v22, v20, s55
    v_perm_b32 v39, v26, v24, s55
    ds_write_b64 v62, v[36:37] offset:512
    ds_write_b64 v62, v[38:39] offset:768
    s_cmp_ge_u32 s36, 4
    s_waitcnt lgkmcnt(0)
    s_barrier
    s_cbranch_scc1 ka_aux
    s_setprio 2
    ds_read_b64 v[120:121], v92 offset:4032
    ds_read_b64 v[122:123], v92 offset:4040
    ds_read_b128 v[136:139], v96 offset:3456
    ds_read_b128 v[140:143], v96 offset:8064
    ds_read_b64 v[124:125], v92 offset:3008
    ds_read_b64 v[126:127], v92 offset:3016
    ds_read_b128 v[144:147], v96 offset:12672
    ds_read_b64 v[128:129], v92 offset:1984
    ds_read_b64 v[130:131], v92 offset:1992
    ds_read_b128 v[148:151], v96 offset:17280
    ds_read_b64 v[132:133], v92 offset:960
    ds_read_b64 v[134:135], v92 offset:968
    s_mov_b32 s42, 145344
    v_lshrrev_b32 v56, 2, v94
    v_mul_u32_u24 v93, 1152, v56
    v_and_b32 v57, 3, v1
    v_lshlrev_b32 v57, 5, v57
    v_lshl_add_u32 v57, v95, 3, v57
    s_lshl_b32 s39, s41, 7
    s_lshl_b32 s40, s37, 8
    s_add_u32 s39, s39, s40
    v_add_u32 v57, s39, v57
    v_add3_u32 v93, v93, v57, s42
    s_waitcnt lgkmcnt(9)
    v_mfma_f32_16x16x32_bf16 v[104:107], v[120:123], v[136:139], 0
    ds_read_b64 v[152:153], v92 offset:3968
    s_waitcnt lgkmcnt(9)
    v_mfma_f32_16x16x32_bf16 v[108:111], v[120:123], v[140:143], 0
    ds_read_b64 v[154:155], v92 offset:3976
    s_waitcnt lgkmcnt(8)
    v_mfma_f32_16x16x32_bf16 v[108:111], v[124:127], v[136:139], v[108:111]
    ds_read_b128 v[168:171], v97 offset:3456
    s_waitcnt lgkmcnt(8)
    v_mfma_f32_16x16x32_bf16 v[112:115], v[120:123], v[144:147], 0
    ds_read_b128 v[172:175], v97 offset:8064
    v_mfma_f32_16x16x32_bf16 v[112:115], v[124:127], v[140:143], v[112:115]
    ds_read_b64 v[156:157], v92 offset:2944
    ds_read_b64 v[158:159], v92 offset:2952
    s_waitcnt lgkmcnt(9)
    v_mfma_f32_16x16x32_bf16 v[112:115], v[128:131], v[136:139], v[112:115]
    ds_read_b128 v[176:179], v97 offset:12672
    s_waitcnt lgkmcnt(9)
    v_mfma_f32_16x16x32_bf16 v[116:119], v[120:123], v[148:151], 0
    ds_read_b64 v[160:161], v92 offset:1920
    v_mfma_f32_16x16x32_bf16 v[116:119], v[124:127], v[144:147], v[116:119]
    ds_read_b64 v[162:163], v92 offset:1928
    v_mfma_f32_16x16x32_bf16 v[116:119], v[128:131], v[140:143], v[116:119]
    ds_read_b128 v[180:183], v97 offset:17280
    s_waitcnt lgkmcnt(10)
    v_mfma_f32_16x16x32_bf16 v[116:119], v[132:135], v[136:139], v[116:119]
    ds_read_b64 v[164:165], v92 offset:896
    ds_read_b64 v[166:167], v92 offset:904
    s_waitcnt lgkmcnt(5)
    v_mfma_f32_16x16x32_bf16 v[104:107], v[152:155], v[168:171], v[104:107]
    ds_read_b64 v[120:121], v92 offset:3904
    v_mfma_f32_16x16x32_bf16 v[108:111], v[152:155], v[172:175], v[108:111]
    ds_read_b64 v[122:123], v92 offset:3912
    ds_read_b128 v[136:139], v98 offset:3456
    v_mfma_f32_16x16x32_bf16 v[108:111], v[156:159], v[168:171], v[108:111]
    ds_read_b128 v[140:143], v98 offset:8064
    v_mfma_f32_16x16x32_bf16 v[112:115], v[152:155], v[176:179], v[112:115]
    ds_read_b64 v[124:125], v92 offset:2880
    ds_read_b64 v[126:127], v92 offset:2888
    v_mfma_f32_16x16x32_bf16 v[112:115], v[156:159], v[172:175], v[112:115]
    ds_read_b128 v[144:147], v98 offset:12672
    ds_read_b64 v[128:129], v92 offset:1856
    s_waitcnt lgkmcnt(8)
    v_mfma_f32_16x16x32_bf16 v[112:115], v[160:163], v[168:171], v[112:115]
    ds_read_b64 v[130:131], v92 offset:1864
    v_mfma_f32_16x16x32_bf16 v[116:119], v[152:155], v[180:183], v[116:119]
    ds_read_b128 v[148:151], v98 offset:17280
    ds_read_b64 v[132:133], v92 offset:832
    v_mfma_f32_16x16x32_bf16 v[116:119], v[156:159], v[176:179], v[116:119]
    ds_read_b64 v[134:135], v92 offset:840
    v_mfma_f32_16x16x32_bf16 v[116:119], v[160:163], v[172:175], v[116:119]
    ds_read_b64 v[184:185], v93 offset:0
    ds_read_b64 v[186:187], v93 offset:4608
    v_mfma_f32_16x16x32_bf16 v[116:119], v[164:167], v[168:171], v[116:119]
    ds_read_b64 v[188:189], v93 offset:9216
    ds_read_b64 v[190:191], v93 offset:13824
    s_waitcnt lgkmcnt(9)
    v_mfma_f32_16x16x32_bf16 v[104:107], v[120:123], v[136:139], v[104:107]
    ds_read_b64 v[152:153], v92 offset:3840
    v_mfma_f32_16x16x32_bf16 v[108:111], v[120:123], v[140:143], v[108:111]
    ds_read_b64 v[154:155], v92 offset:3848
    ds_read_b128 v[168:171], v99 offset:3456
    v_mfma_f32_16x16x32_bf16 v[108:111], v[124:127], v[136:139], v[108:111]
    ds_read_b128 v[172:175], v99 offset:8064
    v_mfma_f32_16x16x32_bf16 v[112:115], v[120:123], v[144:147], v[112:115]
    ds_read_b64 v[156:157], v92 offset:2816
    ds_read_b64 v[158:159], v92 offset:2824
    v_mfma_f32_16x16x32_bf16 v[112:115], v[124:127], v[140:143], v[112:115]
    ds_read_b128 v[176:179], v99 offset:12672
    ds_read_b64 v[160:161], v92 offset:1792
    s_waitcnt lgkmcnt(12)
    v_mfma_f32_16x16x32_bf16 v[112:115], v[128:131], v[136:139], v[112:115]
    ds_read_b64 v[162:163], v92 offset:1800
    v_mfma_f32_16x16x32_bf16 v[116:119], v[120:123], v[148:151], v[116:119]
    ds_read_b128 v[180:183], v99 offset:17280
    ds_read_b64 v[164:165], v92 offset:768
    v_mfma_f32_16x16x32_bf16 v[116:119], v[124:127], v[144:147], v[116:119]
    ds_read_b64 v[166:167], v92 offset:776
    v_mfma_f32_16x16x32_bf16 v[116:119], v[128:131], v[140:143], v[116:119]
    ds_read_b64 v[192:193], v93 offset:512
    ds_read_b64 v[194:195], v93 offset:5120
    v_mfma_f32_16x16x32_bf16 v[116:119], v[132:135], v[136:139], v[116:119]
    ds_read_b64 v[196:197], v93 offset:9728
    ds_read_b64 v[198:199], v93 offset:14336
    s_waitcnt lgkmcnt(9)
    v_mfma_f32_16x16x32_bf16 v[104:107], v[152:155], v[168:171], v[104:107]
    ds_read_b64 v[120:121], v92 offset:3776
    v_mfma_f32_16x16x32_bf16 v[108:111], v[152:155], v[172:175], v[108:111]
    ds_read_b64 v[122:123], v92 offset:3784
    v_mfma_f32_16x16x32_bf16 v[108:111], v[156:159], v[168:171], v[108:111]
    ds_read_b128 v[136:139], v96 offset:2304
    v_mfma_f32_16x16x32_bf16 v[112:115], v[152:155], v[176:179], v[112:115]
    ds_read_b128 v[140:143], v96 offset:6912
    v_mfma_f32_16x16x32_bf16 v[112:115], v[156:159], v[172:175], v[112:115]
    ds_read_b64 v[124:125], v92 offset:2752
    ds_read_b64 v[126:127], v92 offset:2760
    s_waitcnt lgkmcnt(10)
    v_mfma_f32_16x16x32_bf16 v[112:115], v[160:163], v[168:171], v[112:115]
    ds_read_b128 v[144:147], v96 offset:11520
    v_mfma_f32_16x16x32_bf16 v[116:119], v[152:155], v[180:183], v[116:119]
    ds_read_b64 v[128:129], v92 offset:1728
    v_mfma_f32_16x16x32_bf16 v[116:119], v[156:159], v[176:179], v[116:119]
    ds_read_b64 v[130:131], v92 offset:1736
    v_mfma_f32_16x16x32_bf16 v[116:119], v[160:163], v[172:175], v[116:119]
    ds_read_b128 v[148:151], v96 offset:16128
    v_mfma_f32_16x16x32_bf16 v[116:119], v[164:167], v[168:171], v[116:119]
    ds_read_b64 v[132:133], v92 offset:704
    ds_read_b64 v[134:135], v92 offset:712
    s_waitcnt lgkmcnt(5)
    v_mfma_f32_16x16x32_bf16 v[104:107], v[120:123], v[136:139], v[104:107]
    ds_read_b64 v[152:153], v92 offset:3712
    v_lshl_add_u32 v100, v56, 17, v57
    v_mfma_f32_16x16x32_bf16 v[108:111], v[120:123], v[140:143], v[108:111]
    ds_read_b64 v[154:155], v92 offset:3720
    s_lshl_b32 s39, s38, 9
    v_mfma_f32_16x16x32_bf16 v[108:111], v[124:127], v[136:139], v[108:111]
    ds_read_b128 v[168:171], v97 offset:2304
    s_add_u32 s39, s39, 1048576
    v_mfma_f32_16x16x32_bf16 v[112:115], v[120:123], v[144:147], v[112:115]
    ds_read_b128 v[172:175], v97 offset:6912
    v_add_u32 v100, s39, v100
    v_mfma_f32_16x16x32_bf16 v[112:115], v[124:127], v[140:143], v[112:115]
    ds_read_b64 v[156:157], v92 offset:2688
    ds_read_b64 v[158:159], v92 offset:2696
    s_waitcnt lgkmcnt(6)
    v_mfma_f32_16x16x32_bf16 v[112:115], v[128:131], v[136:139], v[112:115]
    ds_read_b128 v[176:179], v97 offset:11520
    v_add_u32 v101, 524288, v100
    v_mfma_f32_16x16x32_bf16 v[116:119], v[120:123], v[148:151], v[116:119]
    ds_read_b64 v[160:161], v92 offset:1664
    v_add_u32 v102, 1048576, v100
    v_mfma_f32_16x16x32_bf16 v[116:119], v[124:127], v[144:147], v[116:119]
    ds_read_b64 v[162:163], v92 offset:1672
    v_add_u32 v103, 1572864, v100
    v_mfma_f32_16x16x32_bf16 v[116:119], v[128:131], v[140:143], v[116:119]
    ds_read_b128 v[180:183], v97 offset:16128
    s_lshl_b32 s39, s50, 16
    v_mfma_f32_16x16x32_bf16 v[116:119], v[132:135], v[136:139], v[116:119]
    ds_read_b64 v[164:165], v92 offset:640
    ds_read_b64 v[166:167], v92 offset:648
    s_waitcnt lgkmcnt(5)
    v_mfma_f32_16x16x32_bf16 v[104:107], v[152:155], v[168:171], v[104:107]
    ds_read_b64 v[120:121], v92 offset:3648
    s_and_b32 s40, s50, 0xffff0000
    v_mfma_f32_16x16x32_bf16 v[108:111], v[152:155], v[172:175], v[108:111]
    ds_read_b64 v[122:123], v92 offset:3656
    s_cmp_eq_u32 s37, 0
    v_mfma_f32_16x16x32_bf16 v[108:111], v[156:159], v[168:171], v[108:111]
    ds_read_b128 v[136:139], v98 offset:2304
    s_cselect_b32 s50, s39, s40
    v_mfma_f32_16x16x32_bf16 v[112:115], v[152:155], v[176:179], v[112:115]
    ds_read_b128 v[140:143], v98 offset:6912
    v_lshlrev_b32 v200, 16, v184
    v_mfma_f32_16x16x32_bf16 v[112:115], v[156:159], v[172:175], v[112:115]
    ds_read_b64 v[124:125], v92 offset:2624
    ds_read_b64 v[126:127], v92 offset:2632
    s_waitcnt lgkmcnt(6)
    v_mfma_f32_16x16x32_bf16 v[112:115], v[160:163], v[168:171], v[112:115]
    ds_read_b128 v[144:147], v98 offset:11520
    v_and_b32 v201, 0xffff0000, v184
    v_mfma_f32_16x16x32_bf16 v[116:119], v[152:155], v[180:183], v[116:119]
    ds_read_b64 v[128:129], v92 offset:1600
    v_mul_f32 v200, s50, v200
    v_mfma_f32_16x16x32_bf16 v[116:119], v[156:159], v[176:179], v[116:119]
    ds_read_b64 v[130:131], v92 offset:1608
    v_mul_f32 v201, s50, v201
    v_mfma_f32_16x16x32_bf16 v[116:119], v[160:163], v[172:175], v[116:119]
    ds_read_b128 v[148:151], v98 offset:16128
    v_cvt_pk_bf16_f32 v200, v200, v201
    v_mfma_f32_16x16x32_bf16 v[116:119], v[164:167], v[168:171], v[116:119]
    ds_read_b64 v[132:133], v92 offset:576
    ds_read_b64 v[134:135], v92 offset:584
    s_waitcnt lgkmcnt(5)
    v_mfma_f32_16x16x32_bf16 v[104:107], v[120:123], v[136:139], v[104:107]
    ds_read_b64 v[152:153], v92 offset:3584
    v_and_b32 v201, 0xffff0000, v200
    v_mfma_f32_16x16x32_bf16 v[108:111], v[120:123], v[140:143], v[108:111]
    ds_read_b64 v[154:155], v92 offset:3592
    v_lshlrev_b32 v200, 16, v200
    v_mfma_f32_16x16x32_bf16 v[108:111], v[124:127], v[136:139], v[108:111]
    ds_read_b128 v[168:171], v99 offset:2304
    v_lshlrev_b32 v202, 16, v185
    v_mfma_f32_16x16x32_bf16 v[112:115], v[120:123], v[144:147], v[112:115]
    ds_read_b128 v[172:175], v99 offset:6912
    v_and_b32 v203, 0xffff0000, v185
    v_mfma_f32_16x16x32_bf16 v[112:115], v[124:127], v[140:143], v[112:115]
    ds_read_b64 v[156:157], v92 offset:2560
    ds_read_b64 v[158:159], v92 offset:2568
    s_waitcnt lgkmcnt(6)
    v_mfma_f32_16x16x32_bf16 v[112:115], v[128:131], v[136:139], v[112:115]
    ds_read_b128 v[176:179], v99 offset:11520
    v_mul_f32 v202, s50, v202
    v_mfma_f32_16x16x32_bf16 v[116:119], v[120:123], v[148:151], v[116:119]
    ds_read_b64 v[160:161], v92 offset:1536
    v_mul_f32 v203, s50, v203
    v_mfma_f32_16x16x32_bf16 v[116:119], v[124:127], v[144:147], v[116:119]
    ds_read_b64 v[162:163], v92 offset:1544
    v_cvt_pk_bf16_f32 v202, v202, v203
    v_mfma_f32_16x16x32_bf16 v[116:119], v[128:131], v[140:143], v[116:119]
    ds_read_b128 v[180:183], v99 offset:16128
    v_and_b32 v203, 0xffff0000, v202
    v_mfma_f32_16x16x32_bf16 v[116:119], v[132:135], v[136:139], v[116:119]
    ds_read_b64 v[164:165], v92 offset:512
    ds_read_b64 v[166:167], v92 offset:520
    s_waitcnt lgkmcnt(5)
    v_mfma_f32_16x16x32_bf16 v[104:107], v[152:155], v[168:171], v[104:107]
    ds_read_b64 v[120:121], v92 offset:3520
    v_lshlrev_b32 v202, 16, v202
    v_mfma_f32_16x16x32_bf16 v[108:111], v[152:155], v[172:175], v[108:111]
    ds_read_b64 v[122:123], v92 offset:3528
    v_lshlrev_b32 v204, 16, v186
    v_mfma_f32_16x16x32_bf16 v[108:111], v[156:159], v[168:171], v[108:111]
    ds_read_b128 v[136:139], v96 offset:1152
    v_and_b32 v205, 0xffff0000, v186
    v_mfma_f32_16x16x32_bf16 v[112:115], v[152:155], v[176:179], v[112:115]
    ds_read_b128 v[140:143], v96 offset:5760
    v_mul_f32 v204, s50, v204
    v_mfma_f32_16x16x32_bf16 v[112:115], v[156:159], v[172:175], v[112:115]
    ds_read_b64 v[124:125], v92 offset:2496
    ds_read_b64 v[126:127], v92 offset:2504
    s_waitcnt lgkmcnt(6)
    v_mfma_f32_16x16x32_bf16 v[112:115], v[160:163], v[168:171], v[112:115]
    ds_read_b128 v[144:147], v96 offset:10368
    v_mul_f32 v205, s50, v205
    v_mfma_f32_16x16x32_bf16 v[116:119], v[152:155], v[180:183], v[116:119]
    ds_read_b64 v[128:129], v92 offset:1472
    v_cvt_pk_bf16_f32 v204, v204, v205
    v_mfma_f32_16x16x32_bf16 v[116:119], v[156:159], v[176:179], v[116:119]
    ds_read_b64 v[130:131], v92 offset:1480
    v_and_b32 v205, 0xffff0000, v204
    v_mfma_f32_16x16x32_bf16 v[116:119], v[160:163], v[172:175], v[116:119]
    ds_read_b128 v[148:151], v96 offset:14976
    v_lshlrev_b32 v204, 16, v204
    v_mfma_f32_16x16x32_bf16 v[116:119], v[164:167], v[168:171], v[116:119]
    ds_read_b64 v[132:133], v92 offset:448
    ds_read_b64 v[134:135], v92 offset:456
    s_waitcnt lgkmcnt(5)
    v_mfma_f32_16x16x32_bf16 v[104:107], v[120:123], v[136:139], v[104:107]
    ds_read_b64 v[152:153], v92 offset:3456
    v_lshlrev_b32 v206, 16, v187
    v_mfma_f32_16x16x32_bf16 v[108:111], v[120:123], v[140:143], v[108:111]
    ds_read_b64 v[154:155], v92 offset:3464
    v_and_b32 v207, 0xffff0000, v187
    v_mfma_f32_16x16x32_bf16 v[108:111], v[124:127], v[136:139], v[108:111]
    ds_read_b128 v[168:171], v97 offset:1152
    v_mul_f32 v206, s50, v206
    v_mfma_f32_16x16x32_bf16 v[112:115], v[120:123], v[144:147], v[112:115]
    ds_read_b128 v[172:175], v97 offset:5760
    v_mul_f32 v207, s50, v207
    v_mfma_f32_16x16x32_bf16 v[112:115], v[124:127], v[140:143], v[112:115]
    ds_read_b64 v[156:157], v92 offset:2432
    ds_read_b64 v[158:159], v92 offset:2440
    s_waitcnt lgkmcnt(6)
    v_mfma_f32_16x16x32_bf16 v[112:115], v[128:131], v[136:139], v[112:115]
    ds_read_b128 v[176:179], v97 offset:10368
    v_cvt_pk_bf16_f32 v206, v206, v207
    v_mfma_f32_16x16x32_bf16 v[116:119], v[120:123], v[148:151], v[116:119]
    ds_read_b64 v[160:161], v92 offset:1408
    v_and_b32 v207, 0xffff0000, v206
    v_mfma_f32_16x16x32_bf16 v[116:119], v[124:127], v[144:147], v[116:119]
    ds_read_b64 v[162:163], v92 offset:1416
    v_lshlrev_b32 v206, 16, v206
    v_mfma_f32_16x16x32_bf16 v[116:119], v[128:131], v[140:143], v[116:119]
    ds_read_b128 v[180:183], v97 offset:14976
    v_lshlrev_b32 v208, 16, v188
    v_mfma_f32_16x16x32_bf16 v[116:119], v[132:135], v[136:139], v[116:119]
    ds_read_b64 v[164:165], v92 offset:384
    ds_read_b64 v[166:167], v92 offset:392
    s_waitcnt lgkmcnt(5)
    v_mfma_f32_16x16x32_bf16 v[104:107], v[152:155], v[168:171], v[104:107]
    ds_read_b64 v[120:121], v92 offset:3392
    v_and_b32 v209, 0xffff0000, v188
    v_mfma_f32_16x16x32_bf16 v[108:111], v[152:155], v[172:175], v[108:111]
    ds_read_b64 v[122:123], v92 offset:3400
    v_mul_f32 v208, s50, v208
    v_mfma_f32_16x16x32_bf16 v[108:111], v[156:159], v[168:171], v[108:111]
    ds_read_b128 v[136:139], v98 offset:1152
    v_mul_f32 v209, s50, v209
    v_mfma_f32_16x16x32_bf16 v[112:115], v[152:155], v[176:179], v[112:115]
    ds_read_b128 v[140:143], v98 offset:5760
    v_cvt_pk_bf16_f32 v208, v208, v209
    v_mfma_f32_16x16x32_bf16 v[112:115], v[156:159], v[172:175], v[112:115]
    ds_read_b64 v[124:125], v92 offset:2368
    ds_read_b64 v[126:127], v92 offset:2376
    s_waitcnt lgkmcnt(6)
    v_mfma_f32_16x16x32_bf16 v[112:115], v[160:163], v[168:171], v[112:115]
    ds_read_b128 v[144:147], v98 offset:10368
    v_and_b32 v209, 0xffff0000, v208
    v_mfma_f32_16x16x32_bf16 v[116:119], v[152:155], v[180:183], v[116:119]
    ds_read_b64 v[128:129], v92 offset:1344
    v_lshlrev_b32 v208, 16, v208
    v_mfma_f32_16x16x32_bf16 v[116:119], v[156:159], v[176:179], v[116:119]
    ds_read_b64 v[130:131], v92 offset:1352
    v_lshlrev_b32 v210, 16, v189
    v_mfma_f32_16x16x32_bf16 v[116:119], v[160:163], v[172:175], v[116:119]
    ds_read_b128 v[148:151], v98 offset:14976
    v_and_b32 v211, 0xffff0000, v189
    v_mfma_f32_16x16x32_bf16 v[116:119], v[164:167], v[168:171], v[116:119]
    ds_read_b64 v[132:133], v92 offset:320
    ds_read_b64 v[134:135], v92 offset:328
    s_waitcnt lgkmcnt(5)
    v_mfma_f32_16x16x32_bf16 v[104:107], v[120:123], v[136:139], v[104:107]
    ds_read_b64 v[152:153], v92 offset:3328
    v_mul_f32 v210, s50, v210
    v_mfma_f32_16x16x32_bf16 v[108:111], v[120:123], v[140:143], v[108:111]
    ds_read_b64 v[154:155], v92 offset:3336
    v_mul_f32 v211, s50, v211
    v_mfma_f32_16x16x32_bf16 v[108:111], v[124:127], v[136:139], v[108:111]
    ds_read_b128 v[168:171], v99 offset:1152
    v_cvt_pk_bf16_f32 v210, v210, v211
    v_mfma_f32_16x16x32_bf16 v[112:115], v[120:123], v[144:147], v[112:115]
    ds_read_b128 v[172:175], v99 offset:5760
    v_and_b32 v211, 0xffff0000, v210
    v_mfma_f32_16x16x32_bf16 v[112:115], v[124:127], v[140:143], v[112:115]
    ds_read_b64 v[156:157], v92 offset:2304
    ds_read_b64 v[158:159], v92 offset:2312
    s_waitcnt lgkmcnt(6)
    v_mfma_f32_16x16x32_bf16 v[112:115], v[128:131], v[136:139], v[112:115]
    ds_read_b128 v[176:179], v99 offset:10368
    v_lshlrev_b32 v210, 16, v210
    v_mfma_f32_16x16x32_bf16 v[116:119], v[120:123], v[148:151], v[116:119]
    ds_read_b64 v[160:161], v92 offset:1280
    v_lshlrev_b32 v212, 16, v190
    v_mfma_f32_16x16x32_bf16 v[116:119], v[124:127], v[144:147], v[116:119]
    ds_read_b64 v[162:163], v92 offset:1288
    v_and_b32 v213, 0xffff0000, v190
    v_mfma_f32_16x16x32_bf16 v[116:119], v[128:131], v[140:143], v[116:119]
    ds_read_b128 v[180:183], v99 offset:14976
    v_mul_f32 v212, s50, v212
    v_mfma_f32_16x16x32_bf16 v[116:119], v[132:135], v[136:139], v[116:119]
    ds_read_b64 v[164:165], v92 offset:256
    ds_read_b64 v[166:167], v92 offset:264
    s_waitcnt lgkmcnt(5)
    v_mfma_f32_16x16x32_bf16 v[104:107], v[152:155], v[168:171], v[104:107]
    ds_read_b64 v[120:121], v92 offset:3264
    v_mul_f32 v213, s50, v213
    v_mfma_f32_16x16x32_bf16 v[108:111], v[152:155], v[172:175], v[108:111]
    ds_read_b64 v[122:123], v92 offset:3272
    v_cvt_pk_bf16_f32 v212, v212, v213
    v_mfma_f32_16x16x32_bf16 v[108:111], v[156:159], v[168:171], v[108:111]
    ds_read_b128 v[136:139], v96 offset:0
    v_and_b32 v213, 0xffff0000, v212
    v_mfma_f32_16x16x32_bf16 v[112:115], v[152:155], v[176:179], v[112:115]
    ds_read_b128 v[140:143], v96 offset:4608
    v_lshlrev_b32 v212, 16, v212
    v_mfma_f32_16x16x32_bf16 v[112:115], v[156:159], v[172:175], v[112:115]
    ds_read_b64 v[124:125], v92 offset:2240
    ds_read_b64 v[126:127], v92 offset:2248
    s_waitcnt lgkmcnt(6)
    v_mfma_f32_16x16x32_bf16 v[112:115], v[160:163], v[168:171], v[112:115]
    ds_read_b128 v[144:147], v96 offset:9216
    v_lshlrev_b32 v214, 16, v191
    v_mfma_f32_16x16x32_bf16 v[116:119], v[152:155], v[180:183], v[116:119]
    ds_read_b64 v[128:129], v92 offset:1216
    v_and_b32 v215, 0xffff0000, v191
    v_mfma_f32_16x16x32_bf16 v[116:119], v[156:159], v[176:179], v[116:119]
    ds_read_b64 v[130:131], v92 offset:1224
    v_mul_f32 v214, s50, v214
    v_mfma_f32_16x16x32_bf16 v[116:119], v[160:163], v[172:175], v[116:119]
    ds_read_b128 v[148:151], v96 offset:13824
    v_mul_f32 v215, s50, v215
    v_mfma_f32_16x16x32_bf16 v[116:119], v[164:167], v[168:171], v[116:119]
    ds_read_b64 v[132:133], v92 offset:192
    ds_read_b64 v[134:135], v92 offset:200
    s_waitcnt lgkmcnt(5)
    v_mfma_f32_16x16x32_bf16 v[104:107], v[120:123], v[136:139], v[104:107]
    ds_read_b64 v[152:153], v92 offset:3200
    v_cvt_pk_bf16_f32 v214, v214, v215
    v_mfma_f32_16x16x32_bf16 v[108:111], v[120:123], v[140:143], v[108:111]
    ds_read_b64 v[154:155], v92 offset:3208
    v_and_b32 v215, 0xffff0000, v214
    v_mfma_f32_16x16x32_bf16 v[108:111], v[124:127], v[136:139], v[108:111]
    ds_read_b128 v[168:171], v97 offset:0
    v_lshlrev_b32 v214, 16, v214
    v_mfma_f32_16x16x32_bf16 v[112:115], v[120:123], v[144:147], v[112:115]
    ds_read_b128 v[172:175], v97 offset:4608
    v_lshlrev_b32 v216, 16, v192
    v_mfma_f32_16x16x32_bf16 v[112:115], v[124:127], v[140:143], v[112:115]
    ds_read_b64 v[156:157], v92 offset:2176
    ds_read_b64 v[158:159], v92 offset:2184
    s_waitcnt lgkmcnt(6)
    v_mfma_f32_16x16x32_bf16 v[112:115], v[128:131], v[136:139], v[112:115]
    ds_read_b128 v[176:179], v97 offset:9216
    v_and_b32 v217, 0xffff0000, v192
    v_mfma_f32_16x16x32_bf16 v[116:119], v[120:123], v[148:151], v[116:119]
    ds_read_b64 v[160:161], v92 offset:1152
    v_lshlrev_b32 v218, 16, v193
    v_mfma_f32_16x16x32_bf16 v[116:119], v[124:127], v[144:147], v[116:119]
    ds_read_b64 v[162:163], v92 offset:1160
    v_and_b32 v219, 0xffff0000, v193
    v_mfma_f32_16x16x32_bf16 v[116:119], v[128:131], v[140:143], v[116:119]
    ds_read_b128 v[180:183], v97 offset:13824
    v_lshlrev_b32 v220, 16, v194
    v_mfma_f32_16x16x32_bf16 v[116:119], v[132:135], v[136:139], v[116:119]
    ds_read_b64 v[164:165], v92 offset:128
    ds_read_b64 v[166:167], v92 offset:136
    s_waitcnt lgkmcnt(5)
    v_mfma_f32_16x16x32_bf16 v[104:107], v[152:155], v[168:171], v[104:107]
    ds_read_b64 v[120:121], v92 offset:3136
    v_and_b32 v221, 0xffff0000, v194
    v_mfma_f32_16x16x32_bf16 v[108:111], v[152:155], v[172:175], v[108:111]
    ds_read_b64 v[122:123], v92 offset:3144
    v_lshlrev_b32 v222, 16, v195
    v_mfma_f32_16x16x32_bf16 v[108:111], v[156:159], v[168:171], v[108:111]
    ds_read_b128 v[136:139], v98 offset:0
    v_and_b32 v223, 0xffff0000, v195
    v_mfma_f32_16x16x32_bf16 v[112:115], v[152:155], v[176:179], v[112:115]
    ds_read_b128 v[140:143], v98 offset:4608
    v_lshlrev_b32 v224, 16, v196
    v_mfma_f32_16x16x32_bf16 v[112:115], v[156:159], v[172:175], v[112:115]
    ds_read_b64 v[124:125], v92 offset:2112
    ds_read_b64 v[126:127], v92 offset:2120
    s_waitcnt lgkmcnt(6)
    v_mfma_f32_16x16x32_bf16 v[112:115], v[160:163], v[168:171], v[112:115]
    ds_read_b128 v[144:147], v98 offset:9216
    v_and_b32 v225, 0xffff0000, v196
    v_mfma_f32_16x16x32_bf16 v[116:119], v[152:155], v[180:183], v[116:119]
    ds_read_b64 v[128:129], v92 offset:1088
    v_lshlrev_b32 v226, 16, v197
    v_mfma_f32_16x16x32_bf16 v[116:119], v[156:159], v[176:179], v[116:119]
    ds_read_b64 v[130:131], v92 offset:1096
    v_and_b32 v227, 0xffff0000, v197
    v_mfma_f32_16x16x32_bf16 v[116:119], v[160:163], v[172:175], v[116:119]
    ds_read_b128 v[148:151], v98 offset:13824
    v_lshlrev_b32 v228, 16, v198
    v_mfma_f32_16x16x32_bf16 v[116:119], v[164:167], v[168:171], v[116:119]
    ds_read_b64 v[132:133], v92 offset:64
    ds_read_b64 v[134:135], v92 offset:72
    s_waitcnt lgkmcnt(5)
    v_mfma_f32_16x16x32_bf16 v[104:107], v[120:123], v[136:139], v[104:107]
    ds_read_b64 v[152:153], v92 offset:3072
    v_and_b32 v229, 0xffff0000, v198
    v_mfma_f32_16x16x32_bf16 v[108:111], v[120:123], v[140:143], v[108:111]
    ds_read_b64 v[154:155], v92 offset:3080
    v_lshlrev_b32 v230, 16, v199
    v_mfma_f32_16x16x32_bf16 v[108:111], v[124:127], v[136:139], v[108:111]
    ds_read_b128 v[168:171], v99 offset:0
    v_and_b32 v231, 0xffff0000, v199
    v_mfma_f32_16x16x32_bf16 v[112:115], v[120:123], v[144:147], v[112:115]
    ds_read_b128 v[172:175], v99 offset:4608
    v_mfma_f32_16x16x32_bf16 v[112:115], v[124:127], v[140:143], v[112:115]
    ds_read_b64 v[156:157], v92 offset:2048
    ds_read_b64 v[158:159], v92 offset:2056
    s_waitcnt lgkmcnt(6)
    v_mfma_f32_16x16x32_bf16 v[112:115], v[128:131], v[136:139], v[112:115]
    ds_read_b128 v[176:179], v99 offset:9216
    v_mfma_f32_16x16x32_bf16 v[116:119], v[120:123], v[148:151], v[116:119]
    ds_read_b64 v[160:161], v92 offset:1024
    v_mfma_f32_16x16x32_bf16 v[116:119], v[124:127], v[144:147], v[116:119]
    ds_read_b64 v[162:163], v92 offset:1032
    v_mfma_f32_16x16x32_bf16 v[116:119], v[128:131], v[140:143], v[116:119]
    ds_read_b128 v[180:183], v99 offset:13824
    v_mfma_f32_16x16x32_bf16 v[116:119], v[132:135], v[136:139], v[116:119]
    ds_read_b64 v[164:165], v92 offset:0
    ds_read_b64 v[166:167], v92 offset:8
    s_waitcnt lgkmcnt(5)
    v_mfma_f32_16x16x32_bf16 v[104:107], v[152:155], v[168:171], v[104:107]
    v_mfma_f32_16x16x32_bf16 v[108:111], v[152:155], v[172:175], v[108:111]
    v_mfma_f32_16x16x32_bf16 v[108:111], v[156:159], v[168:171], v[108:111]
    v_mfma_f32_16x16x32_bf16 v[112:115], v[152:155], v[176:179], v[112:115]
    v_mfma_f32_16x16x32_bf16 v[112:115], v[156:159], v[172:175], v[112:115]
    s_waitcnt lgkmcnt(0)
    v_mfma_f32_16x16x32_bf16 v[112:115], v[160:163], v[168:171], v[112:115]
    v_mfma_f32_16x16x32_bf16 v[116:119], v[152:155], v[180:183], v[116:119]
    v_mfma_f32_16x16x32_bf16 v[116:119], v[156:159], v[176:179], v[116:119]
    v_mfma_f32_16x16x32_bf16 v[116:119], v[160:163], v[172:175], v[116:119]
    v_mfma_f32_16x16x32_bf16 v[116:119], v[164:167], v[168:171], v[116:119]
    v_cvt_pk_bf16_f32 v104, v104, v105
    v_cvt_pk_bf16_f32 v106, v106, v107
    v_and_b32 v105, 0xffff0000, v104
    v_and_b32 v107, 0xffff0000, v106
    v_lshlrev_b32 v104, 16, v104
    v_lshlrev_b32 v106, 16, v106
    v_pk_add_f32 v[104:105], v[104:105], v[200:201]
    v_pk_add_f32 v[106:107], v[106:107], v[202:203]
    v_cvt_pk_bf16_f32 v104, v104, v105
    v_cvt_pk_bf16_f32 v106, v106, v107
    v_and_b32 v105, 0xffff0000, v104
    v_and_b32 v107, 0xffff0000, v106
    v_lshlrev_b32 v104, 16, v104
    v_lshlrev_b32 v106, 16, v106
    v_pk_add_f32 v[104:105], v[104:105], v[216:217]
    v_pk_add_f32 v[106:107], v[106:107], v[218:219]
    v_cvt_pk_bf16_f32 v104, v104, v105
    v_cvt_pk_bf16_f32 v105, v106, v107
    global_store_dwordx2 v100, v[104:105], s[30:31] sc0 sc1
    v_cvt_pk_bf16_f32 v108, v108, v109
    v_cvt_pk_bf16_f32 v110, v110, v111
    v_and_b32 v109, 0xffff0000, v108
    v_and_b32 v111, 0xffff0000, v110
    v_lshlrev_b32 v108, 16, v108
    v_lshlrev_b32 v110, 16, v110
    v_pk_add_f32 v[108:109], v[108:109], v[204:205]
    v_pk_add_f32 v[110:111], v[110:111], v[206:207]
    v_cvt_pk_bf16_f32 v108, v108, v109
    v_cvt_pk_bf16_f32 v110, v110, v111
    v_and_b32 v109, 0xffff0000, v108
    v_and_b32 v111, 0xffff0000, v110
    v_lshlrev_b32 v108, 16, v108
    v_lshlrev_b32 v110, 16, v110
    v_pk_add_f32 v[108:109], v[108:109], v[220:221]
    v_pk_add_f32 v[110:111], v[110:111], v[222:223]
    v_cvt_pk_bf16_f32 v108, v108, v109
    v_cvt_pk_bf16_f32 v109, v110, v111
    global_store_dwordx2 v101, v[108:109], s[30:31] sc0 sc1
    v_cvt_pk_bf16_f32 v112, v112, v113
    v_cvt_pk_bf16_f32 v114, v114, v115
    v_and_b32 v113, 0xffff0000, v112
    v_and_b32 v115, 0xffff0000, v114
    v_lshlrev_b32 v112, 16, v112
    v_lshlrev_b32 v114, 16, v114
    v_pk_add_f32 v[112:113], v[112:113], v[208:209]
    v_pk_add_f32 v[114:115], v[114:115], v[210:211]
    v_cvt_pk_bf16_f32 v112, v112, v113
    v_cvt_pk_bf16_f32 v114, v114, v115
    v_and_b32 v113, 0xffff0000, v112
    v_and_b32 v115, 0xffff0000, v114
    v_lshlrev_b32 v112, 16, v112
    v_lshlrev_b32 v114, 16, v114
    v_pk_add_f32 v[112:113], v[112:113], v[224:225]
    v_pk_add_f32 v[114:115], v[114:115], v[226:227]
    v_cvt_pk_bf16_f32 v112, v112, v113
    v_cvt_pk_bf16_f32 v113, v114, v115
    global_store_dwordx2 v102, v[112:113], s[30:31] sc0 sc1
    v_cvt_pk_bf16_f32 v116, v116, v117
    v_cvt_pk_bf16_f32 v118, v118, v119
    v_and_b32 v117, 0xffff0000, v116
    v_and_b32 v119, 0xffff0000, v118
    v_lshlrev_b32 v116, 16, v116
    v_lshlrev_b32 v118, 16, v118
    v_pk_add_f32 v[116:117], v[116:117], v[212:213]
    v_pk_add_f32 v[118:119], v[118:119], v[214:215]
    v_cvt_pk_bf16_f32 v116, v116, v117
    v_cvt_pk_bf16_f32 v118, v118, v119
    v_and_b32 v117, 0xffff0000, v116
    v_and_b32 v119, 0xffff0000, v118
    v_lshlrev_b32 v116, 16, v116
    v_lshlrev_b32 v118, 16, v118
    v_pk_add_f32 v[116:117], v[116:117], v[228:229]
    v_pk_add_f32 v[118:119], v[118:119], v[230:231]
    v_cvt_pk_bf16_f32 v116, v116, v117
    v_cvt_pk_bf16_f32 v117, v118, v119
    global_store_dwordx2 v103, v[116:117], s[30:31] sc0 sc1
    s_lshl_b32 s39, s38, 2
    s_add_u32 s39, s39, 212992
    v_lshl_add_u32 v58, v1, 10, s39
    v_mov_b32 v59, s34
    s_waitcnt vmcnt(0)
ka_fin:
    s_barrier
    s_cmp_lg_u32 s36, 0
    s_cbranch_scc1 ka_nofl
    s_mov_b64 exec, 0xff
    global_store_dword v58, v59, s[30:31] sc0 sc1
ka_nofl:
    s_mov_b64 exec, -1
    s_branch m_b
ka_retry:
    s_add_u32 s57, s57, 1
    s_cmp_ge_u32 s57, 65536
    s_cbranch_scc1 ka_ok
    s_mov_b64 exec, vcc
    global_load_dwordx4 v[20:23], v52, s[30:31] sc0 sc1
    global_load_dwordx4 v[24:27], v52, s[30:31] offset:16 sc0 sc1
    global_load_dwordx4 v[28:31], v53, s[30:31] offset:0 sc0 sc1
    global_load_dwordx4 v[32:35], v53, s[30:31] offset:16 sc0 sc1
    s_mov_b64 exec, -1
    s_branch ka_chk
ka_aux:
    s_sub_u32 s56, s36, 6
    s_lshl_b32 s56, s56, 8
    s_add_u32 s56, s56, s2
    s_cmp_ge_u32 s56, 344
    s_cbranch_scc1 ka_nocs
    s_lshr_b32 s39, s56, 2
    s_cmp_ge_u32 s39, 43
    s_cselect_b32 s62, s22, s20
    s_cselect_b32 s63, s23, s21
    s_cselect_b32 s40, 43, 0
    s_sub_u32 s39, s39, s40
    s_lshl_b32 s39, s39, 6
    s_and_b32 s40, s56, 3
    s_mul_i32 s40, s40, 352256
    s_add_u32 s39, s39, s40
    v_lshrrev_b32 v204, 2, v1
    v_mul_u32_u24 v204, 2752, v204
    v_and_b32 v205, 3, v1
    v_lshl_add_u32 v204, v205, 4, v204
    v_add_u32 v204, s39, v204
    global_load_dwordx4 v[216:219], v204, s[62:63]
    v_add_u32 v204, 44032, v204
    global_load_dwordx4 v[220:223], v204, s[62:63]
    v_add_u32 v204, 44032, v204
    global_load_dwordx4 v[224:227], v204, s[62:63]
    v_add_u32 v204, 44032, v204
    global_load_dwordx4 v[228:231], v204, s[62:63]
    v_add_u32 v204, 44032, v204
    global_load_dwordx4 v[232:235], v204, s[62:63]
    v_add_u32 v204, 44032, v204
    global_load_dwordx4 v[236:239], v204, s[62:63]
    v_add_u32 v204, 44032, v204
    global_load_dwordx4 v[240:243], v204, s[62:63]
    v_add_u32 v204, 44032, v204
    global_load_dwordx4 v[244:247], v204, s[62:63]
ka_nocs:
    v_mov_b32 v117, 0x40000000
    v_add_u32 v112, 0, v1
    v_mul_u32_u24 v113, 0xaaab, v112
    v_lshrrev_b32 v113, 19, v113
    v_mul_u32_u24 v114, 12, v113
    v_sub_u32 v114, v112, v114
    v_mul_u32_u24 v113, 2560, v113
    v_lshl_add_u32 v253, v1, 4, v113
    v_add_u32 v112, 64, v1
    v_mul_u32_u24 v113, 0xaaab, v112
    v_lshrrev_b32 v113, 19, v113
    v_mul_u32_u24 v115, 12, v113
    v_sub_u32 v115, v112, v115
    v_mul_u32_u24 v113, 2560, v113
    v_lshl_add_u32 v254, v1, 4, v113
    v_add_u32 v112, 128, v1
    v_mul_u32_u24 v113, 0xaaab, v112
    v_lshrrev_b32 v113, 19, v113
    v_mul_u32_u24 v116, 12, v113
    v_sub_u32 v116, v112, v116
    v_mul_u32_u24 v113, 2560, v113
    v_lshl_add_u32 v255, v1, 4, v113
    s_and_b32 s39, s2, 1
    s_lshr_b32 s40, s2, 5
    s_mul_i32 s14, s39, 7
    s_add_u32 s14, s14, s40
    s_add_u32 s39, s39, 14
    s_cmp_eq_u32 s40, 7
    s_cselect_b32 s14, s39, s14
    s_cmp_eq_u32 s14, 14
    s_cselect_b32 s39, 4, 12
    s_cmp_eq_u32 s14, 15
    s_cselect_b32 s39, 0, s39
    v_cmp_le_u32 vcc, s39, v114
    s_nop 1
    v_cndmask_b32 v253, v253, v117, vcc
    v_cmp_le_u32 vcc, s39, v115
    s_nop 1
    v_cndmask_b32 v254, v254, v117, vcc
    v_cmp_le_u32 vcc, s39, v116
    s_nop 1
    v_cndmask_b32 v255, v255, v117, vcc
    s_mul_i32 s12, s37, 44032
    s_mul_i32 s40, s14, 192
    s_add_u32 s12, s12, s40
    s_and_b32 s35, s2, 6
    s_lshl_b32 s35, s35, 1
    s_mul_i32 s40, s35, 88064
    s_add_u32 s12, s12, s40
    s_mul_i32 s13, s37, 3072
    s_mul_i32 s39, s41, 6176
    s_add_u32 s13, s13, s39
    s_cmp_ge_u32 s36, 6
    s_cselect_b32 s8, s22, s20
    s_cselect_b32 s9, s23, s21
    s_mov_b32 s10, 1409024
    s_mov_b32 s11, 0x20000
    s_mul_i32 s57, s14, 3
    s_min_u32 s57, s57, 40
    s_and_b32 s39, s2, 6
    s_lshl_b32 s39, s39, 1
    s_bfe_u32 s40, s2, 0x20003
    s_add_u32 s39, s39, s40
    s_lshl_b32 s39, s39, 2
    s_add_u32 s39, s39, s36
    s_sub_u32 s39, s39, 4
    s_mul_i32 s39, s39, 86
    s_add_u32 s39, s39, s57
    s_lshl_b32 s39, s39, 10
    s_add_u32 s39, s39, 4194304
    v_lshl_add_u32 v112, v1, 4, s39
    v_add_u32 v113, 44032, v112
    v_mov_b32 v116, -1
    v_mov_b32 v117, -1
    v_mov_b32 v118, -1
    v_mov_b32 v119, -1
    global_store_dwordx4 v112, v[116:119], s[30:31] offset:0 sc0 sc1
    global_store_dwordx4 v113, v[116:119], s[30:31] offset:0 sc0 sc1
    global_store_dwordx4 v112, v[116:119], s[30:31] offset:1024 sc0 sc1
    global_store_dwordx4 v113, v[116:119], s[30:31] offset:1024 sc0 sc1
    global_store_dwordx4 v112, v[116:119], s[30:31] offset:2048 sc0 sc1
    global_store_dwordx4 v113, v[116:119], s[30:31] offset:2048 sc0 sc1
    s_add_u32 m0, s13, 0
    s_nop 0
    buffer_load_dwordx4 v253, s[8:11], s12 offen lds
    buffer_load_dwordx4 v254, s[8:11], s12 offen offset:1024 lds
    buffer_load_dwordx4 v255, s[8:11], s12 offen offset:2048 lds
    s_add_u32 s12, s12, 88064
    s_add_u32 m0, s13, 12320
    s_nop 0
    buffer_load_dwordx4 v253, s[8:11], s12 offen lds
    buffer_load_dwordx4 v254, s[8:11], s12 offen offset:1024 lds
    buffer_load_dwordx4 v255, s[8:11], s12 offen offset:2048 lds
    s_add_u32 s12, s12, 88064
    s_cmp_lg_u32 s36, 4
    s_cbranch_scc1 ka_a3
    s_cmp_lg_u32 s2, 0
    s_cbranch_scc1 ka_a3
    s_add_u32 s39, s58, 1
    v_mov_b32 v108, 32768
    v_mov_b32 v109, s39
    s_mov_b64 exec, 1
    global_store_dword v108, v109, s[30:31]
ka_a3:
    s_mov_b64 exec, -1
    s_cmp_ge_u32 s56, 344
    s_cbranch_scc1 ka_pfw
    s_waitcnt vmcnt(12)
    v_lshlrev_b32 v100, 16, v216
    v_and_b32 v101, 0xffff0000, v216
    v_lshlrev_b32 v102, 16, v217
    v_and_b32 v103, 0xffff0000, v217
    v_lshlrev_b32 v104, 16, v218
    v_and_b32 v105, 0xffff0000, v218
    v_lshlrev_b32 v106, 16, v219
    v_and_b32 v107, 0xffff0000, v219
    v_lshlrev_b32 v108, 16, v220
    v_and_b32 v109, 0xffff0000, v220
    v_add_f32 v100, v100, v108
    v_add_f32 v101, v101, v109
    v_lshlrev_b32 v108, 16, v221
    v_and_b32 v109, 0xffff0000, v221
    v_add_f32 v102, v102, v108
    v_add_f32 v103, v103, v109
    v_lshlrev_b32 v108, 16, v222
    v_and_b32 v109, 0xffff0000, v222
    v_add_f32 v104, v104, v108
    v_add_f32 v105, v105, v109
    v_lshlrev_b32 v108, 16, v223
    v_and_b32 v109, 0xffff0000, v223
    v_add_f32 v106, v106, v108
    v_add_f32 v107, v107, v109
    v_lshlrev_b32 v108, 16, v224
    v_and_b32 v109, 0xffff0000, v224
    v_add_f32 v100, v100, v108
    v_add_f32 v101, v101, v109
    v_lshlrev_b32 v108, 16, v225
    v_and_b32 v109, 0xffff0000, v225
    v_add_f32 v102, v102, v108
    v_add_f32 v103, v103, v109
    v_lshlrev_b32 v108, 16, v226
    v_and_b32 v109, 0xffff0000, v226
    v_add_f32 v104, v104, v108
    v_add_f32 v105, v105, v109
    v_lshlrev_b32 v108, 16, v227
    v_and_b32 v109, 0xffff0000, v227
    v_add_f32 v106, v106, v108
    v_add_f32 v107, v107, v109
    v_lshlrev_b32 v108, 16, v228
    v_and_b32 v109, 0xffff0000, v228
    v_add_f32 v100, v100, v108
    v_add_f32 v101, v101, v109
    v_lshlrev_b32 v108, 16, v229
    v_and_b32 v109, 0xffff0000, v229
    v_add_f32 v102, v102, v108
    v_add_f32 v103, v103, v109
    v_lshlrev_b32 v108, 16, v230
    v_and_b32 v109, 0xffff0000, v230
    v_add_f32 v104, v104, v108
    v_add_f32 v105, v105, v109
    v_lshlrev_b32 v108, 16, v231
    v_and_b32 v109, 0xffff0000, v231
    v_add_f32 v106, v106, v108
    v_add_f32 v107, v107, v109
    v_lshlrev_b32 v108, 16, v232
    v_and_b32 v109, 0xffff0000, v232
    v_add_f32 v100, v100, v108
    v_add_f32 v101, v101, v109
    v_lshlrev_b32 v108, 16, v233
    v_and_b32 v109, 0xffff0000, v233
    v_add_f32 v102, v102, v108
    v_add_f32 v103, v103, v109
    v_lshlrev_b32 v108, 16, v234
    v_and_b32 v109, 0xffff0000, v234
    v_add_f32 v104, v104, v108
    v_add_f32 v105, v105, v109
    v_lshlrev_b32 v108, 16, v235
    v_and_b32 v109, 0xffff0000, v235
    v_add_f32 v106, v106, v108
    v_add_f32 v107, v107, v109
    v_lshlrev_b32 v108, 16, v236
    v_and_b32 v109, 0xffff0000, v236
    v_add_f32 v100, v100, v108
    v_add_f32 v101, v101, v109
    v_lshlrev_b32 v108, 16, v237
    v_and_b32 v109, 0xffff0000, v237
    v_add_f32 v102, v102, v108
    v_add_f32 v103, v103, v109
    v_lshlrev_b32 v108, 16, v238
    v_and_b32 v109, 0xffff0000, v238
    v_add_f32 v104, v104, v108
    v_add_f32 v105, v105, v109
    v_lshlrev_b32 v108, 16, v239
    v_and_b32 v109, 0xffff0000, v239
    v_add_f32 v106, v106, v108
    v_add_f32 v107, v107, v109
    v_lshlrev_b32 v108, 16, v240
    v_and_b32 v109, 0xffff0000, v240
    v_add_f32 v100, v100, v108
    v_add_f32 v101, v101, v109
    v_lshlrev_b32 v108, 16, v241
    v_and_b32 v109, 0xffff0000, v241
    v_add_f32 v102, v102, v108
    v_add_f32 v103, v103, v109
    v_lshlrev_b32 v108, 16, v242
    v_and_b32 v109, 0xffff0000, v242
    v_add_f32 v104, v104, v108
    v_add_f32 v105, v105, v109
    v_lshlrev_b32 v108, 16, v243
    v_and_b32 v109, 0xffff0000, v243
    v_add_f32 v106, v106, v108
    v_add_f32 v107, v107, v109
    v_lshlrev_b32 v108, 16, v244
    v_and_b32 v109, 0xffff0000, v244
    v_add_f32 v100, v100, v108
    v_add_f32 v101, v101, v109
    v_lshlrev_b32 v108, 16, v245
    v_and_b32 v109, 0xffff0000, v245
    v_add_f32 v102, v102, v108
    v_add_f32 v103, v103, v109
    v_lshlrev_b32 v108, 16, v246
    v_and_b32 v109, 0xffff0000, v246
    v_add_f32 v104, v104, v108
    v_add_f32 v105, v105, v109
    v_lshlrev_b32 v108, 16, v247
    v_and_b32 v109, 0xffff0000, v247
    v_add_f32 v106, v106, v108
    v_add_f32 v107, v107, v109
    v_permlane32_swap_b32 v100, v104
    v_permlane32_swap_b32 v101, v105
    v_permlane32_swap_b32 v102, v106
    v_permlane32_swap_b32 v103, v107
    v_add_f32 v100, v100, v104
    v_add_f32 v101, v101, v105
    v_add_f32 v102, v102, v106
    v_add_f32 v103, v103, v107
    s_nop 0
    v_permlane16_swap_b32 v100, v102
    v_permlane16_swap_b32 v101, v103
    v_add_f32 v100, v100, v102
    v_add_f32 v101, v101, v103
    s_nop 0
    v_add_f32_dpp v100, v100, v100 row_ror:8 row_mask:0xf bank_mask:0xf
    v_add_f32_dpp v101, v101, v101 row_ror:8 row_mask:0xf bank_mask:0xf
    s_nop 0
    v_add_f32_dpp v100, v100, v100 row_ror:4 row_mask:0xf bank_mask:0xf
    v_add_f32_dpp v101, v101, v101 row_ror:4 row_mask:0xf bank_mask:0xf
    v_and_b32 v108, 4, v1
    v_cmp_ne_u32 vcc, 0, v108
    s_nop 1
    v_cndmask_b32 v100, v100, v101, vcc
    v_cvt_pk_bf16_f32 v101, v100, v100
    v_and_b32 v101, 0xffff0000, v101
    v_sub_f32 v101, v100, v101
    v_cvt_pk_bf16_f32 v102, v100, v101
    v_mov_b32 v103, s34
    v_lshlrev_b32 v96, 8, v205
    v_lshl_add_u32 v96, v19, 7, v96
    v_and_b32 v109, 16, v1
    v_lshl_add_u32 v96, v109, 2, v96
    v_lshl_add_u32 v96, v108, 3, v96
    s_lshr_b32 s39, s56, 2
    s_lshl_b32 s39, s39, 10
    s_and_b32 s40, s56, 3
    s_lshl_b32 s40, s40, 3
    s_add_u32 s39, s39, s40
    s_add_u32 s39, s39, 65536
    v_add_u32 v96, s39, v96
    s_mov_b32 exec_lo, 0x00ff00ff
    s_mov_b32 exec_hi, 0x00ff00ff
    global_store_dwordx2 v96, v[102:103], s[30:31] sc0 sc1
    s_mov_b64 exec, -1
ka_pfw:
    s_add_u32 m0, s13, 24640
    s_nop 0
    buffer_load_dwordx4 v253, s[8:11], s12 offen lds
    buffer_load_dwordx4 v254, s[8:11], s12 offen offset:1024 lds
    buffer_load_dwordx4 v255, s[8:11], s12 offen offset:2048 lds
    s_add_u32 s12, s12, 88064
    s_add_u32 m0, s13, 36960
    s_nop 0
    buffer_load_dwordx4 v253, s[8:11], s12 offen lds
    buffer_load_dwordx4 v254, s[8:11], s12 offen offset:1024 lds
    buffer_load_dwordx4 v255, s[8:11], s12 offen offset:2048 lds
    s_add_u32 s12, s12, 88064
    s_cmp_eq_u32 s35, 12
    s_cselect_b32 s3, 1409024, 0
    s_sub_u32 s12, s12, s3
    s_add_u32 m0, s13, 49280
    s_nop 0
    buffer_load_dwordx4 v253, s[8:11], s12 offen lds
    buffer_load_dwordx4 v254, s[8:11], s12 offen offset:1024 lds
    buffer_load_dwordx4 v255, s[8:11], s12 offen offset:2048 lds
    s_add_u32 s12, s12, 88064
    s_waitcnt vmcnt(15)
    s_branch ka_fin
m_b:
    s_and_b32 s39, s2, 1
    s_lshr_b32 s40, s2, 5
    s_mul_i32 s38, s39, 7
    s_add_u32 s38, s38, s40
    s_add_u32 s39, s39, 14
    s_cmp_eq_u32 s40, 7
    s_cselect_b32 s38, s39, s38
    s_and_b32 s39, s40, 3
    s_cmp_eq_u32 s39, 3
    s_cselect_b32 s39, 4, 0
    s_xor_b32 s55, s40, s39
    s_and_b32 s41, s2, 1
    s_and_b32 s23, s2, 7
    s_mul_i32 s23, s23, 7
    s_bfe_u32 s39, s2, 0x20003
    s_mul_i32 s39, s39, 14
    s_add_u32 s23, s23, s39
    s_mul_i32 s39, s55, 0
    s_add_u32 s23, s23, s39
    s_lshr_b32 s23, s23, 2
    s_sub_u32 s39, s23, 14
    s_cselect_b32 s23, s23, s39
    s_sub_u32 s39, s23, 14
    s_cselect_b32 s23, s23, s39
    s_mul_i32 s23, s23, 3072
    s_and_b32 s39, s2, 6
    s_lshl_b32 s39, s39, 1
    s_bfe_u32 s40, s2, 0x20003
    s_add_u32 s37, s39, s40
    v_mov_b32 v8, 163824
    s_mov_b32 s48, s30
    s_mov_b32 s49, s31
    s_mov_b32 s50, 16777216
    s_mov_b32 s51, 0x20000
    s_cmp_lt_u32 s36, 4
    s_cbranch_scc1 k2_lo
    s_cmp_eq_u32 s38, 15
    s_cbranch_scc1 k2_stats
    s_add_u32 m0, s13, 61600
    s_nop 0
    buffer_load_dwordx4 v253, s[8:11], s12 offen lds
    buffer_load_dwordx4 v254, s[8:11], s12 offen offset:1024 lds
    buffer_load_dwordx4 v255, s[8:11], s12 offen offset:2048 lds
    s_add_u32 s12, s12, 88064
    s_add_u32 m0, s13, 73920
    s_nop 0
    buffer_load_dwordx4 v253, s[8:11], s12 offen lds
    buffer_load_dwordx4 v254, s[8:11], s12 offen offset:1024 lds
    buffer_load_dwordx4 v255, s[8:11], s12 offen offset:2048 lds
    s_add_u32 s12, s12, 88064
    s_add_u32 m0, s13, 86240
    s_nop 0
    buffer_load_dwordx4 v253, s[8:11], s12 offen lds
    buffer_load_dwordx4 v254, s[8:11], s12 offen offset:1024 lds
    buffer_load_dwordx4 v255, s[8:11], s12 offen offset:2048 lds
    s_add_u32 s12, s12, 88064
    s_cmp_eq_u32 s35, 8
    s_cselect_b32 s3, 1409024, 0
    s_sub_u32 s12, s12, s3
    s_sub_u32 s36, s36, 4
    v_lshrrev_b32 v10, 4, v1
    v_lshlrev_b32 v11, 2, v10
    v_and_b32 v12, 15, v1
    v_xor_b32 v11, v11, v12
    v_lshlrev_b32 v11, 4, v11
    v_lshl_add_u32 v2, v10, 8, v11
    s_lshl_b32 s45, s36, 11
    s_lshl_b32 s39, s37, 17
    s_add_u32 s43, s45, s39
    s_add_u32 s43, s43, 1048576
    s_lshl_b32 s39, s35, 13
    s_add_u32 s43, s43, s39
    s_mov_b32 s39, s55
    s_lshl_b32 s16, s36, 10
    v_bfe_u32 v10, v1, 4, 2
    v_lshlrev_b32 v10, 1, v10
    v_and_b32 v11, 7, v1
    v_xor_b32 v10, v10, v11
    v_lshlrev_b32 v10, 4, v10
    v_lshrrev_b32 v12, 3, v1
    v_lshl_add_u32 v7, v12, 8, v10
    s_lshl_b32 s47, s39, 7
    s_lshl_b32 s40, s36, 13
    s_add_u32 s47, s47, s40
    v_bfe_u32 v10, v1, 4, 1
    s_and_b32 s39, s36, 1
    s_lshl_b32 s39, s39, 1
    v_or_b32 v10, s39, v10
    v_lshlrev_b32 v10, 1, v10
    v_xor_b32 v10, v10, v11
    v_lshlrev_b32 v10, 4, v10
    v_lshl_add_u32 v3, v12, 10, v10
    s_mov_b32 s4, s24
    s_mov_b32 s5, s25
    s_mov_b32 s6, 1409024
    s_mov_b32 s7, 0x20000
    v_bfe_u32 v10, v1, 2, 2
    v_lshrrev_b32 v11, 4, v1
    v_lshl_add_u32 v12, v11, 3, v10
    v_lshlrev_b32 v12, 7, v12
    v_and_b32 v13, 3, v1
    v_lshl_add_u32 v12, v13, 3, v12
    v_lshrrev_b32 v14, 1, v10
    v_and_b32 v16, 1, v11
    v_lshl_or_b32 v14, v16, 1, v14
    v_xor_b32 v16, 0, v14
    v_lshl_add_u32 v240, v16, 5, v12
    v_add_u32 v244, 0xf000, v240
    v_add_u32 v248, 0x1e000, v240
    v_xor_b32 v16, 1, v14
    v_lshl_add_u32 v241, v16, 5, v12
    v_add_u32 v245, 0xf000, v241
    v_add_u32 v249, 0x1e000, v241
    v_xor_b32 v16, 2, v14
    v_lshl_add_u32 v242, v16, 5, v12
    v_add_u32 v246, 0xf000, v242
    v_add_u32 v250, 0x1e000, v242
    v_xor_b32 v16, 3, v14
    v_lshl_add_u32 v243, v16, 5, v12
    v_add_u32 v247, 0xf000, v243
    v_add_u32 v251, 0x1e000, v243
    v_lshl_add_u32 v15, v11, 2, v10
    v_lshlrev_b32 v15, 7, v15
    v_lshl_add_u32 v15, v13, 3, v15
    v_xor_b32 v16, s36, v14
    v_lshl_add_u32 v15, v16, 5, v15
    v_add_u32 v15, 73920, v15
    v_lshlrev_b32 v17, 4, v1
    v_and_b32 v18, 15, v1
    v_lshlrev_b32 v18, 10, v18
    v_lshl_add_u32 v18, v11, 3, v18
    s_mov_b32 s39, 61600
    s_cmp_eq_u32 s36, 1
    s_cselect_b32 s39, 65696, s39
    s_cmp_eq_u32 s36, 2
    s_cselect_b32 s39, 69792, s39
    s_cmp_eq_u32 s36, 3
    s_cselect_b32 s39, 147776, s39
    v_add_u32 v19, s39, v17
    s_mov_b32 s60, s26
    s_mov_b32 s61, s27
    s_mov_b32 s62, 2097152
    s_mov_b32 s63, 0x20000
    s_lshl_b32 s39, s37, 1
    s_mov_b32 s40, s41
    s_add_u32 s39, s39, s40
    s_lshl_b32 s39, s39, 2
    s_add_u32 s39, s39, s36
    s_mul_i32 s46, s39, 44032
    s_add_u32 s46, s46, 4194304
    s_lshl_b32 s44, s39, 14
    s_mov_b32 s40, s55
    s_lshl_b32 s40, s40, 7
    s_add_u32 s44, s44, s40
    s_add_u32 s40, s23, 0
    s_sub_u32 s39, s40, 43008
    s_cselect_b32 s40, s40, s39
    s_lshl_b32 s40, s40, 5
    s_add_u32 m0, s16, 155968
    s_add_u32 s39, s47, s40
    buffer_load_dwordx4 v3, s[4:7], s39 offen lds
    s_cmp_lg_u32 s36, 0
    s_cbranch_scc1 k2_hp_d
    s_lshr_b32 s39, s37, 1
    s_lshl_b32 s39, s39, 10
    s_add_u32 s39, s39, 212992
    v_lshl_add_u32 v204, v1, 4, s39
    s_mov_b32 s17, 0
k2_hp:
    global_load_dwordx4 v[200:203], v204, s[30:31] sc0 sc1
    s_add_u32 s17, s17, 1
    s_cmp_ge_u32 s17, 65536
    s_cbranch_scc1 k2_hp_d
    s_waitcnt vmcnt(0)
    v_xor_b32 v200, s34, v200
    v_xor_b32 v201, s34, v201
    v_xor_b32 v202, s34, v202
    v_xor_b32 v203, s34, v203
    v_or3_b32 v200, v200, v201, v202
    v_or_b32 v200, v200, v203
    v_cmp_ne_u32 vcc, 0, v200
    s_nop 0
    s_mov_b64 exec, vcc
    s_cbranch_vccnz k2_hp
k2_hp_d:
    s_mov_b64 exec, -1
    s_barrier
    s_add_u32 m0, s45, 123200
    s_nop 0
    buffer_load_dwordx4 v2, s[48:51], s43 offen lds
    buffer_load_dwordx4 v2, s[48:51], s43 offen offset:1024 lds
    s_add_u32 s43, s43, 8192
    s_add_u32 m0, s45, 131392
    s_nop 0
    buffer_load_dwordx4 v2, s[48:51], s43 offen lds
    buffer_load_dwordx4 v2, s[48:51], s43 offen offset:1024 lds
    s_add_u32 s43, s43, 8192
    s_add_u32 m0, s45, 139584
    s_nop 0
    buffer_load_dwordx4 v2, s[48:51], s43 offen lds
    buffer_load_dwordx4 v2, s[48:51], s43 offen offset:1024 lds
    s_add_u32 s43, s43, 8192
    s_waitcnt vmcnt(4) lgkmcnt(0)
    s_barrier
    s_add_u32 m0, s45, 147776
    s_nop 0
    buffer_load_dwordx4 v2, s[48:51], s43 offen lds
    buffer_load_dwordx4 v2, s[48:51], s43 offen offset:1024 lds
    s_add_u32 s43, s43, 8192
    s_cmp_eq_u32 s35, 12
    s_cselect_b32 s3, 131072, 0
    s_sub_u32 s43, s43, s3
    s_add_u32 m0, s13, 98560
    s_nop 0
    buffer_load_dwordx4 v253, s[8:11], s12 offen lds
    buffer_load_dwordx4 v254, s[8:11], s12 offen offset:1024 lds
    buffer_load_dwordx4 v255, s[8:11], s12 offen offset:2048 lds
    s_add_u32 s12, s12, 88064
    s_waitcnt vmcnt(7) lgkmcnt(0)
    s_barrier
    s_add_u32 m0, s45, 123200
    s_nop 0
    buffer_load_dwordx4 v2, s[48:51], s43 offen lds
    buffer_load_dwordx4 v2, s[48:51], s43 offen offset:1024 lds
    s_add_u32 s43, s43, 8192
    s_add_u32 m0, s13, 110880
    s_nop 0
    buffer_load_dwordx4 v253, s[8:11], s12 offen lds
    buffer_load_dwordx4 v254, s[8:11], s12 offen offset:1024 lds
    buffer_load_dwordx4 v255, s[8:11], s12 offen offset:2048 lds
    s_add_u32 s12, s12, 88064
    ds_read_b64_tr_b16 v[36:37], v248 offset:33088
    ds_read_b64_tr_b16 v[38:39], v248 offset:33600
    ds_read_b64_tr_b16 v[40:41], v249 offset:33088
    ds_read_b64_tr_b16 v[42:43], v249 offset:33600
    ds_read_b64_tr_b16 v[44:45], v250 offset:33088
    ds_read_b64_tr_b16 v[46:47], v250 offset:33600
    ds_read_b64_tr_b16 v[48:49], v251 offset:33088
    ds_read_b64_tr_b16 v[50:51], v251 offset:33600
    s_waitcnt vmcnt(10) lgkmcnt(0)
    s_barrier
    s_add_u32 m0, s45, 131392
    s_nop 0
    buffer_load_dwordx4 v2, s[48:51], s43 offen lds
    buffer_load_dwordx4 v2, s[48:51], s43 offen offset:1024 lds
    s_add_u32 s43, s43, 8192
    s_add_u32 m0, s13, 0
    s_nop 0
    buffer_load_dwordx4 v253, s[8:11], s12 offen lds
    buffer_load_dwordx4 v254, s[8:11], s12 offen offset:1024 lds
    buffer_load_dwordx4 v255, s[8:11], s12 offen offset:2048 lds
    s_add_u32 s12, s12, 88064
    s_add_u32 s40, s23, 1024
    s_sub_u32 s39, s40, 43008
    s_cselect_b32 s40, s40, s39
    s_lshl_b32 s40, s40, 5
    s_add_u32 m0, s16, 155968
    s_add_u32 s39, s47, s40
    buffer_load_dwordx4 v3, s[4:7], s39 offen lds
    s_waitcnt vmcnt(14) lgkmcnt(0)
    s_barrier
    s_add_u32 m0, s45, 139584
    s_nop 0
    buffer_load_dwordx4 v2, s[48:51], s43 offen lds
    buffer_load_dwordx4 v2, s[48:51], s43 offen offset:1024 lds
    s_add_u32 s43, s43, 8192
    s_add_u32 m0, s13, 12320
    s_nop 0
    buffer_load_dwordx4 v253, s[8:11], s12 offen lds
    buffer_load_dwordx4 v254, s[8:11], s12 offen offset:1024 lds
    buffer_load_dwordx4 v255, s[8:11], s12 offen offset:2048 lds
    s_add_u32 s12, s12, 88064
    s_cmp_eq_u32 s35, 4
    s_cselect_b32 s3, 1409024, 0
    s_sub_u32 s12, s12, s3
    s_waitcnt vmcnt(14) lgkmcnt(0)
    s_barrier
    s_add_u32 m0, s45, 147776
    s_nop 0
    buffer_load_dwordx4 v2, s[48:51], s43 offen lds
    buffer_load_dwordx4 v2, s[48:51], s43 offen offset:1024 lds
    s_add_u32 s43, s43, 8192
    s_cmp_eq_u32 s35, 8
    s_cselect_b32 s3, 131072, 0
    s_sub_u32 s43, s43, s3
    s_add_u32 m0, s13, 24640
    s_nop 0
    buffer_load_dwordx4 v253, s[8:11], s12 offen lds
    buffer_load_dwordx4 v254, s[8:11], s12 offen offset:1024 lds
    buffer_load_dwordx4 v255, s[8:11], s12 offen offset:2048 lds
    s_add_u32 s12, s12, 88064
    s_waitcnt vmcnt(14) lgkmcnt(0)
    s_barrier
    s_add_u32 m0, s45, 123200
    s_nop 0
    buffer_load_dwordx4 v2, s[48:51], s43 offen lds
    buffer_load_dwordx4 v2, s[48:51], s43 offen offset:1024 lds
    s_add_u32 s43, s43, 8192
    s_add_u32 m0, s13, 36960
    s_nop 0
    buffer_load_dwordx4 v253, s[8:11], s12 offen lds
    buffer_load_dwordx4 v254, s[8:11], s12 offen offset:1024 lds
    buffer_load_dwordx4 v255, s[8:11], s12 offen offset:2048 lds
    s_add_u32 s12, s12, 88064
    s_waitcnt vmcnt(13) lgkmcnt(0)
    s_barrier
    s_add_u32 m0, s45, 131392
    s_nop 0
    buffer_load_dwordx4 v2, s[48:51], s43 offen lds
    buffer_load_dwordx4 v2, s[48:51], s43 offen offset:1024 lds
    s_add_u32 s43, s43, 8192
    s_add_u32 m0, s13, 49280
    s_nop 0
    buffer_load_dwordx4 v253, s[8:11], s12 offen lds
    buffer_load_dwordx4 v254, s[8:11], s12 offen offset:1024 lds
    buffer_load_dwordx4 v255, s[8:11], s12 offen offset:2048 lds
    s_add_u32 s12, s12, 88064
    ds_read_b64_tr_b16 v[52:53], v248 offset:33088
    ds_read_b64_tr_b16 v[54:55], v248 offset:33600
    ds_read_b64_tr_b16 v[56:57], v249 offset:33088
    ds_read_b64_tr_b16 v[58:59], v249 offset:33600
    ds_read_b64_tr_b16 v[60:61], v250 offset:33088
    ds_read_b64_tr_b16 v[62:63], v250 offset:33600
    ds_read_b64_tr_b16 v[64:65], v251 offset:33088
    ds_read_b64_tr_b16 v[66:67], v251 offset:33600
    s_waitcnt vmcnt(13) lgkmcnt(0)
    s_barrier
    s_add_u32 m0, s45, 139584
    s_nop 0
    buffer_load_dwordx4 v2, s[48:51], s43 offen lds
    buffer_load_dwordx4 v2, s[48:51], s43 offen offset:1024 lds
    s_add_u32 s43, s43, 8192
    s_add_u32 m0, s13, 61600
    s_nop 0
    buffer_load_dwordx4 v253, s[8:11], s12 offen lds
    buffer_load_dwordx4 v254, s[8:11], s12 offen offset:1024 lds
    buffer_load_dwordx4 v255, s[8:11], s12 offen offset:2048 lds
    s_add_u32 s12, s12, 88064
    s_mov_b32 s39, s55
    s_lshl_b32 s39, s39, 14
    s_lshl_b32 s40, s36, 12
    s_add_u32 s39, s39, s40
    s_lshl_b32 s40, s37, 17
    s_add_u32 s39, s39, s40
    s_mov_b32 s40, s41
    s_lshl_b32 s40, s40, 7
    s_add_u32 s39, s39, s40
    s_add_u32 s39, s39, 1048576
    s_lshl_b32 s40, s36, 11
    s_add_u32 m0, s40, 73920
    s_add_u32 s40, s39, 2048
    buffer_load_dwordx4 v7, s[48:51], s39 offen lds
    s_add_u32 m0, m0, 1024
    s_nop 0
    buffer_load_dwordx4 v7, s[48:51], s40 offen lds
    s_add_u32 s40, s23, 3072
    s_sub_u32 s39, s40, 43008
    s_cselect_b32 s40, s40, s39
    s_lshl_b32 s40, s40, 5
    s_add_u32 m0, s16, 82112
    s_add_u32 s39, s47, s40
    buffer_load_dwordx4 v3, s[4:7], s39 offen lds
    s_waitcnt vmcnt(16) lgkmcnt(0)
    s_barrier
    s_add_u32 m0, s45, 147776
    s_nop 0
    buffer_load_dwordx4 v2, s[48:51], s43 offen lds
    buffer_load_dwordx4 v2, s[48:51], s43 offen offset:1024 lds
    s_add_u32 s43, s43, 8192
    s_cmp_eq_u32 s35, 4
    s_cselect_b32 s3, 131072, 0
    s_sub_u32 s43, s43, s3
    s_add_u32 s40, s23, 4096
    s_sub_u32 s39, s40, 43008
    s_cselect_b32 s40, s40, s39
    s_lshl_b32 s40, s40, 5
    s_add_u32 m0, s16, 155968
    s_add_u32 s39, s47, s40
    buffer_load_dwordx4 v3, s[4:7], s39 offen lds
    s_add_u32 s40, s23, 6144
    s_sub_u32 s39, s40, 43008
    s_cselect_b32 s40, s40, s39
    s_lshl_b32 s40, s40, 5
    s_add_u32 m0, s16, 86240
    s_add_u32 s39, s47, s40
    buffer_load_dwordx4 v3, s[4:7], s39 offen lds
    s_add_u32 s40, s23, 7168
    s_sub_u32 s39, s40, 43008
    s_cselect_b32 s40, s40, s39
    s_lshl_b32 s40, s40, 5
    s_add_u32 m0, s16, 90336
    s_add_u32 s39, s47, s40
    buffer_load_dwordx4 v3, s[4:7], s39 offen lds
    s_waitcnt vmcnt(16) lgkmcnt(0)
    s_barrier
    s_add_u32 m0, s45, 123200
    s_nop 0
    buffer_load_dwordx4 v2, s[48:51], s43 offen lds
    buffer_load_dwordx4 v2, s[48:51], s43 offen offset:1024 lds
    s_add_u32 s43, s43, 8192
    s_add_u32 s40, s23, 9216
    s_sub_u32 s39, s40, 43008
    s_cselect_b32 s40, s40, s39
    s_lshl_b32 s40, s40, 5
    s_add_u32 m0, s16, 94432
    s_add_u32 s39, s47, s40
    buffer_load_dwordx4 v3, s[4:7], s39 offen lds
    s_add_u32 s40, s23, 10240
    s_sub_u32 s39, s40, 43008
    s_cselect_b32 s40, s40, s39
    s_lshl_b32 s40, s40, 5
    s_add_u32 m0, s16, 98560
    s_add_u32 s39, s47, s40
    buffer_load_dwordx4 v3, s[4:7], s39 offen lds
    s_add_u32 s40, s23, 12288
    s_sub_u32 s39, s40, 43008
    s_cselect_b32 s40, s40, s39
    s_lshl_b32 s40, s40, 5
    s_add_u32 m0, s16, 102656
    s_add_u32 s39, s47, s40
    buffer_load_dwordx4 v3, s[4:7], s39 offen lds
    s_waitcnt vmcnt(16) lgkmcnt(0)
    s_barrier
    s_add_u32 m0, s45, 131392
    s_nop 0
    buffer_load_dwordx4 v2, s[48:51], s43 offen lds
    buffer_load_dwordx4 v2, s[48:51], s43 offen offset:1024 lds
    s_add_u32 s43, s43, 8192
    s_add_u32 s40, s23, 13312
    s_sub_u32 s39, s40, 43008
    s_cselect_b32 s40, s40, s39
    s_lshl_b32 s40, s40, 5
    s_add_u32 m0, s16, 106752
    s_add_u32 s39, s47, s40
    buffer_load_dwordx4 v3, s[4:7], s39 offen lds
    s_add_u32 s40, s23, 15360
    s_sub_u32 s39, s40, 43008
    s_cselect_b32 s40, s40, s39
    s_lshl_b32 s40, s40, 5
    s_add_u32 m0, s16, 110880
    s_add_u32 s39, s47, s40
    buffer_load_dwordx4 v3, s[4:7], s39 offen lds
    s_add_u32 s40, s23, 16384
    s_sub_u32 s39, s40, 43008
    s_cselect_b32 s40, s40, s39
    s_lshl_b32 s40, s40, 5
    s_add_u32 m0, s16, 114976
    s_add_u32 s39, s47, s40
    buffer_load_dwordx4 v3, s[4:7], s39 offen lds
    s_waitcnt vmcnt(13) lgkmcnt(0)
    s_barrier
    s_add_u32 m0, s45, 139584
    s_nop 0
    buffer_load_dwordx4 v2, s[48:51], s43 offen lds
    buffer_load_dwordx4 v2, s[48:51], s43 offen offset:1024 lds
    s_add_u32 s43, s43, 8192
    s_add_u32 s40, s23, 18432
    s_sub_u32 s39, s40, 43008
    s_cselect_b32 s40, s40, s39
    s_lshl_b32 s40, s40, 5
    s_add_u32 m0, s16, 119072
    s_add_u32 s39, s47, s40
    buffer_load_dwordx4 v3, s[4:7], s39 offen lds
    ds_read_b64_tr_b16 v[196:197], v15 offset:0
    ds_read_b64_tr_b16 v[198:199], v15 offset:2048
    ds_read_b64_tr_b16 v[200:201], v15 offset:4096
    ds_read_b64_tr_b16 v[202:203], v15 offset:6144
    s_waitcnt lgkmcnt(0)
    v_lshlrev_b32 v20, 16, v196
    v_and_b32 v21, 0xffff0000, v196
    v_lshlrev_b32 v22, 16, v197
    v_and_b32 v23, 0xffff0000, v197
    v_lshlrev_b32 v24, 16, v198
    v_and_b32 v25, 0xffff0000, v198
    v_lshlrev_b32 v26, 16, v199
    v_and_b32 v27, 0xffff0000, v199
    v_lshlrev_b32 v28, 16, v200
    v_and_b32 v29, 0xffff0000, v200
    v_lshlrev_b32 v30, 16, v201
    v_and_b32 v31, 0xffff0000, v201
    v_lshlrev_b32 v32, 16, v202
    v_and_b32 v33, 0xffff0000, v202
    v_lshlrev_b32 v34, 16, v203
    v_and_b32 v35, 0xffff0000, v203
    s_add_u32 s40, s23, 19456
    s_sub_u32 s39, s40, 43008
    s_cselect_b32 s40, s40, s39
    s_lshl_b32 s40, s40, 5
    s_add_u32 m0, s16, 0
    s_add_u32 s39, s47, s40
    buffer_load_dwordx4 v3, s[4:7], s39 offen lds
    ds_read_b64_tr_b16 v[68:69], v244 offset:20672
    ds_read_b64_tr_b16 v[70:71], v244 offset:21184
    ds_read_b64_tr_b16 v[72:73], v245 offset:20672
    ds_read_b64_tr_b16 v[74:75], v245 offset:21184
    ds_read_b64_tr_b16 v[76:77], v246 offset:20672
    ds_read_b64_tr_b16 v[78:79], v246 offset:21184
    ds_read_b64_tr_b16 v[80:81], v247 offset:20672
    ds_read_b64_tr_b16 v[82:83], v247 offset:21184
    s_add_u32 s40, s23, 21504
    s_sub_u32 s39, s40, 43008
    s_cselect_b32 s40, s40, s39
    s_lshl_b32 s40, s40, 5
    s_add_u32 m0, s16, 4096
    s_add_u32 s39, s47, s40
    buffer_load_dwordx4 v3, s[4:7], s39 offen lds
    s_waitcnt vmcnt(13) lgkmcnt(0)
    s_barrier
    s_add_u32 m0, s45, 147776
    s_nop 0
    buffer_load_dwordx4 v2, s[48:51], s43 offen lds
    buffer_load_dwordx4 v2, s[48:51], s43 offen offset:1024 lds
    s_add_u32 s43, s43, 8192
    s_add_u32 s40, s23, 22528
    s_sub_u32 s39, s40, 43008
    s_cselect_b32 s40, s40, s39
    s_lshl_b32 s40, s40, 5
    s_add_u32 m0, s16, 8192
    s_add_u32 s39, s47, s40
    buffer_load_dwordx4 v3, s[4:7], s39 offen lds
    ds_read_b64_tr_b16 v[84:85], v248 offset:33088
    ds_read_b64_tr_b16 v[86:87], v248 offset:33600
    ds_read_b64_tr_b16 v[88:89], v249 offset:33088
    ds_read_b64_tr_b16 v[90:91], v249 offset:33600
    ds_read_b64_tr_b16 v[92:93], v250 offset:33088
    ds_read_b64_tr_b16 v[94:95], v250 offset:33600
    ds_read_b64_tr_b16 v[96:97], v251 offset:33088
    ds_read_b64_tr_b16 v[98:99], v251 offset:33600
    s_add_u32 s40, s23, 24576
    s_sub_u32 s39, s40, 43008
    s_cselect_b32 s40, s40, s39
    s_lshl_b32 s40, s40, 5
    s_add_u32 m0, s16, 12320
    s_add_u32 s39, s47, s40
    buffer_load_dwordx4 v3, s[4:7], s39 offen lds
    ds_read_b64_tr_b16 v[100:101], v244 offset:24800
    ds_read_b64_tr_b16 v[102:103], v244 offset:25312
    ds_read_b64_tr_b16 v[104:105], v245 offset:24800
    ds_read_b64_tr_b16 v[106:107], v245 offset:25312
    ds_read_b64_tr_b16 v[108:109], v246 offset:24800
    ds_read_b64_tr_b16 v[110:111], v246 offset:25312
    ds_read_b64_tr_b16 v[112:113], v247 offset:24800
    ds_read_b64_tr_b16 v[114:115], v247 offset:25312
    s_add_u32 s40, s23, 25600
    s_sub_u32 s39, s40, 43008
    s_cselect_b32 s40, s40, s39
    s_lshl_b32 s40, s40, 5
    s_add_u32 m0, s16, 16416
    s_add_u32 s39, s47, s40
    buffer_load_dwordx4 v3, s[4:7], s39 offen lds
    ds_read_b64_tr_b16 v[116:117], v244 offset:28896
    ds_read_b64_tr_b16 v[118:119], v244 offset:29408
    ds_read_b64_tr_b16 v[120:121], v245 offset:28896
    ds_read_b64_tr_b16 v[122:123], v245 offset:29408
    ds_read_b64_tr_b16 v[124:125], v246 offset:28896
    ds_read_b64_tr_b16 v[126:127], v246 offset:29408
    ds_read_b64_tr_b16 v[128:129], v247 offset:28896
    ds_read_b64_tr_b16 v[130:131], v247 offset:29408
    s_waitcnt vmcnt(13) lgkmcnt(0)
    s_barrier
    s_add_u32 s40, s23, 27648
    s_sub_u32 s39, s40, 43008
    s_cselect_b32 s40, s40, s39
    s_lshl_b32 s40, s40, 5
    s_add_u32 m0, s16, 20512
    s_add_u32 s39, s47, s40
    buffer_load_dwordx4 v3, s[4:7], s39 offen lds
    ds_read_b64_tr_b16 v[132:133], v244 offset:32992
    ds_read_b64_tr_b16 v[134:135], v244 offset:33504
    ds_read_b64_tr_b16 v[136:137], v245 offset:32992
    ds_read_b64_tr_b16 v[138:139], v245 offset:33504
    ds_read_b64_tr_b16 v[140:141], v246 offset:32992
    ds_read_b64_tr_b16 v[142:143], v246 offset:33504
    ds_read_b64_tr_b16 v[144:145], v247 offset:32992
    ds_read_b64_tr_b16 v[146:147], v247 offset:33504
    s_add_u32 s40, s23, 28672
    s_sub_u32 s39, s40, 43008
    s_cselect_b32 s40, s40, s39
    s_lshl_b32 s40, s40, 5
    s_add_u32 m0, s16, 73920
    s_add_u32 s39, s47, s40
    buffer_load_dwordx4 v3, s[4:7], s39 offen lds
    ds_read_b64_tr_b16 v[148:149], v244 offset:37120
    ds_read_b64_tr_b16 v[150:151], v244 offset:37632
    ds_read_b64_tr_b16 v[152:153], v245 offset:37120
    ds_read_b64_tr_b16 v[154:155], v245 offset:37632
    ds_read_b64_tr_b16 v[156:157], v246 offset:37120
    ds_read_b64_tr_b16 v[158:159], v246 offset:37632
    ds_read_b64_tr_b16 v[160:161], v247 offset:37120
    ds_read_b64_tr_b16 v[162:163], v247 offset:37632
    s_add_u32 s40, s23, 30720
    s_sub_u32 s39, s40, 43008
    s_cselect_b32 s40, s40, s39
    s_lshl_b32 s40, s40, 5
    s_add_u32 m0, s16, 78016
    s_add_u32 s39, s47, s40
    buffer_load_dwordx4 v3, s[4:7], s39 offen lds
    ds_read_b64_tr_b16 v[164:165], v244 offset:41216
    ds_read_b64_tr_b16 v[166:167], v244 offset:41728
    ds_read_b64_tr_b16 v[168:169], v245 offset:41216
    ds_read_b64_tr_b16 v[170:171], v245 offset:41728
    ds_read_b64_tr_b16 v[172:173], v246 offset:41216
    ds_read_b64_tr_b16 v[174:175], v246 offset:41728
    ds_read_b64_tr_b16 v[176:177], v247 offset:41216
    ds_read_b64_tr_b16 v[178:179], v247 offset:41728
    s_add_u32 s40, s23, 31744
    s_sub_u32 s39, s40, 43008
    s_cselect_b32 s40, s40, s39
    s_lshl_b32 s40, s40, 5
    s_add_u32 m0, s16, 82112
    s_add_u32 s39, s47, s40
    buffer_load_dwordx4 v3, s[4:7], s39 offen lds
    s_add_u32 s40, s23, 33792
    s_sub_u32 s39, s40, 43008
    s_cselect_b32 s40, s40, s39
    s_lshl_b32 s40, s40, 5
    s_add_u32 m0, s16, 24640
    s_add_u32 s39, s47, s40
    buffer_load_dwordx4 v3, s[4:7], s39 offen lds
    s_waitcnt vmcnt(8) lgkmcnt(0)
    s_barrier
    s_add_u32 s40, s23, 34816
    s_sub_u32 s39, s40, 43008
    s_cselect_b32 s40, s40, s39
    s_lshl_b32 s40, s40, 5
    s_add_u32 m0, s16, 28736
    s_add_u32 s39, s47, s40
    buffer_load_dwordx4 v3, s[4:7], s39 offen lds
    ds_read_b64_tr_b16 v[180:181], v244 offset:45312
    ds_read_b64_tr_b16 v[182:183], v244 offset:45824
    ds_read_b64_tr_b16 v[184:185], v245 offset:45312
    ds_read_b64_tr_b16 v[186:187], v245 offset:45824
    ds_read_b64_tr_b16 v[188:189], v246 offset:45312
    ds_read_b64_tr_b16 v[190:191], v246 offset:45824
    ds_read_b64_tr_b16 v[192:193], v247 offset:45312
    ds_read_b64_tr_b16 v[194:195], v247 offset:45824
    s_add_u32 s40, s23, 36864
    s_sub_u32 s39, s40, 43008
    s_cselect_b32 s40, s40, s39
    s_lshl_b32 s40, s40, 5
    s_add_u32 m0, s16, 32832
    s_add_u32 s39, s47, s40
    buffer_load_dwordx4 v3, s[4:7], s39 offen lds
    s_add_u32 s40, s23, 37888
    s_sub_u32 s39, s40, 43008
    s_cselect_b32 s40, s40, s39
    s_lshl_b32 s40, s40, 5
    s_add_u32 m0, s16, 123200
    s_add_u32 s39, s47, s40
    buffer_load_dwordx4 v3, s[4:7], s39 offen lds
    s_add_u32 s40, s23, 39936
    s_sub_u32 s39, s40, 43008
    s_cselect_b32 s40, s40, s39
    s_lshl_b32 s40, s40, 5
    s_add_u32 m0, s16, 127296
    s_add_u32 s39, s47, s40
    buffer_load_dwordx4 v3, s[4:7], s39 offen lds
    s_add_u32 s40, s23, 40960
    s_sub_u32 s39, s40, 43008
    s_cselect_b32 s40, s40, s39
    s_lshl_b32 s40, s40, 5
    s_add_u32 m0, s16, 155968
    s_add_u32 s39, s47, s40
    buffer_load_dwordx4 v3, s[4:7], s39 offen lds
    s_branch k2_cw_1_e
k2_cw_1:
    s_sleep 1
k2_cw_1_e:
    ds_read_b32 v9, v8 offset:8
    s_waitcnt lgkmcnt(0)
    v_cmp_gt_u32 vcc, 4, v9
    s_nop 0
    s_cbranch_vccnz k2_cw_1
    s_mov_b32 s40, 43008
    s_lshl_b32 s40, s40, 5
    s_add_u32 m0, s16, 86240
    s_add_u32 s39, s47, s40
    buffer_load_dwordx4 v3, s[4:7], s39 offen lds
    s_add_u32 s40, s23, 2048
    s_sub_u32 s39, s40, 43008
    s_cselect_b32 s40, s40, s39
    s_lshl_b32 s40, s40, 5
    s_add_u32 m0, s16, 90336
    s_add_u32 s39, s47, s40
    buffer_load_dwordx4 v3, s[4:7], s39 offen lds
    s_add_u32 s40, s23, 5120
    s_sub_u32 s39, s40, 43008
    s_cselect_b32 s40, s40, s39
    s_lshl_b32 s40, s40, 5
    s_add_u32 m0, s16, 36960
    s_add_u32 s39, s47, s40
    buffer_load_dwordx4 v3, s[4:7], s39 offen lds
    s_add_u32 s40, s23, 8192
    s_sub_u32 s39, s40, 43008
    s_cselect_b32 s40, s40, s39
    s_lshl_b32 s40, s40, 5
    s_add_u32 m0, s16, 41056
    s_add_u32 s39, s47, s40
    buffer_load_dwordx4 v3, s[4:7], s39 offen lds
    s_add_u32 s40, s23, 11264
    s_sub_u32 s39, s40, 43008
    s_cselect_b32 s40, s40, s39
    s_lshl_b32 s40, s40, 5
    s_add_u32 m0, s16, 45152
    s_add_u32 s39, s47, s40
    buffer_load_dwordx4 v3, s[4:7], s39 offen lds
    s_branch k2_cw_2_e
k2_cw_2:
    s_sleep 1
k2_cw_2_e:
    ds_read_b32 v9, v8 offset:12
    s_waitcnt lgkmcnt(0)
    v_cmp_gt_u32 vcc, 4, v9
    s_nop 0
    s_cbranch_vccnz k2_cw_2
    s_add_u32 s40, s23, 14336
    s_sub_u32 s39, s40, 43008
    s_cselect_b32 s40, s40, s39
    s_lshl_b32 s40, s40, 5
    s_add_u32 m0, s16, 131392
    s_add_u32 s39, s47, s40
    buffer_load_dwordx4 v3, s[4:7], s39 offen lds
    s_add_u32 s40, s23, 17408
    s_sub_u32 s39, s40, 43008
    s_cselect_b32 s40, s40, s39
    s_lshl_b32 s40, s40, 5
    s_add_u32 m0, s16, 135488
    s_add_u32 s39, s47, s40
    buffer_load_dwordx4 v3, s[4:7], s39 offen lds
    s_add_u32 s40, s23, 20480
    s_sub_u32 s39, s40, 43008
    s_cselect_b32 s40, s40, s39
    s_lshl_b32 s40, s40, 5
    s_add_u32 m0, s16, 94432
    s_add_u32 s39, s47, s40
    buffer_load_dwordx4 v3, s[4:7], s39 offen lds
    s_add_u32 s40, s23, 23552
    s_sub_u32 s39, s40, 43008
    s_cselect_b32 s40, s40, s39
    s_lshl_b32 s40, s40, 5
    s_add_u32 m0, s16, 98560
    s_add_u32 s39, s47, s40
    buffer_load_dwordx4 v3, s[4:7], s39 offen lds
    s_add_u32 s40, s23, 26624
    s_sub_u32 s39, s40, 43008
    s_cselect_b32 s40, s40, s39
    s_lshl_b32 s40, s40, 5
    s_add_u32 m0, s16, 102656
    s_add_u32 s39, s47, s40
    buffer_load_dwordx4 v3, s[4:7], s39 offen lds
    s_add_u32 s40, s23, 29696
    s_sub_u32 s39, s40, 43008
    s_cselect_b32 s40, s40, s39
    s_lshl_b32 s40, s40, 5
    s_add_u32 m0, s16, 49280
    s_add_u32 s39, s47, s40
    buffer_load_dwordx4 v3, s[4:7], s39 offen lds
    s_add_u32 s40, s23, 32768
    s_sub_u32 s39, s40, 43008
    s_cselect_b32 s40, s40, s39
    s_lshl_b32 s40, s40, 5
    s_add_u32 m0, s16, 53376
    s_add_u32 s39, s47, s40
    buffer_load_dwordx4 v3, s[4:7], s39 offen lds
    s_add_u32 s40, s23, 35840
    s_sub_u32 s39, s40, 43008
    s_cselect_b32 s40, s40, s39
    s_lshl_b32 s40, s40, 5
    s_add_u32 m0, s16, 57472
    s_add_u32 s39, s47, s40
    buffer_load_dwordx4 v3, s[4:7], s39 offen lds
    s_add_u32 s40, s23, 38912
    s_sub_u32 s39, s40, 43008
    s_cselect_b32 s40, s40, s39
    s_lshl_b32 s40, s40, 5
    s_add_u32 m0, s16, 139584
    s_add_u32 s39, s47, s40
    buffer_load_dwordx4 v3, s[4:7], s39 offen lds
    s_add_u32 s40, s23, 41984
    s_sub_u32 s39, s40, 43008
    s_cselect_b32 s40, s40, s39
    s_lshl_b32 s40, s40, 5
    s_add_u32 m0, s16, 143680
    s_add_u32 s39, s47, s40
    buffer_load_dwordx4 v3, s[4:7], s39 offen lds
k2_p2:
    s_waitcnt vmcnt(0)
    v_mov_b32 v9, 1
    s_mov_b64 exec, 1
    ds_add_u32 v8, v9 offset:0
    s_mov_b64 exec, -1
    s_branch k2_cw_3_e
k2_cw_3:
    s_sleep 1
k2_cw_3_e:
    ds_read_b32 v9, v8 offset:0
    s_waitcnt lgkmcnt(0)
    v_cmp_gt_u32 vcc, 4, v9
    s_nop 0
    s_cbranch_vccnz k2_cw_3
    s_branch k2_cw_4_e
k2_cw_4:
    s_sleep 1
k2_cw_4_e:
    ds_read_b32 v9, v8 offset:4
    s_waitcnt lgkmcnt(0)
    v_cmp_gt_u32 vcc, 4, v9
    s_nop 0
    s_cbranch_vccnz k2_cw_4
    s_mov_b32 s17, 0
    s_add_u32 s40, s23, 0
    s_sub_u32 s39, s40, 43008
    s_cselect_b32 s40, s40, s39
    s_add_u32 s39, s46, s40
    buffer_load_dwordx4 v[212:215], v17, s[48:51], s39 offen
    s_add_u32 s40, s23, 1024
    s_sub_u32 s39, s40, 43008
    s_cselect_b32 s40, s40, s39
    s_add_u32 s39, s46, s40
    buffer_load_dwordx4 v[216:219], v17, s[48:51], s39 offen
    s_add_u32 s40, s23, 3072
    s_sub_u32 s39, s40, 43008
    s_cselect_b32 s40, s40, s39
    s_add_u32 s39, s46, s40
    buffer_load_dwordx4 v[220:223], v17, s[48:51], s39 offen
    s_add_u32 s40, s23, 4096
    s_sub_u32 s39, s40, 43008
    s_cselect_b32 s40, s40, s39
    s_add_u32 s39, s46, s40
    buffer_load_dwordx4 v[224:227], v17, s[48:51], s39 offen
    s_add_u32 s40, s23, 6144
    s_sub_u32 s39, s40, 43008
    s_cselect_b32 s40, s40, s39
    s_add_u32 s39, s46, s40
    buffer_load_dwordx4 v[228:231], v17, s[48:51], s39 offen
    s_add_u32 s40, s23, 7168
    s_sub_u32 s39, s40, 43008
    s_cselect_b32 s40, s40, s39
    s_add_u32 s39, s46, s40
    buffer_load_dwordx4 v[232:235], v17, s[48:51], s39 offen
    s_waitcnt vmcnt(5)
k2_c0:
    v_max3_u32 v10, v212, v213, v214
    v_max_u32 v10, v10, v215
    v_cmp_eq_u32 vcc, -1, v10
    s_nop 0
    s_cbranch_vccnz k2_r0
k2_o0:
    s_add_u32 s40, s23, 9216
    s_sub_u32 s39, s40, 43008
    s_cselect_b32 s40, s40, s39
    s_add_u32 s39, s46, s40
    buffer_load_dwordx4 v[236:239], v17, s[48:51], s39 offen
    v_mfma_f32_16x16x32_bf16 v[20:23], v[36:39], v[212:215], v[20:23]
    s_waitcnt lgkmcnt(7)
    ds_read_b64_tr_b16 v[196:197], v244 offset:49440
    ds_read_b64_tr_b16 v[198:199], v244 offset:49952
    v_mfma_f32_16x16x32_bf16 v[24:27], v[40:43], v[212:215], v[24:27]
    ds_read_b64_tr_b16 v[200:201], v245 offset:49440
    ds_read_b64_tr_b16 v[202:203], v245 offset:49952
    v_mfma_f32_16x16x32_bf16 v[28:31], v[44:47], v[212:215], v[28:31]
    ds_read_b64_tr_b16 v[204:205], v246 offset:49440
    ds_read_b64_tr_b16 v[206:207], v246 offset:49952
    v_mfma_f32_16x16x32_bf16 v[32:35], v[48:51], v[212:215], v[32:35]
    ds_read_b64_tr_b16 v[208:209], v247 offset:49440
    ds_read_b64_tr_b16 v[210:211], v247 offset:49952
    s_waitcnt vmcnt(5)
k2_c1:
    v_max3_u32 v10, v216, v217, v218
    v_max_u32 v10, v10, v219
    v_cmp_eq_u32 vcc, -1, v10
    s_nop 0
    s_cbranch_vccnz k2_r1
k2_o1:
    s_add_u32 s40, s23, 10240
    s_sub_u32 s39, s40, 43008
    s_cselect_b32 s40, s40, s39
    s_add_u32 s39, s46, s40
    buffer_load_dwordx4 v[212:215], v17, s[48:51], s39 offen
    v_mfma_f32_16x16x32_bf16 v[20:23], v[52:55], v[216:219], v[20:23]
    s_waitcnt lgkmcnt(7)
    ds_read_b64_tr_b16 v[36:37], v244 offset:53536
    ds_read_b64_tr_b16 v[38:39], v244 offset:54048
    v_mfma_f32_16x16x32_bf16 v[24:27], v[56:59], v[216:219], v[24:27]
    ds_read_b64_tr_b16 v[40:41], v245 offset:53536
    ds_read_b64_tr_b16 v[42:43], v245 offset:54048
    v_mfma_f32_16x16x32_bf16 v[28:31], v[60:63], v[216:219], v[28:31]
    ds_read_b64_tr_b16 v[44:45], v246 offset:53536
    ds_read_b64_tr_b16 v[46:47], v246 offset:54048
    v_mfma_f32_16x16x32_bf16 v[32:35], v[64:67], v[216:219], v[32:35]
    ds_read_b64_tr_b16 v[48:49], v247 offset:53536
    ds_read_b64_tr_b16 v[50:51], v247 offset:54048
    s_waitcnt vmcnt(5)
k2_c2:
    v_max3_u32 v10, v220, v221, v222
    v_max_u32 v10, v10, v223
    v_cmp_eq_u32 vcc, -1, v10
    s_nop 0
    s_cbranch_vccnz k2_r2
k2_o2:
    s_add_u32 s40, s23, 12288
    s_sub_u32 s39, s40, 43008
    s_cselect_b32 s40, s40, s39
    s_add_u32 s39, s46, s40
    buffer_load_dwordx4 v[216:219], v17, s[48:51], s39 offen
    v_mfma_f32_16x16x32_bf16 v[20:23], v[68:71], v[220:223], v[20:23]
    s_waitcnt lgkmcnt(7)
    ds_read_b64_tr_b16 v[52:53], v244 offset:57632
    ds_read_b64_tr_b16 v[54:55], v244 offset:58144
    v_mfma_f32_16x16x32_bf16 v[24:27], v[72:75], v[220:223], v[24:27]
    ds_read_b64_tr_b16 v[56:57], v245 offset:57632
    ds_read_b64_tr_b16 v[58:59], v245 offset:58144
    v_mfma_f32_16x16x32_bf16 v[28:31], v[76:79], v[220:223], v[28:31]
    ds_read_b64_tr_b16 v[60:61], v246 offset:57632
    ds_read_b64_tr_b16 v[62:63], v246 offset:58144
    v_mfma_f32_16x16x32_bf16 v[32:35], v[80:83], v[220:223], v[32:35]
    ds_read_b64_tr_b16 v[64:65], v247 offset:57632
    ds_read_b64_tr_b16 v[66:67], v247 offset:58144
    s_waitcnt vmcnt(5)
k2_c3:
    v_max3_u32 v10, v224, v225, v226
    v_max_u32 v10, v10, v227
    v_cmp_eq_u32 vcc, -1, v10
    s_nop 0
    s_cbranch_vccnz k2_r3
k2_o3:
    s_add_u32 s40, s23, 13312
    s_sub_u32 s39, s40, 43008
    s_cselect_b32 s40, s40, s39
    s_add_u32 s39, s46, s40
    buffer_load_dwordx4 v[220:223], v17, s[48:51], s39 offen
    v_mfma_f32_16x16x32_bf16 v[20:23], v[84:87], v[224:227], v[20:23]
    s_waitcnt lgkmcnt(7)
    ds_read_b64_tr_b16 v[68:69], v240 offset:0
    ds_read_b64_tr_b16 v[70:71], v240 offset:512
    v_mfma_f32_16x16x32_bf16 v[24:27], v[88:91], v[224:227], v[24:27]
    ds_read_b64_tr_b16 v[72:73], v241 offset:0
    ds_read_b64_tr_b16 v[74:75], v241 offset:512
    v_mfma_f32_16x16x32_bf16 v[28:31], v[92:95], v[224:227], v[28:31]
    ds_read_b64_tr_b16 v[76:77], v242 offset:0
    ds_read_b64_tr_b16 v[78:79], v242 offset:512
    v_mfma_f32_16x16x32_bf16 v[32:35], v[96:99], v[224:227], v[32:35]
    ds_read_b64_tr_b16 v[80:81], v243 offset:0
    ds_read_b64_tr_b16 v[82:83], v243 offset:512
    s_waitcnt vmcnt(5)
k2_c4:
    v_max3_u32 v10, v228, v229, v230
    v_max_u32 v10, v10, v231
    v_cmp_eq_u32 vcc, -1, v10
    s_nop 0
    s_cbranch_vccnz k2_r4
k2_o4:
    s_add_u32 s40, s23, 15360
    s_sub_u32 s39, s40, 43008
    s_cselect_b32 s40, s40, s39
    s_add_u32 s39, s46, s40
    buffer_load_dwordx4 v[224:227], v17, s[48:51], s39 offen
    v_mfma_f32_16x16x32_bf16 v[20:23], v[100:103], v[228:231], v[20:23]
    s_waitcnt lgkmcnt(7)
    ds_read_b64_tr_b16 v[84:85], v240 offset:4096
    ds_read_b64_tr_b16 v[86:87], v240 offset:4608
    v_mfma_f32_16x16x32_bf16 v[24:27], v[104:107], v[228:231], v[24:27]
    ds_read_b64_tr_b16 v[88:89], v241 offset:4096
    ds_read_b64_tr_b16 v[90:91], v241 offset:4608
    v_mfma_f32_16x16x32_bf16 v[28:31], v[108:111], v[228:231], v[28:31]
    ds_read_b64_tr_b16 v[92:93], v242 offset:4096
    ds_read_b64_tr_b16 v[94:95], v242 offset:4608
    v_mfma_f32_16x16x32_bf16 v[32:35], v[112:115], v[228:231], v[32:35]
    ds_read_b64_tr_b16 v[96:97], v243 offset:4096
    ds_read_b64_tr_b16 v[98:99], v243 offset:4608
    s_waitcnt vmcnt(5)
k2_c5:
    v_max3_u32 v10, v232, v233, v234
    v_max_u32 v10, v10, v235
    v_cmp_eq_u32 vcc, -1, v10
    s_nop 0
    s_cbranch_vccnz k2_r5
k2_o5:
    s_add_u32 s40, s23, 16384
    s_sub_u32 s39, s40, 43008
    s_cselect_b32 s40, s40, s39
    s_add_u32 s39, s46, s40
    buffer_load_dwordx4 v[228:231], v17, s[48:51], s39 offen
    v_mfma_f32_16x16x32_bf16 v[20:23], v[116:119], v[232:235], v[20:23]
    s_waitcnt lgkmcnt(7)
    ds_read_b64_tr_b16 v[100:101], v240 offset:8192
    ds_read_b64_tr_b16 v[102:103], v240 offset:8704
    v_mfma_f32_16x16x32_bf16 v[24:27], v[120:123], v[232:235], v[24:27]
    ds_read_b64_tr_b16 v[104:105], v241 offset:8192
    ds_read_b64_tr_b16 v[106:107], v241 offset:8704
    v_mfma_f32_16x16x32_bf16 v[28:31], v[124:127], v[232:235], v[28:31]
    ds_read_b64_tr_b16 v[108:109], v242 offset:8192
    ds_read_b64_tr_b16 v[110:111], v242 offset:8704
    v_mfma_f32_16x16x32_bf16 v[32:35], v[128:131], v[232:235], v[32:35]
    ds_read_b64_tr_b16 v[112:113], v243 offset:8192
    ds_read_b64_tr_b16 v[114:115], v243 offset:8704
    s_waitcnt vmcnt(5)
k2_c6:
    v_max3_u32 v10, v236, v237, v238
    v_max_u32 v10, v10, v239
    v_cmp_eq_u32 vcc, -1, v10
    s_nop 0
    s_cbranch_vccnz k2_r6
k2_o6:
    s_add_u32 s40, s23, 18432
    s_sub_u32 s39, s40, 43008
    s_cselect_b32 s40, s40, s39
    s_add_u32 s39, s46, s40
    buffer_load_dwordx4 v[232:235], v17, s[48:51], s39 offen
    v_mfma_f32_16x16x32_bf16 v[20:23], v[132:135], v[236:239], v[20:23]
    s_waitcnt lgkmcnt(7)
    ds_read_b64_tr_b16 v[116:117], v240 offset:12320
    ds_read_b64_tr_b16 v[118:119], v240 offset:12832
    v_mfma_f32_16x16x32_bf16 v[24:27], v[136:139], v[236:239], v[24:27]
    ds_read_b64_tr_b16 v[120:121], v241 offset:12320
    ds_read_b64_tr_b16 v[122:123], v241 offset:12832
    v_mfma_f32_16x16x32_bf16 v[28:31], v[140:143], v[236:239], v[28:31]
    ds_read_b64_tr_b16 v[124:125], v242 offset:12320
    ds_read_b64_tr_b16 v[126:127], v242 offset:12832
    v_mfma_f32_16x16x32_bf16 v[32:35], v[144:147], v[236:239], v[32:35]
    ds_read_b64_tr_b16 v[128:129], v243 offset:12320
    ds_read_b64_tr_b16 v[130:131], v243 offset:12832
    s_waitcnt vmcnt(5)
k2_c7:
    v_max3_u32 v10, v212, v213, v214
    v_max_u32 v10, v10, v215
    v_cmp_eq_u32 vcc, -1, v10
    s_nop 0
    s_cbranch_vccnz k2_r7
k2_o7:
    s_add_u32 s40, s23, 19456
    s_sub_u32 s39, s40, 43008
    s_cselect_b32 s40, s40, s39
    s_add_u32 s39, s46, s40
    buffer_load_dwordx4 v[236:239], v17, s[48:51], s39 offen
    v_mfma_f32_16x16x32_bf16 v[20:23], v[148:151], v[212:215], v[20:23]
    s_waitcnt lgkmcnt(7)
    ds_read_b64_tr_b16 v[132:133], v240 offset:16416
    ds_read_b64_tr_b16 v[134:135], v240 offset:16928
    v_mfma_f32_16x16x32_bf16 v[24:27], v[152:155], v[212:215], v[24:27]
    ds_read_b64_tr_b16 v[136:137], v241 offset:16416
    ds_read_b64_tr_b16 v[138:139], v241 offset:16928
    v_mfma_f32_16x16x32_bf16 v[28:31], v[156:159], v[212:215], v[28:31]
    ds_read_b64_tr_b16 v[140:141], v242 offset:16416
    ds_read_b64_tr_b16 v[142:143], v242 offset:16928
    v_mfma_f32_16x16x32_bf16 v[32:35], v[160:163], v[212:215], v[32:35]
    ds_read_b64_tr_b16 v[144:145], v243 offset:16416
    ds_read_b64_tr_b16 v[146:147], v243 offset:16928
    s_waitcnt vmcnt(5)
k2_c8:
    v_max3_u32 v10, v216, v217, v218
    v_max_u32 v10, v10, v219
    v_cmp_eq_u32 vcc, -1, v10
    s_nop 0
    s_cbranch_vccnz k2_r8
k2_o8:
    s_add_u32 s40, s23, 21504
    s_sub_u32 s39, s40, 43008
    s_cselect_b32 s40, s40, s39
    s_add_u32 s39, s46, s40
    buffer_load_dwordx4 v[212:215], v17, s[48:51], s39 offen
    v_mfma_f32_16x16x32_bf16 v[20:23], v[164:167], v[216:219], v[20:23]
    s_waitcnt lgkmcnt(7)
    ds_read_b64_tr_b16 v[148:149], v240 offset:20512
    ds_read_b64_tr_b16 v[150:151], v240 offset:21024
    v_mfma_f32_16x16x32_bf16 v[24:27], v[168:171], v[216:219], v[24:27]
    ds_read_b64_tr_b16 v[152:153], v241 offset:20512
    ds_read_b64_tr_b16 v[154:155], v241 offset:21024
    v_mfma_f32_16x16x32_bf16 v[28:31], v[172:175], v[216:219], v[28:31]
    ds_read_b64_tr_b16 v[156:157], v242 offset:20512
    ds_read_b64_tr_b16 v[158:159], v242 offset:21024
    v_mfma_f32_16x16x32_bf16 v[32:35], v[176:179], v[216:219], v[32:35]
    ds_read_b64_tr_b16 v[160:161], v243 offset:20512
    ds_read_b64_tr_b16 v[162:163], v243 offset:21024
    s_waitcnt vmcnt(5)
k2_c9:
    v_max3_u32 v10, v220, v221, v222
    v_max_u32 v10, v10, v223
    v_cmp_eq_u32 vcc, -1, v10
    s_nop 0
    s_cbranch_vccnz k2_r9
k2_o9:
    s_add_u32 s40, s23, 22528
    s_sub_u32 s39, s40, 43008
    s_cselect_b32 s40, s40, s39
    s_add_u32 s39, s46, s40
    buffer_load_dwordx4 v[216:219], v17, s[48:51], s39 offen
    v_mfma_f32_16x16x32_bf16 v[20:23], v[180:183], v[220:223], v[20:23]
    s_waitcnt lgkmcnt(7)
    ds_read_b64_tr_b16 v[164:165], v244 offset:12480
    ds_read_b64_tr_b16 v[166:167], v244 offset:12992
    v_mfma_f32_16x16x32_bf16 v[24:27], v[184:187], v[220:223], v[24:27]
    ds_read_b64_tr_b16 v[168:169], v245 offset:12480
    ds_read_b64_tr_b16 v[170:171], v245 offset:12992
    v_mfma_f32_16x16x32_bf16 v[28:31], v[188:191], v[220:223], v[28:31]
    ds_read_b64_tr_b16 v[172:173], v246 offset:12480
    ds_read_b64_tr_b16 v[174:175], v246 offset:12992
    v_mfma_f32_16x16x32_bf16 v[32:35], v[192:195], v[220:223], v[32:35]
    ds_read_b64_tr_b16 v[176:177], v247 offset:12480
    ds_read_b64_tr_b16 v[178:179], v247 offset:12992
    s_waitcnt vmcnt(5)
k2_c10:
    v_max3_u32 v10, v224, v225, v226
    v_max_u32 v10, v10, v227
    v_cmp_eq_u32 vcc, -1, v10
    s_nop 0
    s_cbranch_vccnz k2_r10
k2_o10:
    s_add_u32 s40, s23, 24576
    s_sub_u32 s39, s40, 43008
    s_cselect_b32 s40, s40, s39
    s_add_u32 s39, s46, s40
    buffer_load_dwordx4 v[220:223], v17, s[48:51], s39 offen
    v_mfma_f32_16x16x32_bf16 v[20:23], v[196:199], v[224:227], v[20:23]
    s_waitcnt lgkmcnt(7)
    ds_read_b64_tr_b16 v[180:181], v244 offset:16576
    ds_read_b64_tr_b16 v[182:183], v244 offset:17088
    v_mfma_f32_16x16x32_bf16 v[24:27], v[200:203], v[224:227], v[24:27]
    ds_read_b64_tr_b16 v[184:185], v245 offset:16576
    ds_read_b64_tr_b16 v[186:187], v245 offset:17088
    v_mfma_f32_16x16x32_bf16 v[28:31], v[204:207], v[224:227], v[28:31]
    ds_read_b64_tr_b16 v[188:189], v246 offset:16576
    ds_read_b64_tr_b16 v[190:191], v246 offset:17088
    v_mfma_f32_16x16x32_bf16 v[32:35], v[208:211], v[224:227], v[32:35]
    ds_read_b64_tr_b16 v[192:193], v247 offset:16576
    ds_read_b64_tr_b16 v[194:195], v247 offset:17088
    s_waitcnt vmcnt(5)
k2_c11:
    v_max3_u32 v10, v228, v229, v230
    v_max_u32 v10, v10, v231
    v_cmp_eq_u32 vcc, -1, v10
    s_nop 0
    s_cbranch_vccnz k2_r11
k2_o11:
    s_add_u32 s40, s23, 25600
    s_sub_u32 s39, s40, 43008
    s_cselect_b32 s40, s40, s39
    s_add_u32 s39, s46, s40
    buffer_load_dwordx4 v[224:227], v17, s[48:51], s39 offen
    v_mfma_f32_16x16x32_bf16 v[20:23], v[36:39], v[228:231], v[20:23]
    v_mfma_f32_16x16x32_bf16 v[24:27], v[40:43], v[228:231], v[24:27]
    v_mfma_f32_16x16x32_bf16 v[28:31], v[44:47], v[228:231], v[28:31]
    v_mfma_f32_16x16x32_bf16 v[32:35], v[48:51], v[228:231], v[32:35]
    s_waitcnt vmcnt(5)
k2_c12:
    v_max3_u32 v10, v232, v233, v234
    v_max_u32 v10, v10, v235
    v_cmp_eq_u32 vcc, -1, v10
    s_nop 0
    s_cbranch_vccnz k2_r12
k2_o12:
    s_add_u32 s40, s23, 27648
    s_sub_u32 s39, s40, 43008
    s_cselect_b32 s40, s40, s39
    s_add_u32 s39, s46, s40
    buffer_load_dwordx4 v[228:231], v17, s[48:51], s39 offen
    v_mfma_f32_16x16x32_bf16 v[20:23], v[52:55], v[232:235], v[20:23]
    v_mfma_f32_16x16x32_bf16 v[24:27], v[56:59], v[232:235], v[24:27]
    v_mfma_f32_16x16x32_bf16 v[28:31], v[60:63], v[232:235], v[28:31]
    v_mfma_f32_16x16x32_bf16 v[32:35], v[64:67], v[232:235], v[32:35]
    s_waitcnt vmcnt(5)
k2_c13:
    v_max3_u32 v10, v236, v237, v238
    v_max_u32 v10, v10, v239
    v_cmp_eq_u32 vcc, -1, v10
    s_nop 0
    s_cbranch_vccnz k2_r13
k2_o13:
    s_add_u32 s40, s23, 28672
    s_sub_u32 s39, s40, 43008
    s_cselect_b32 s40, s40, s39
    s_add_u32 s39, s46, s40
    buffer_load_dwordx4 v[232:235], v17, s[48:51], s39 offen
    v_mfma_f32_16x16x32_bf16 v[20:23], v[68:71], v[236:239], v[20:23]
    v_mfma_f32_16x16x32_bf16 v[24:27], v[72:75], v[236:239], v[24:27]
    v_mfma_f32_16x16x32_bf16 v[28:31], v[76:79], v[236:239], v[28:31]
    v_mfma_f32_16x16x32_bf16 v[32:35], v[80:83], v[236:239], v[32:35]
    s_waitcnt vmcnt(5)
k2_c14:
    v_max3_u32 v10, v212, v213, v214
    v_max_u32 v10, v10, v215
    v_cmp_eq_u32 vcc, -1, v10
    s_nop 0
    s_cbranch_vccnz k2_r14
k2_o14:
    s_add_u32 s40, s23, 30720
    s_sub_u32 s39, s40, 43008
    s_cselect_b32 s40, s40, s39
    s_add_u32 s39, s46, s40
    buffer_load_dwordx4 v[236:239], v17, s[48:51], s39 offen
    v_mfma_f32_16x16x32_bf16 v[20:23], v[84:87], v[212:215], v[20:23]
    v_mfma_f32_16x16x32_bf16 v[24:27], v[88:91], v[212:215], v[24:27]
    v_mfma_f32_16x16x32_bf16 v[28:31], v[92:95], v[212:215], v[28:31]
    v_mfma_f32_16x16x32_bf16 v[32:35], v[96:99], v[212:215], v[32:35]
    s_waitcnt vmcnt(5)
k2_c15:
    v_max3_u32 v10, v216, v217, v218
    v_max_u32 v10, v10, v219
    v_cmp_eq_u32 vcc, -1, v10
    s_nop 0
    s_cbranch_vccnz k2_r15
k2_o15:
    v_mfma_f32_16x16x32_bf16 v[20:23], v[100:103], v[216:219], v[20:23]
    v_mfma_f32_16x16x32_bf16 v[24:27], v[104:107], v[216:219], v[24:27]
    v_mfma_f32_16x16x32_bf16 v[28:31], v[108:111], v[216:219], v[28:31]
    v_mfma_f32_16x16x32_bf16 v[32:35], v[112:115], v[216:219], v[32:35]
    s_waitcnt vmcnt(4)
k2_c16:
    v_max3_u32 v10, v220, v221, v222
    v_max_u32 v10, v10, v223
    v_cmp_eq_u32 vcc, -1, v10
    s_nop 0
    s_cbranch_vccnz k2_r16
k2_o16:
    v_mfma_f32_16x16x32_bf16 v[20:23], v[116:119], v[220:223], v[20:23]
    v_mfma_f32_16x16x32_bf16 v[24:27], v[120:123], v[220:223], v[24:27]
    v_mfma_f32_16x16x32_bf16 v[28:31], v[124:127], v[220:223], v[28:31]
    v_mfma_f32_16x16x32_bf16 v[32:35], v[128:131], v[220:223], v[32:35]
    s_waitcnt vmcnt(3)
k2_c17:
    v_max3_u32 v10, v224, v225, v226
    v_max_u32 v10, v10, v227
    v_cmp_eq_u32 vcc, -1, v10
    s_nop 0
    s_cbranch_vccnz k2_r17
k2_o17:
    v_mfma_f32_16x16x32_bf16 v[20:23], v[132:135], v[224:227], v[20:23]
    v_mfma_f32_16x16x32_bf16 v[24:27], v[136:139], v[224:227], v[24:27]
    v_mfma_f32_16x16x32_bf16 v[28:31], v[140:143], v[224:227], v[28:31]
    v_mfma_f32_16x16x32_bf16 v[32:35], v[144:147], v[224:227], v[32:35]
    s_waitcnt vmcnt(2)
k2_c18:
    v_max3_u32 v10, v228, v229, v230
    v_max_u32 v10, v10, v231
    v_cmp_eq_u32 vcc, -1, v10
    s_nop 0
    s_cbranch_vccnz k2_r18
k2_o18:
    v_mfma_f32_16x16x32_bf16 v[20:23], v[148:151], v[228:231], v[20:23]
    v_mfma_f32_16x16x32_bf16 v[24:27], v[152:155], v[228:231], v[24:27]
    v_mfma_f32_16x16x32_bf16 v[28:31], v[156:159], v[228:231], v[28:31]
    v_mfma_f32_16x16x32_bf16 v[32:35], v[160:163], v[228:231], v[32:35]
    s_waitcnt vmcnt(1) lgkmcnt(8)
k2_c19:
    v_max3_u32 v10, v232, v233, v234
    v_max_u32 v10, v10, v235
    v_cmp_eq_u32 vcc, -1, v10
    s_nop 0
    s_cbranch_vccnz k2_r19
k2_o19:
    v_mfma_f32_16x16x32_bf16 v[20:23], v[164:167], v[232:235], v[20:23]
    v_mfma_f32_16x16x32_bf16 v[24:27], v[168:171], v[232:235], v[24:27]
    v_mfma_f32_16x16x32_bf16 v[28:31], v[172:175], v[232:235], v[28:31]
    v_mfma_f32_16x16x32_bf16 v[32:35], v[176:179], v[232:235], v[32:35]
    s_waitcnt vmcnt(0) lgkmcnt(0)
k2_c20:
    v_max3_u32 v10, v236, v237, v238
    v_max_u32 v10, v10, v239
    v_cmp_eq_u32 vcc, -1, v10
    s_nop 0
    s_cbranch_vccnz k2_r20
k2_o20:
    v_mfma_f32_16x16x32_bf16 v[20:23], v[180:183], v[236:239], v[20:23]
    v_mfma_f32_16x16x32_bf16 v[24:27], v[184:187], v[236:239], v[24:27]
    v_mfma_f32_16x16x32_bf16 v[28:31], v[188:191], v[236:239], v[28:31]
    v_mfma_f32_16x16x32_bf16 v[32:35], v[192:195], v[236:239], v[32:35]
    s_nop 6
    ds_write_b128 v19, v[28:31] offset:2048
    ds_write_b128 v19, v[32:35] offset:3072
    s_waitcnt lgkmcnt(0)
    s_barrier
    ds_read_b128 v[36:39], v19 offset:0
    ds_read_b128 v[40:43], v19 offset:1024
    s_waitcnt lgkmcnt(1)
    v_pk_add_f32 v[20:21], v[20:21], v[36:37]
    v_pk_add_f32 v[22:23], v[22:23], v[38:39]
    v_cvt_pk_bf16_f32 v44, v20, v21
    v_cvt_pk_bf16_f32 v45, v22, v23
    buffer_store_dwordx2 v[44:45], v18, s[60:63], s44 offen offset:0
    s_waitcnt lgkmcnt(0)
    v_pk_add_f32 v[24:25], v[24:25], v[40:41]
    v_pk_add_f32 v[26:27], v[26:27], v[42:43]
    v_cvt_pk_bf16_f32 v46, v24, v25
    v_cvt_pk_bf16_f32 v47, v26, v27
    buffer_store_dwordx2 v[46:47], v18, s[60:63], s44 offen offset:32
    s_endpgm
k2_lo:
    s_cmp_eq_u32 s38, 15
    s_cbranch_scc1 k2_stats_lo
    v_bfe_u32 v10, v1, 2, 2
    v_lshrrev_b32 v11, 4, v1
    v_lshl_add_u32 v12, v11, 3, v10
    v_lshlrev_b32 v12, 7, v12
    v_and_b32 v13, 3, v1
    v_lshl_add_u32 v12, v13, 3, v12
    v_lshrrev_b32 v14, 1, v10
    v_and_b32 v16, 1, v11
    v_lshl_or_b32 v14, v16, 1, v14
    v_xor_b32 v16, 0, v14
    v_lshl_add_u32 v240, v16, 5, v12
    v_add_u32 v244, 0xf000, v240
    v_add_u32 v248, 0x1e000, v240
    v_xor_b32 v16, 1, v14
    v_lshl_add_u32 v241, v16, 5, v12
    v_add_u32 v245, 0xf000, v241
    v_add_u32 v249, 0x1e000, v241
    v_xor_b32 v16, 2, v14
    v_lshl_add_u32 v242, v16, 5, v12
    v_add_u32 v246, 0xf000, v242
    v_add_u32 v250, 0x1e000, v242
    v_xor_b32 v16, 3, v14
    v_lshl_add_u32 v243, v16, 5, v12
    v_add_u32 v247, 0xf000, v243
    v_add_u32 v251, 0x1e000, v243
    v_lshlrev_b32 v17, 4, v1
    v_and_b32 v18, 15, v1
    v_lshlrev_b32 v18, 10, v18
    v_lshl_add_u32 v18, v11, 3, v18
    s_mov_b32 s39, 61600
    s_cmp_eq_u32 s36, 1
    s_cselect_b32 s39, 65696, s39
    s_cmp_eq_u32 s36, 2
    s_cselect_b32 s39, 69792, s39
    s_cmp_eq_u32 s36, 3
    s_cselect_b32 s39, 147776, s39
    v_add_u32 v19, s39, v17
    s_mov_b32 s60, s26
    s_mov_b32 s61, s27
    s_mov_b32 s62, 2097152
    s_mov_b32 s63, 0x20000
    s_lshl_b32 s39, s37, 1
    s_mov_b32 s40, s41
    s_add_u32 s39, s39, s40
    s_lshl_b32 s39, s39, 2
    s_add_u32 s39, s39, s36
    s_mul_i32 s46, s39, 44032
    s_add_u32 s46, s46, 4194304
    s_lshl_b32 s44, s39, 14
    s_mov_b32 s40, s55
    s_lshl_b32 s40, s40, 7
    s_add_u32 s44, s44, s40
    s_setprio 1
    s_and_b32 s18, s36, 1
    s_lshr_b32 s19, s36, 1
    v_bfe_u32 v11, v1, 2, 2
    v_lshrrev_b32 v12, 5, v1
    v_lshl_add_u32 v12, v12, 3, v11
    v_and_b32 v13, 3, v1
    v_bfe_u32 v14, v1, 4, 1
    v_lshlrev_b32 v15, 8, v12
    v_lshl_add_u32 v15, v14, 5, v15
    v_lshl_add_u32 v15, v13, 3, v15
    v_add_u32 v15, 123200, v15
    s_lshl_b32 s39, s18, 1
    v_xor_b32 v16, s39, v11
    v_lshl_add_u32 v2, v16, 6, v15
    v_xor_b32 v16, 1, v16
    v_lshl_add_u32 v3, v16, 6, v15
    v_mul_u32_u24 v4, 192, v12
    v_mul_u32_u24 v15, 6176, v14
    v_add_u32 v4, v4, v15
    v_and_b32 v15, 1, v1
    v_lshl_add_u32 v4, v15, 4, v4
    v_bfe_u32 v15, v1, 1, 1
    v_lshl_add_u32 v4, v15, 3, v4
    s_lshl_b32 s39, s19, 5
    v_add_u32 v6, s39, v4
    v_add_u32 v4, s39, v6
    v_add_u32 v5, 61600, v4
    v_add_u32 v7, 61600, v6
    v_and_b32 v15, 1, v11
    v_lshl_add_u32 v15, v15, 3, v13
    v_lshrrev_b32 v16, 1, v11
    v_lshl_add_u32 v15, v16, 2, v15
    v_mul_u32_u24 v16, 1376, v14
    v_add_u32 v15, v15, v16
    v_and_b32 v16, 32, v1
    v_lshrrev_b32 v12, 1, v16
    v_lshl_add_u32 v15, v15, 5, v12
    s_mul_i32 s54, s38, 6
    s_add_u32 s54, s54, s19
    s_add_u32 s52, s54, s19
    s_add_u32 s53, s52, 1
    s_add_u32 s54, s54, 4
    s_min_u32 s20, s52, 85
    s_lshl_b32 s20, s20, 9
    s_add_u32 s20, s20, 65536
    s_min_u32 s21, s53, 85
    s_lshl_b32 s21, s21, 9
    s_add_u32 s21, s21, 65536
    s_min_u32 s22, s54, 85
    s_lshl_b32 s22, s22, 9
    s_add_u32 s22, s22, 65536
    s_lshl_b32 s39, s37, 10
    s_lshl_b32 s40, s18, 9
    s_add_u32 s39, s39, s40
    s_add_u32 s39, s39, 196608
    v_and_b32 v11, 31, v1
    v_lshl_add_u32 v170, v11, 3, s39
    v_mul_u32_u24 v12, 44032, v14
    v_lshl_add_u32 v12, v16, 3, v12
    v_and_b32 v11, 15, v1
    v_lshl_add_u32 v12, v11, 4, v12
    s_lshl_b32 s39, s37, 1
    s_add_u32 s39, s39, s18
    s_mul_i32 s42, s39, 176128
    s_add_u32 s42, s42, 4194304
    v_mov_b32 v166, 0
    buffer_load_dwordx4 v[208:211], v15, s[48:51], s20 offen
    buffer_load_dwordx4 v[212:215], v15, s[48:51], s21 offen
    buffer_load_dwordx4 v[216:219], v15, s[48:51], s22 offen
    s_cmp_lg_u32 s36, 3
    s_cbranch_scc1 k2_now
    global_load_dword v167, v166, s[26:27]
k2_now:
    s_barrier
    s_barrier
    ds_read_b64_tr_b16 v[38:39], v4 offset:0
    ds_read_b64_tr_b16 v[40:41], v4 offset:768
    ds_read_b64_tr_b16 v[30:31], v2 offset:0
    ds_read_b64_tr_b16 v[32:33], v2 offset:1024
    ds_read_b64_tr_b16 v[34:35], v3 offset:0
    ds_read_b64_tr_b16 v[36:37], v3 offset:1024
    ds_read_b64_tr_b16 v[42:43], v4 offset:32
    ds_read_b64_tr_b16 v[44:45], v4 offset:800
    ds_read_b64_tr_b16 v[46:47], v6 offset:128
    ds_read_b64_tr_b16 v[48:49], v6 offset:896
    s_waitcnt lgkmcnt(6)
    v_mfma_f32_32x32x16_bf16 v[70:85], v[38:41], v[30:33], 0
    ds_read_b64_tr_b16 v[58:59], v4 offset:3072
    ds_read_b64_tr_b16 v[60:61], v4 offset:3840
    s_waitcnt lgkmcnt(6)
    v_mfma_f32_32x32x16_bf16 v[86:101], v[38:41], v[34:37], 0
    ds_read_b64_tr_b16 v[50:51], v2 offset:4096
    ds_read_b64_tr_b16 v[52:53], v2 offset:5120
    s_waitcnt lgkmcnt(6)
    v_mfma_f32_32x32x16_bf16 v[102:117], v[42:45], v[30:33], 0
    ds_read_b64_tr_b16 v[54:55], v3 offset:4096
    ds_read_b64_tr_b16 v[56:57], v3 offset:5120
    v_mfma_f32_32x32x16_bf16 v[118:133], v[42:45], v[34:37], 0
    ds_read_b64_tr_b16 v[62:63], v4 offset:3104
    ds_read_b64_tr_b16 v[64:65], v4 offset:3872
    s_waitcnt lgkmcnt(8)
    v_mfma_f32_32x32x16_bf16 v[134:149], v[46:49], v[30:33], 0
    ds_read_b64_tr_b16 v[66:67], v6 offset:3200
    ds_read_b64_tr_b16 v[68:69], v6 offset:3968
    v_mfma_f32_32x32x16_bf16 v[150:165], v[46:49], v[34:37], 0
    s_waitcnt lgkmcnt(0)
    s_barrier
    v_mfma_f32_32x32x16_bf16 v[70:85], v[58:61], v[50:53], v[70:85]
    ds_read_b64_tr_b16 v[38:39], v4 offset:12320
    ds_read_b64_tr_b16 v[40:41], v4 offset:13088
    v_mfma_f32_32x32x16_bf16 v[86:101], v[58:61], v[54:57], v[86:101]
    ds_read_b64_tr_b16 v[30:31], v2 offset:8192
    ds_read_b64_tr_b16 v[32:33], v2 offset:9216
    v_mfma_f32_32x32x16_bf16 v[102:117], v[62:65], v[50:53], v[102:117]
    ds_read_b64_tr_b16 v[34:35], v3 offset:8192
    ds_read_b64_tr_b16 v[36:37], v3 offset:9216
    v_mfma_f32_32x32x16_bf16 v[118:133], v[62:65], v[54:57], v[118:133]
    ds_read_b64_tr_b16 v[42:43], v4 offset:12352
    ds_read_b64_tr_b16 v[44:45], v4 offset:13120
    v_mfma_f32_32x32x16_bf16 v[134:149], v[66:69], v[50:53], v[134:149]
    ds_read_b64_tr_b16 v[46:47], v6 offset:12448
    ds_read_b64_tr_b16 v[48:49], v6 offset:13216
    v_mfma_f32_32x32x16_bf16 v[150:165], v[66:69], v[54:57], v[150:165]
    s_waitcnt lgkmcnt(6)
    v_mfma_f32_32x32x16_bf16 v[70:85], v[38:41], v[30:33], v[70:85]
    ds_read_b64_tr_b16 v[58:59], v4 offset:15392
    ds_read_b64_tr_b16 v[60:61], v4 offset:16160
    s_waitcnt lgkmcnt(6)
    v_mfma_f32_32x32x16_bf16 v[86:101], v[38:41], v[34:37], v[86:101]
    ds_read_b64_tr_b16 v[50:51], v2 offset:12288
    ds_read_b64_tr_b16 v[52:53], v2 offset:13312
    s_waitcnt lgkmcnt(6)
    v_mfma_f32_32x32x16_bf16 v[102:117], v[42:45], v[30:33], v[102:117]
    ds_read_b64_tr_b16 v[54:55], v3 offset:12288
    ds_read_b64_tr_b16 v[56:57], v3 offset:13312
    v_mfma_f32_32x32x16_bf16 v[118:133], v[42:45], v[34:37], v[118:133]
    ds_read_b64_tr_b16 v[62:63], v4 offset:15424
    ds_read_b64_tr_b16 v[64:65], v4 offset:16192
    s_waitcnt lgkmcnt(8)
    v_mfma_f32_32x32x16_bf16 v[134:149], v[46:49], v[30:33], v[134:149]
    ds_read_b64_tr_b16 v[66:67], v6 offset:15520
    ds_read_b64_tr_b16 v[68:69], v6 offset:16288
    v_mfma_f32_32x32x16_bf16 v[150:165], v[46:49], v[34:37], v[150:165]
    s_waitcnt lgkmcnt(0)
    s_barrier
    v_mfma_f32_32x32x16_bf16 v[70:85], v[58:61], v[50:53], v[70:85]
    ds_read_b64_tr_b16 v[38:39], v4 offset:24640
    ds_read_b64_tr_b16 v[40:41], v4 offset:25408
    v_mfma_f32_32x32x16_bf16 v[86:101], v[58:61], v[54:57], v[86:101]
    ds_read_b64_tr_b16 v[30:31], v2 offset:16384
    ds_read_b64_tr_b16 v[32:33], v2 offset:17408
    v_mfma_f32_32x32x16_bf16 v[102:117], v[62:65], v[50:53], v[102:117]
    ds_read_b64_tr_b16 v[34:35], v3 offset:16384
    ds_read_b64_tr_b16 v[36:37], v3 offset:17408
    v_mfma_f32_32x32x16_bf16 v[118:133], v[62:65], v[54:57], v[118:133]
    ds_read_b64_tr_b16 v[42:43], v4 offset:24672
    ds_read_b64_tr_b16 v[44:45], v4 offset:25440
    v_mfma_f32_32x32x16_bf16 v[134:149], v[66:69], v[50:53], v[134:149]
    ds_read_b64_tr_b16 v[46:47], v6 offset:24768
    ds_read_b64_tr_b16 v[48:49], v6 offset:25536
    v_mfma_f32_32x32x16_bf16 v[150:165], v[66:69], v[54:57], v[150:165]
    s_waitcnt lgkmcnt(6)
    v_mfma_f32_32x32x16_bf16 v[70:85], v[38:41], v[30:33], v[70:85]
    ds_read_b64_tr_b16 v[58:59], v4 offset:27712
    ds_read_b64_tr_b16 v[60:61], v4 offset:28480
    s_waitcnt lgkmcnt(6)
    v_mfma_f32_32x32x16_bf16 v[86:101], v[38:41], v[34:37], v[86:101]
    ds_read_b64_tr_b16 v[50:51], v2 offset:20480
    ds_read_b64_tr_b16 v[52:53], v2 offset:21504
    s_waitcnt lgkmcnt(6)
    v_mfma_f32_32x32x16_bf16 v[102:117], v[42:45], v[30:33], v[102:117]
    ds_read_b64_tr_b16 v[54:55], v3 offset:20480
    ds_read_b64_tr_b16 v[56:57], v3 offset:21504
    v_mfma_f32_32x32x16_bf16 v[118:133], v[42:45], v[34:37], v[118:133]
    ds_read_b64_tr_b16 v[62:63], v4 offset:27744
    ds_read_b64_tr_b16 v[64:65], v4 offset:28512
    s_waitcnt lgkmcnt(8)
    v_mfma_f32_32x32x16_bf16 v[134:149], v[46:49], v[30:33], v[134:149]
    ds_read_b64_tr_b16 v[66:67], v6 offset:27840
    ds_read_b64_tr_b16 v[68:69], v6 offset:28608
    v_mfma_f32_32x32x16_bf16 v[150:165], v[46:49], v[34:37], v[150:165]
    s_waitcnt lgkmcnt(0)
    s_barrier
    v_mfma_f32_32x32x16_bf16 v[70:85], v[58:61], v[50:53], v[70:85]
    ds_read_b64_tr_b16 v[38:39], v4 offset:36960
    ds_read_b64_tr_b16 v[40:41], v4 offset:37728
    v_mfma_f32_32x32x16_bf16 v[86:101], v[58:61], v[54:57], v[86:101]
    ds_read_b64_tr_b16 v[30:31], v2 offset:24576
    ds_read_b64_tr_b16 v[32:33], v2 offset:25600
    v_mfma_f32_32x32x16_bf16 v[102:117], v[62:65], v[50:53], v[102:117]
    ds_read_b64_tr_b16 v[34:35], v3 offset:24576
    ds_read_b64_tr_b16 v[36:37], v3 offset:25600
    v_mfma_f32_32x32x16_bf16 v[118:133], v[62:65], v[54:57], v[118:133]
    ds_read_b64_tr_b16 v[42:43], v4 offset:36992
    ds_read_b64_tr_b16 v[44:45], v4 offset:37760
    v_mfma_f32_32x32x16_bf16 v[134:149], v[66:69], v[50:53], v[134:149]
    ds_read_b64_tr_b16 v[46:47], v6 offset:37088
    ds_read_b64_tr_b16 v[48:49], v6 offset:37856
    v_mfma_f32_32x32x16_bf16 v[150:165], v[66:69], v[54:57], v[150:165]
    s_waitcnt lgkmcnt(6)
    v_mfma_f32_32x32x16_bf16 v[70:85], v[38:41], v[30:33], v[70:85]
    ds_read_b64_tr_b16 v[58:59], v4 offset:40032
    ds_read_b64_tr_b16 v[60:61], v4 offset:40800
    s_waitcnt lgkmcnt(6)
    v_mfma_f32_32x32x16_bf16 v[86:101], v[38:41], v[34:37], v[86:101]
    ds_read_b64_tr_b16 v[50:51], v2 offset:28672
    ds_read_b64_tr_b16 v[52:53], v2 offset:29696
    s_waitcnt lgkmcnt(6)
    v_mfma_f32_32x32x16_bf16 v[102:117], v[42:45], v[30:33], v[102:117]
    ds_read_b64_tr_b16 v[54:55], v3 offset:28672
    ds_read_b64_tr_b16 v[56:57], v3 offset:29696
    v_mfma_f32_32x32x16_bf16 v[118:133], v[42:45], v[34:37], v[118:133]
    ds_read_b64_tr_b16 v[62:63], v4 offset:40064
    ds_read_b64_tr_b16 v[64:65], v4 offset:40832
    s_waitcnt lgkmcnt(8)
    v_mfma_f32_32x32x16_bf16 v[134:149], v[46:49], v[30:33], v[134:149]
    ds_read_b64_tr_b16 v[66:67], v6 offset:40160
    ds_read_b64_tr_b16 v[68:69], v6 offset:40928
    v_mfma_f32_32x32x16_bf16 v[150:165], v[46:49], v[34:37], v[150:165]
    s_waitcnt lgkmcnt(0)
    s_barrier
    v_mfma_f32_32x32x16_bf16 v[70:85], v[58:61], v[50:53], v[70:85]
    ds_read_b64_tr_b16 v[38:39], v4 offset:49280
    ds_read_b64_tr_b16 v[40:41], v4 offset:50048
    v_mfma_f32_32x32x16_bf16 v[86:101], v[58:61], v[54:57], v[86:101]
    ds_read_b64_tr_b16 v[30:31], v2 offset:0
    ds_read_b64_tr_b16 v[32:33], v2 offset:1024
    v_mfma_f32_32x32x16_bf16 v[102:117], v[62:65], v[50:53], v[102:117]
    ds_read_b64_tr_b16 v[34:35], v3 offset:0
    ds_read_b64_tr_b16 v[36:37], v3 offset:1024
    v_mfma_f32_32x32x16_bf16 v[118:133], v[62:65], v[54:57], v[118:133]
    ds_read_b64_tr_b16 v[42:43], v4 offset:49312
    ds_read_b64_tr_b16 v[44:45], v4 offset:50080
    v_mfma_f32_32x32x16_bf16 v[134:149], v[66:69], v[50:53], v[134:149]
    ds_read_b64_tr_b16 v[46:47], v6 offset:49408
    ds_read_b64_tr_b16 v[48:49], v6 offset:50176
    v_mfma_f32_32x32x16_bf16 v[150:165], v[66:69], v[54:57], v[150:165]
    s_waitcnt lgkmcnt(6)
    v_mfma_f32_32x32x16_bf16 v[70:85], v[38:41], v[30:33], v[70:85]
    ds_read_b64_tr_b16 v[58:59], v4 offset:52352
    ds_read_b64_tr_b16 v[60:61], v4 offset:53120
    s_waitcnt lgkmcnt(6)
    v_mfma_f32_32x32x16_bf16 v[86:101], v[38:41], v[34:37], v[86:101]
    ds_read_b64_tr_b16 v[50:51], v2 offset:4096
    ds_read_b64_tr_b16 v[52:53], v2 offset:5120
    s_waitcnt lgkmcnt(6)
    v_mfma_f32_32x32x16_bf16 v[102:117], v[42:45], v[30:33], v[102:117]
    ds_read_b64_tr_b16 v[54:55], v3 offset:4096
    ds_read_b64_tr_b16 v[56:57], v3 offset:5120
    v_mfma_f32_32x32x16_bf16 v[118:133], v[42:45], v[34:37], v[118:133]
    ds_read_b64_tr_b16 v[62:63], v4 offset:52384
    ds_read_b64_tr_b16 v[64:65], v4 offset:53152
    s_waitcnt lgkmcnt(8)
    v_mfma_f32_32x32x16_bf16 v[134:149], v[46:49], v[30:33], v[134:149]
    ds_read_b64_tr_b16 v[66:67], v6 offset:52480
    ds_read_b64_tr_b16 v[68:69], v6 offset:53248
    v_mfma_f32_32x32x16_bf16 v[150:165], v[46:49], v[34:37], v[150:165]
    s_waitcnt lgkmcnt(0)
    s_barrier
    v_mfma_f32_32x32x16_bf16 v[70:85], v[58:61], v[50:53], v[70:85]
    ds_read_b64_tr_b16 v[38:39], v5 offset:0
    ds_read_b64_tr_b16 v[40:41], v5 offset:768
    v_mfma_f32_32x32x16_bf16 v[86:101], v[58:61], v[54:57], v[86:101]
    ds_read_b64_tr_b16 v[30:31], v2 offset:8192
    ds_read_b64_tr_b16 v[32:33], v2 offset:9216
    v_mfma_f32_32x32x16_bf16 v[102:117], v[62:65], v[50:53], v[102:117]
    ds_read_b64_tr_b16 v[34:35], v3 offset:8192
    ds_read_b64_tr_b16 v[36:37], v3 offset:9216
    v_mfma_f32_32x32x16_bf16 v[118:133], v[62:65], v[54:57], v[118:133]
    ds_read_b64_tr_b16 v[42:43], v5 offset:32
    ds_read_b64_tr_b16 v[44:45], v5 offset:800
    v_mfma_f32_32x32x16_bf16 v[134:149], v[66:69], v[50:53], v[134:149]
    ds_read_b64_tr_b16 v[46:47], v7 offset:128
    ds_read_b64_tr_b16 v[48:49], v7 offset:896
    v_mfma_f32_32x32x16_bf16 v[150:165], v[66:69], v[54:57], v[150:165]
    s_waitcnt lgkmcnt(6)
    v_mfma_f32_32x32x16_bf16 v[70:85], v[38:41], v[30:33], v[70:85]
    ds_read_b64_tr_b16 v[58:59], v5 offset:3072
    ds_read_b64_tr_b16 v[60:61], v5 offset:3840
    s_waitcnt lgkmcnt(6)
    v_mfma_f32_32x32x16_bf16 v[86:101], v[38:41], v[34:37], v[86:101]
    ds_read_b64_tr_b16 v[50:51], v2 offset:12288
    ds_read_b64_tr_b16 v[52:53], v2 offset:13312
    s_waitcnt lgkmcnt(6)
    v_mfma_f32_32x32x16_bf16 v[102:117], v[42:45], v[30:33], v[102:117]
    ds_read_b64_tr_b16 v[54:55], v3 offset:12288
    ds_read_b64_tr_b16 v[56:57], v3 offset:13312
    v_mfma_f32_32x32x16_bf16 v[118:133], v[42:45], v[34:37], v[118:133]
    ds_read_b64_tr_b16 v[62:63], v5 offset:3104
    ds_read_b64_tr_b16 v[64:65], v5 offset:3872
    s_waitcnt lgkmcnt(8)
    v_mfma_f32_32x32x16_bf16 v[134:149], v[46:49], v[30:33], v[134:149]
    ds_read_b64_tr_b16 v[66:67], v7 offset:3200
    ds_read_b64_tr_b16 v[68:69], v7 offset:3968
    v_mfma_f32_32x32x16_bf16 v[150:165], v[46:49], v[34:37], v[150:165]
    s_waitcnt lgkmcnt(0)
    s_barrier
    v_mfma_f32_32x32x16_bf16 v[70:85], v[58:61], v[50:53], v[70:85]
    ds_read_b64_tr_b16 v[38:39], v5 offset:12320
    ds_read_b64_tr_b16 v[40:41], v5 offset:13088
    v_mfma_f32_32x32x16_bf16 v[86:101], v[58:61], v[54:57], v[86:101]
    ds_read_b64_tr_b16 v[30:31], v2 offset:16384
    ds_read_b64_tr_b16 v[32:33], v2 offset:17408
    v_mfma_f32_32x32x16_bf16 v[102:117], v[62:65], v[50:53], v[102:117]
    ds_read_b64_tr_b16 v[34:35], v3 offset:16384
    ds_read_b64_tr_b16 v[36:37], v3 offset:17408
    v_mfma_f32_32x32x16_bf16 v[118:133], v[62:65], v[54:57], v[118:133]
    ds_read_b64_tr_b16 v[42:43], v5 offset:12352
    ds_read_b64_tr_b16 v[44:45], v5 offset:13120
    v_mfma_f32_32x32x16_bf16 v[134:149], v[66:69], v[50:53], v[134:149]
    ds_read_b64_tr_b16 v[46:47], v7 offset:12448
    ds_read_b64_tr_b16 v[48:49], v7 offset:13216
    v_mfma_f32_32x32x16_bf16 v[150:165], v[66:69], v[54:57], v[150:165]
    s_waitcnt lgkmcnt(6)
    v_mfma_f32_32x32x16_bf16 v[70:85], v[38:41], v[30:33], v[70:85]
    ds_read_b64_tr_b16 v[58:59], v5 offset:15392
    ds_read_b64_tr_b16 v[60:61], v5 offset:16160
    s_waitcnt lgkmcnt(6)
    v_mfma_f32_32x32x16_bf16 v[86:101], v[38:41], v[34:37], v[86:101]
    ds_read_b64_tr_b16 v[50:51], v2 offset:20480
    ds_read_b64_tr_b16 v[52:53], v2 offset:21504
    s_waitcnt lgkmcnt(6)
    v_mfma_f32_32x32x16_bf16 v[102:117], v[42:45], v[30:33], v[102:117]
    ds_read_b64_tr_b16 v[54:55], v3 offset:20480
    ds_read_b64_tr_b16 v[56:57], v3 offset:21504
    v_mfma_f32_32x32x16_bf16 v[118:133], v[42:45], v[34:37], v[118:133]
    ds_read_b64_tr_b16 v[62:63], v5 offset:15424
    ds_read_b64_tr_b16 v[64:65], v5 offset:16192
    s_waitcnt lgkmcnt(8)
    v_mfma_f32_32x32x16_bf16 v[134:149], v[46:49], v[30:33], v[134:149]
    ds_read_b64_tr_b16 v[66:67], v7 offset:15520
    ds_read_b64_tr_b16 v[68:69], v7 offset:16288
    v_mfma_f32_32x32x16_bf16 v[150:165], v[46:49], v[34:37], v[150:165]
    s_waitcnt lgkmcnt(0)
    s_barrier
    v_mfma_f32_32x32x16_bf16 v[70:85], v[58:61], v[50:53], v[70:85]
    ds_read_b64_tr_b16 v[38:39], v5 offset:24640
    ds_read_b64_tr_b16 v[40:41], v5 offset:25408
    v_mfma_f32_32x32x16_bf16 v[86:101], v[58:61], v[54:57], v[86:101]
    ds_read_b64_tr_b16 v[30:31], v2 offset:24576
    ds_read_b64_tr_b16 v[32:33], v2 offset:25600
    v_mfma_f32_32x32x16_bf16 v[102:117], v[62:65], v[50:53], v[102:117]
    ds_read_b64_tr_b16 v[34:35], v3 offset:24576
    ds_read_b64_tr_b16 v[36:37], v3 offset:25600
    v_mfma_f32_32x32x16_bf16 v[118:133], v[62:65], v[54:57], v[118:133]
    ds_read_b64_tr_b16 v[42:43], v5 offset:24672
    ds_read_b64_tr_b16 v[44:45], v5 offset:25440
    v_mfma_f32_32x32x16_bf16 v[134:149], v[66:69], v[50:53], v[134:149]
    ds_read_b64_tr_b16 v[46:47], v7 offset:24768
    ds_read_b64_tr_b16 v[48:49], v7 offset:25536
    v_mfma_f32_32x32x16_bf16 v[150:165], v[66:69], v[54:57], v[150:165]
    s_waitcnt lgkmcnt(6)
    v_mfma_f32_32x32x16_bf16 v[70:85], v[38:41], v[30:33], v[70:85]
    ds_read_b64_tr_b16 v[58:59], v5 offset:27712
    ds_read_b64_tr_b16 v[60:61], v5 offset:28480
    s_waitcnt lgkmcnt(6)
    v_mfma_f32_32x32x16_bf16 v[86:101], v[38:41], v[34:37], v[86:101]
    ds_read_b64_tr_b16 v[50:51], v2 offset:28672
    ds_read_b64_tr_b16 v[52:53], v2 offset:29696
    s_waitcnt lgkmcnt(6)
    v_mfma_f32_32x32x16_bf16 v[102:117], v[42:45], v[30:33], v[102:117]
    ds_read_b64_tr_b16 v[54:55], v3 offset:28672
    ds_read_b64_tr_b16 v[56:57], v3 offset:29696
    v_mfma_f32_32x32x16_bf16 v[118:133], v[42:45], v[34:37], v[118:133]
    ds_read_b64_tr_b16 v[62:63], v5 offset:27744
    ds_read_b64_tr_b16 v[64:65], v5 offset:28512
    s_waitcnt lgkmcnt(8)
    v_mfma_f32_32x32x16_bf16 v[134:149], v[46:49], v[30:33], v[134:149]
    ds_read_b64_tr_b16 v[66:67], v7 offset:27840
    ds_read_b64_tr_b16 v[68:69], v7 offset:28608
    v_mfma_f32_32x32x16_bf16 v[150:165], v[46:49], v[34:37], v[150:165]
    s_waitcnt lgkmcnt(0)
    s_barrier
    v_mfma_f32_32x32x16_bf16 v[70:85], v[58:61], v[50:53], v[70:85]
    ds_read_b64_tr_b16 v[38:39], v5 offset:36960
    ds_read_b64_tr_b16 v[40:41], v5 offset:37728
    v_mfma_f32_32x32x16_bf16 v[86:101], v[58:61], v[54:57], v[86:101]
    ds_read_b64_tr_b16 v[30:31], v2 offset:0
    ds_read_b64_tr_b16 v[32:33], v2 offset:1024
    v_mfma_f32_32x32x16_bf16 v[102:117], v[62:65], v[50:53], v[102:117]
    ds_read_b64_tr_b16 v[34:35], v3 offset:0
    ds_read_b64_tr_b16 v[36:37], v3 offset:1024
    v_mfma_f32_32x32x16_bf16 v[118:133], v[62:65], v[54:57], v[118:133]
    ds_read_b64_tr_b16 v[42:43], v5 offset:36992
    ds_read_b64_tr_b16 v[44:45], v5 offset:37760
    v_mfma_f32_32x32x16_bf16 v[134:149], v[66:69], v[50:53], v[134:149]
    ds_read_b64_tr_b16 v[46:47], v7 offset:37088
    ds_read_b64_tr_b16 v[48:49], v7 offset:37856
    v_mfma_f32_32x32x16_bf16 v[150:165], v[66:69], v[54:57], v[150:165]
    s_waitcnt lgkmcnt(6)
    v_mfma_f32_32x32x16_bf16 v[70:85], v[38:41], v[30:33], v[70:85]
    ds_read_b64_tr_b16 v[58:59], v5 offset:40032
    ds_read_b64_tr_b16 v[60:61], v5 offset:40800
    s_waitcnt lgkmcnt(6)
    v_mfma_f32_32x32x16_bf16 v[86:101], v[38:41], v[34:37], v[86:101]
    ds_read_b64_tr_b16 v[50:51], v2 offset:4096
    ds_read_b64_tr_b16 v[52:53], v2 offset:5120
    s_waitcnt lgkmcnt(6)
    v_mfma_f32_32x32x16_bf16 v[102:117], v[42:45], v[30:33], v[102:117]
    ds_read_b64_tr_b16 v[54:55], v3 offset:4096
    ds_read_b64_tr_b16 v[56:57], v3 offset:5120
    v_mfma_f32_32x32x16_bf16 v[118:133], v[42:45], v[34:37], v[118:133]
    ds_read_b64_tr_b16 v[62:63], v5 offset:40064
    ds_read_b64_tr_b16 v[64:65], v5 offset:40832
    s_waitcnt lgkmcnt(8)
    v_mfma_f32_32x32x16_bf16 v[134:149], v[46:49], v[30:33], v[134:149]
    ds_read_b64_tr_b16 v[66:67], v7 offset:40160
    ds_read_b64_tr_b16 v[68:69], v7 offset:40928
    v_mfma_f32_32x32x16_bf16 v[150:165], v[46:49], v[34:37], v[150:165]
    s_waitcnt lgkmcnt(0)
    s_barrier
    v_mfma_f32_32x32x16_bf16 v[70:85], v[58:61], v[50:53], v[70:85]
    ds_read_b64_tr_b16 v[38:39], v5 offset:49280
    ds_read_b64_tr_b16 v[40:41], v5 offset:50048
    v_mfma_f32_32x32x16_bf16 v[86:101], v[58:61], v[54:57], v[86:101]
    ds_read_b64_tr_b16 v[30:31], v2 offset:8192
    ds_read_b64_tr_b16 v[32:33], v2 offset:9216
    v_mfma_f32_32x32x16_bf16 v[102:117], v[62:65], v[50:53], v[102:117]
    ds_read_b64_tr_b16 v[34:35], v3 offset:8192
    ds_read_b64_tr_b16 v[36:37], v3 offset:9216
    v_mfma_f32_32x32x16_bf16 v[118:133], v[62:65], v[54:57], v[118:133]
    ds_read_b64_tr_b16 v[42:43], v5 offset:49312
    ds_read_b64_tr_b16 v[44:45], v5 offset:50080
    v_mfma_f32_32x32x16_bf16 v[134:149], v[66:69], v[50:53], v[134:149]
    ds_read_b64_tr_b16 v[46:47], v7 offset:49408
    ds_read_b64_tr_b16 v[48:49], v7 offset:50176
    v_mfma_f32_32x32x16_bf16 v[150:165], v[66:69], v[54:57], v[150:165]
    s_waitcnt lgkmcnt(6)
    v_mfma_f32_32x32x16_bf16 v[70:85], v[38:41], v[30:33], v[70:85]
    ds_read_b64_tr_b16 v[58:59], v5 offset:52352
    ds_read_b64_tr_b16 v[60:61], v5 offset:53120
    s_waitcnt lgkmcnt(6)
    v_mfma_f32_32x32x16_bf16 v[86:101], v[38:41], v[34:37], v[86:101]
    ds_read_b64_tr_b16 v[50:51], v2 offset:12288
    ds_read_b64_tr_b16 v[52:53], v2 offset:13312
    s_waitcnt lgkmcnt(6)
    v_mfma_f32_32x32x16_bf16 v[102:117], v[42:45], v[30:33], v[102:117]
    ds_read_b64_tr_b16 v[54:55], v3 offset:12288
    ds_read_b64_tr_b16 v[56:57], v3 offset:13312
    v_mfma_f32_32x32x16_bf16 v[118:133], v[42:45], v[34:37], v[118:133]
    ds_read_b64_tr_b16 v[62:63], v5 offset:52384
    ds_read_b64_tr_b16 v[64:65], v5 offset:53152
    s_waitcnt lgkmcnt(8)
    v_mfma_f32_32x32x16_bf16 v[134:149], v[46:49], v[30:33], v[134:149]
    ds_read_b64_tr_b16 v[66:67], v7 offset:52480
    ds_read_b64_tr_b16 v[68:69], v7 offset:53248
    v_mfma_f32_32x32x16_bf16 v[150:165], v[46:49], v[34:37], v[150:165]
    s_waitcnt lgkmcnt(0)
    s_barrier
    v_mfma_f32_32x32x16_bf16 v[70:85], v[58:61], v[50:53], v[70:85]
    ds_read_b64_tr_b16 v[38:39], v4 offset:0
    ds_read_b64_tr_b16 v[40:41], v4 offset:768
    v_mfma_f32_32x32x16_bf16 v[86:101], v[58:61], v[54:57], v[86:101]
    ds_read_b64_tr_b16 v[30:31], v2 offset:16384
    ds_read_b64_tr_b16 v[32:33], v2 offset:17408
    v_mfma_f32_32x32x16_bf16 v[102:117], v[62:65], v[50:53], v[102:117]
    ds_read_b64_tr_b16 v[34:35], v3 offset:16384
    ds_read_b64_tr_b16 v[36:37], v3 offset:17408
    v_mfma_f32_32x32x16_bf16 v[118:133], v[62:65], v[54:57], v[118:133]
    ds_read_b64_tr_b16 v[42:43], v4 offset:32
    ds_read_b64_tr_b16 v[44:45], v4 offset:800
    v_mfma_f32_32x32x16_bf16 v[134:149], v[66:69], v[50:53], v[134:149]
    ds_read_b64_tr_b16 v[46:47], v6 offset:128
    ds_read_b64_tr_b16 v[48:49], v6 offset:896
    v_mfma_f32_32x32x16_bf16 v[150:165], v[66:69], v[54:57], v[150:165]
    s_waitcnt lgkmcnt(6)
    v_mfma_f32_32x32x16_bf16 v[70:85], v[38:41], v[30:33], v[70:85]
    ds_read_b64_tr_b16 v[58:59], v4 offset:3072
    ds_read_b64_tr_b16 v[60:61], v4 offset:3840
    s_waitcnt lgkmcnt(6)
    v_mfma_f32_32x32x16_bf16 v[86:101], v[38:41], v[34:37], v[86:101]
    ds_read_b64_tr_b16 v[50:51], v2 offset:20480
    ds_read_b64_tr_b16 v[52:53], v2 offset:21504
    s_waitcnt lgkmcnt(6)
    v_mfma_f32_32x32x16_bf16 v[102:117], v[42:45], v[30:33], v[102:117]
    ds_read_b64_tr_b16 v[54:55], v3 offset:20480
    ds_read_b64_tr_b16 v[56:57], v3 offset:21504
    v_mfma_f32_32x32x16_bf16 v[118:133], v[42:45], v[34:37], v[118:133]
    ds_read_b64_tr_b16 v[62:63], v4 offset:3104
    ds_read_b64_tr_b16 v[64:65], v4 offset:3872
    s_waitcnt lgkmcnt(8)
    v_mfma_f32_32x32x16_bf16 v[134:149], v[46:49], v[30:33], v[134:149]
    ds_read_b64_tr_b16 v[66:67], v6 offset:3200
    ds_read_b64_tr_b16 v[68:69], v6 offset:3968
    v_mfma_f32_32x32x16_bf16 v[150:165], v[46:49], v[34:37], v[150:165]
    s_waitcnt lgkmcnt(0)
    s_barrier
    v_mfma_f32_32x32x16_bf16 v[70:85], v[58:61], v[50:53], v[70:85]
    ds_read_b64_tr_b16 v[38:39], v4 offset:12320
    ds_read_b64_tr_b16 v[40:41], v4 offset:13088
    v_mfma_f32_32x32x16_bf16 v[86:101], v[58:61], v[54:57], v[86:101]
    ds_read_b64_tr_b16 v[30:31], v2 offset:24576
    ds_read_b64_tr_b16 v[32:33], v2 offset:25600
    v_mfma_f32_32x32x16_bf16 v[102:117], v[62:65], v[50:53], v[102:117]
    ds_read_b64_tr_b16 v[34:35], v3 offset:24576
    ds_read_b64_tr_b16 v[36:37], v3 offset:25600
    v_mfma_f32_32x32x16_bf16 v[118:133], v[62:65], v[54:57], v[118:133]
    ds_read_b64_tr_b16 v[42:43], v4 offset:12352
    ds_read_b64_tr_b16 v[44:45], v4 offset:13120
    v_mfma_f32_32x32x16_bf16 v[134:149], v[66:69], v[50:53], v[134:149]
    ds_read_b64_tr_b16 v[46:47], v6 offset:12448
    ds_read_b64_tr_b16 v[48:49], v6 offset:13216
    v_mfma_f32_32x32x16_bf16 v[150:165], v[66:69], v[54:57], v[150:165]
    s_waitcnt lgkmcnt(6)
    v_mfma_f32_32x32x16_bf16 v[70:85], v[38:41], v[30:33], v[70:85]
    ds_read_b64_tr_b16 v[58:59], v4 offset:15392
    ds_read_b64_tr_b16 v[60:61], v4 offset:16160
    s_waitcnt lgkmcnt(6)
    v_mfma_f32_32x32x16_bf16 v[86:101], v[38:41], v[34:37], v[86:101]
    ds_read_b64_tr_b16 v[50:51], v2 offset:28672
    ds_read_b64_tr_b16 v[52:53], v2 offset:29696
    s_waitcnt lgkmcnt(6)
    v_mfma_f32_32x32x16_bf16 v[102:117], v[42:45], v[30:33], v[102:117]
    ds_read_b64_tr_b16 v[54:55], v3 offset:28672
    ds_read_b64_tr_b16 v[56:57], v3 offset:29696
    v_mfma_f32_32x32x16_bf16 v[118:133], v[42:45], v[34:37], v[118:133]
    ds_read_b64_tr_b16 v[62:63], v4 offset:15424
    ds_read_b64_tr_b16 v[64:65], v4 offset:16192
    s_waitcnt lgkmcnt(8)
    v_mfma_f32_32x32x16_bf16 v[134:149], v[46:49], v[30:33], v[134:149]
    ds_read_b64_tr_b16 v[66:67], v6 offset:15520
    ds_read_b64_tr_b16 v[68:69], v6 offset:16288
    v_mfma_f32_32x32x16_bf16 v[150:165], v[46:49], v[34:37], v[150:165]
    s_waitcnt lgkmcnt(0)
    s_barrier
    v_mfma_f32_32x32x16_bf16 v[70:85], v[58:61], v[50:53], v[70:85]
    ds_read_b64_tr_b16 v[38:39], v4 offset:24640
    ds_read_b64_tr_b16 v[40:41], v4 offset:25408
    v_mfma_f32_32x32x16_bf16 v[86:101], v[58:61], v[54:57], v[86:101]
    ds_read_b64_tr_b16 v[30:31], v2 offset:0
    ds_read_b64_tr_b16 v[32:33], v2 offset:1024
    v_mfma_f32_32x32x16_bf16 v[102:117], v[62:65], v[50:53], v[102:117]
    ds_read_b64_tr_b16 v[34:35], v3 offset:0
    ds_read_b64_tr_b16 v[36:37], v3 offset:1024
    v_mfma_f32_32x32x16_bf16 v[118:133], v[62:65], v[54:57], v[118:133]
    ds_read_b64_tr_b16 v[42:43], v4 offset:24672
    ds_read_b64_tr_b16 v[44:45], v4 offset:25440
    v_mfma_f32_32x32x16_bf16 v[134:149], v[66:69], v[50:53], v[134:149]
    ds_read_b64_tr_b16 v[46:47], v6 offset:24768
    ds_read_b64_tr_b16 v[48:49], v6 offset:25536
    v_mfma_f32_32x32x16_bf16 v[150:165], v[66:69], v[54:57], v[150:165]
    global_load_dwordx2 v[166:167], v170, s[30:31] sc0 sc1
    global_load_dwordx2 v[168:169], v170, s[30:31] offset:256 sc0 sc1
    s_waitcnt lgkmcnt(6)
    v_mfma_f32_32x32x16_bf16 v[70:85], v[38:41], v[30:33], v[70:85]
    ds_read_b64_tr_b16 v[58:59], v4 offset:27712
    ds_read_b64_tr_b16 v[60:61], v4 offset:28480
    s_waitcnt lgkmcnt(6)
    v_mfma_f32_32x32x16_bf16 v[86:101], v[38:41], v[34:37], v[86:101]
    ds_read_b64_tr_b16 v[50:51], v2 offset:4096
    ds_read_b64_tr_b16 v[52:53], v2 offset:5120
    s_waitcnt lgkmcnt(6)
    v_mfma_f32_32x32x16_bf16 v[102:117], v[42:45], v[30:33], v[102:117]
    ds_read_b64_tr_b16 v[54:55], v3 offset:4096
    ds_read_b64_tr_b16 v[56:57], v3 offset:5120
    v_mfma_f32_32x32x16_bf16 v[118:133], v[42:45], v[34:37], v[118:133]
    ds_read_b64_tr_b16 v[62:63], v4 offset:27744
    ds_read_b64_tr_b16 v[64:65], v4 offset:28512
    s_waitcnt lgkmcnt(8)
    v_mfma_f32_32x32x16_bf16 v[134:149], v[46:49], v[30:33], v[134:149]
    ds_read_b64_tr_b16 v[66:67], v6 offset:27840
    ds_read_b64_tr_b16 v[68:69], v6 offset:28608
    v_mfma_f32_32x32x16_bf16 v[150:165], v[46:49], v[34:37], v[150:165]
    s_waitcnt lgkmcnt(0)
    s_barrier
    v_mfma_f32_32x32x16_bf16 v[70:85], v[58:61], v[50:53], v[70:85]
    ds_read_b64_tr_b16 v[38:39], v4 offset:36960
    ds_read_b64_tr_b16 v[40:41], v4 offset:37728
    v_mfma_f32_32x32x16_bf16 v[86:101], v[58:61], v[54:57], v[86:101]
    ds_read_b64_tr_b16 v[30:31], v2 offset:8192
    ds_read_b64_tr_b16 v[32:33], v2 offset:9216
    v_mfma_f32_32x32x16_bf16 v[102:117], v[62:65], v[50:53], v[102:117]
    ds_read_b64_tr_b16 v[34:35], v3 offset:8192
    ds_read_b64_tr_b16 v[36:37], v3 offset:9216
    v_mfma_f32_32x32x16_bf16 v[118:133], v[62:65], v[54:57], v[118:133]
    ds_read_b64_tr_b16 v[42:43], v4 offset:36992
    ds_read_b64_tr_b16 v[44:45], v4 offset:37760
    v_mfma_f32_32x32x16_bf16 v[134:149], v[66:69], v[50:53], v[134:149]
    ds_read_b64_tr_b16 v[46:47], v6 offset:37088
    ds_read_b64_tr_b16 v[48:49], v6 offset:37856
    v_mfma_f32_32x32x16_bf16 v[150:165], v[66:69], v[54:57], v[150:165]
    s_waitcnt lgkmcnt(6)
    v_mfma_f32_32x32x16_bf16 v[70:85], v[38:41], v[30:33], v[70:85]
    ds_read_b64_tr_b16 v[58:59], v4 offset:40032
    ds_read_b64_tr_b16 v[60:61], v4 offset:40800
    s_waitcnt lgkmcnt(6)
    v_mfma_f32_32x32x16_bf16 v[86:101], v[38:41], v[34:37], v[86:101]
    ds_read_b64_tr_b16 v[50:51], v2 offset:12288
    ds_read_b64_tr_b16 v[52:53], v2 offset:13312
    s_waitcnt lgkmcnt(6)
    v_mfma_f32_32x32x16_bf16 v[102:117], v[42:45], v[30:33], v[102:117]
    ds_read_b64_tr_b16 v[54:55], v3 offset:12288
    ds_read_b64_tr_b16 v[56:57], v3 offset:13312
    v_mfma_f32_32x32x16_bf16 v[118:133], v[42:45], v[34:37], v[118:133]
    ds_read_b64_tr_b16 v[62:63], v4 offset:40064
    ds_read_b64_tr_b16 v[64:65], v4 offset:40832
    s_waitcnt lgkmcnt(8)
    v_mfma_f32_32x32x16_bf16 v[134:149], v[46:49], v[30:33], v[134:149]
    ds_read_b64_tr_b16 v[66:67], v6 offset:40160
    ds_read_b64_tr_b16 v[68:69], v6 offset:40928
    v_mfma_f32_32x32x16_bf16 v[150:165], v[46:49], v[34:37], v[150:165]
    s_waitcnt lgkmcnt(0)
    s_barrier
    v_mfma_f32_32x32x16_bf16 v[70:85], v[58:61], v[50:53], v[70:85]
    ds_read_b64_tr_b16 v[38:39], v4 offset:49280
    ds_read_b64_tr_b16 v[40:41], v4 offset:50048
    v_mfma_f32_32x32x16_bf16 v[86:101], v[58:61], v[54:57], v[86:101]
    ds_read_b64_tr_b16 v[30:31], v2 offset:16384
    ds_read_b64_tr_b16 v[32:33], v2 offset:17408
    v_mfma_f32_32x32x16_bf16 v[102:117], v[62:65], v[50:53], v[102:117]
    ds_read_b64_tr_b16 v[34:35], v3 offset:16384
    ds_read_b64_tr_b16 v[36:37], v3 offset:17408
    v_mfma_f32_32x32x16_bf16 v[118:133], v[62:65], v[54:57], v[118:133]
    ds_read_b64_tr_b16 v[42:43], v4 offset:49312
    ds_read_b64_tr_b16 v[44:45], v4 offset:50080
    v_mfma_f32_32x32x16_bf16 v[134:149], v[66:69], v[50:53], v[134:149]
    ds_read_b64_tr_b16 v[46:47], v6 offset:49408
    ds_read_b64_tr_b16 v[48:49], v6 offset:50176
    v_mfma_f32_32x32x16_bf16 v[150:165], v[66:69], v[54:57], v[150:165]
    s_waitcnt lgkmcnt(6)
    v_mfma_f32_32x32x16_bf16 v[70:85], v[38:41], v[30:33], v[70:85]
    ds_read_b64_tr_b16 v[58:59], v4 offset:52352
    ds_read_b64_tr_b16 v[60:61], v4 offset:53120
    s_waitcnt lgkmcnt(6)
    v_mfma_f32_32x32x16_bf16 v[86:101], v[38:41], v[34:37], v[86:101]
    ds_read_b64_tr_b16 v[50:51], v2 offset:20480
    ds_read_b64_tr_b16 v[52:53], v2 offset:21504
    s_waitcnt lgkmcnt(6)
    v_mfma_f32_32x32x16_bf16 v[102:117], v[42:45], v[30:33], v[102:117]
    ds_read_b64_tr_b16 v[54:55], v3 offset:20480
    ds_read_b64_tr_b16 v[56:57], v3 offset:21504
    v_mfma_f32_32x32x16_bf16 v[118:133], v[42:45], v[34:37], v[118:133]
    ds_read_b64_tr_b16 v[62:63], v4 offset:52384
    ds_read_b64_tr_b16 v[64:65], v4 offset:53152
    s_waitcnt lgkmcnt(8)
    v_mfma_f32_32x32x16_bf16 v[134:149], v[46:49], v[30:33], v[134:149]
    ds_read_b64_tr_b16 v[66:67], v6 offset:52480
    ds_read_b64_tr_b16 v[68:69], v6 offset:53248
    v_mfma_f32_32x32x16_bf16 v[150:165], v[46:49], v[34:37], v[150:165]
    s_mov_b32 s17, 0
k2_stchk:
    s_waitcnt vmcnt(0)
    v_xor_b32 v192, s34, v167
    v_xor_b32 v193, s34, v169
    v_xor_b32 v194, s34, v209
    v_xor_b32 v195, s34, v211
    v_xor_b32 v196, s34, v213
    v_xor_b32 v197, s34, v215
    v_xor_b32 v198, s34, v217
    v_xor_b32 v199, s34, v219
    v_or3_b32 v192, v192, v193, v194
    v_or3_b32 v195, v195, v196, v197
    v_or3_b32 v192, v192, v198, v199
    v_or_b32 v192, v192, v195
    v_cmp_ne_u32 vcc, 0, v192
    s_nop 0
    s_cbranch_vccnz k2_stretry
k2_stok:
    v_mov_b32 v209, 0
    v_mov_b32 v211, 0
    v_mov_b32 v213, 0
    v_mov_b32 v215, 0
    v_mov_b32 v217, 0
    v_mov_b32 v219, 0
    v_and_b32 v173, 0xffff, v166
    v_xor_b32 v173, 0x8000, v173
    v_lshl_or_b32 v172, v173, 16, v173
    v_mov_b32 v175, 0
    v_mov_b32 v174, v172
    v_and_b32 v177, 0xffff, v168
    v_xor_b32 v177, 0x8000, v177
    v_lshl_or_b32 v176, v177, 16, v177
    v_mov_b32 v179, 0
    v_mov_b32 v178, v176
    v_mfma_f32_32x32x16_bf16 v[70:85], v[208:211], v[172:175], v[70:85]
    v_and_b32 v193, 0xffff0000, v166
    v_rcp_f32 v194, v193
    v_mul_f32 v188, v193, v193
    v_mfma_f32_32x32x16_bf16 v[86:101], v[208:211], v[176:179], v[86:101]
    v_mul_f32 v180, 0xc0135761, v194
    v_mul_f32 v195, v194, v194
    v_mul_f32 v195, v195, v194
    v_mfma_f32_32x32x16_bf16 v[102:117], v[212:215], v[172:175], v[102:117]
    v_mul_f32 v184, 0xbdd2d3e8, v195
    v_and_b32 v197, 0xffff0000, v168
    v_rcp_f32 v198, v197
    v_mfma_f32_32x32x16_bf16 v[118:133], v[212:215], v[176:179], v[118:133]
    v_mul_f32 v190, v197, v197
    v_mul_f32 v182, 0xc0135761, v198
    v_mul_f32 v199, v198, v198
    v_mfma_f32_32x32x16_bf16 v[134:149], v[216:219], v[172:175], v[134:149]
    v_mul_f32 v199, v199, v198
    v_mul_f32 v186, 0xbdd2d3e8, v199
    v_mfma_f32_32x32x16_bf16 v[150:165], v[216:219], v[176:179], v[150:165]
    s_waitcnt lgkmcnt(0)
    v_mov_b32 v9, 1
    s_mov_b64 exec, 1
    ds_add_u32 v8, v9 offset:8
    s_mov_b64 exec, -1
    v_mfma_f32_32x32x16_bf16 v[70:85], v[58:61], v[50:53], v[70:85]
    ds_read_b64_tr_b16 v[38:39], v5 offset:0
    ds_read_b64_tr_b16 v[40:41], v5 offset:768
    v_mfma_f32_32x32x16_bf16 v[86:101], v[58:61], v[54:57], v[86:101]
    ds_read_b64_tr_b16 v[30:31], v2 offset:24576
    ds_read_b64_tr_b16 v[32:33], v2 offset:25600
    v_mfma_f32_32x32x16_bf16 v[102:117], v[62:65], v[50:53], v[102:117]
    ds_read_b64_tr_b16 v[34:35], v3 offset:24576
    ds_read_b64_tr_b16 v[36:37], v3 offset:25600
    v_mfma_f32_32x32x16_bf16 v[118:133], v[62:65], v[54:57], v[118:133]
    ds_read_b64_tr_b16 v[42:43], v5 offset:32
    ds_read_b64_tr_b16 v[44:45], v5 offset:800
    v_mfma_f32_32x32x16_bf16 v[134:149], v[66:69], v[50:53], v[134:149]
    ds_read_b64_tr_b16 v[46:47], v7 offset:128
    ds_read_b64_tr_b16 v[48:49], v7 offset:896
    v_mfma_f32_32x32x16_bf16 v[150:165], v[66:69], v[54:57], v[150:165]
    s_waitcnt lgkmcnt(6)
    v_mfma_f32_32x32x16_bf16 v[70:85], v[38:41], v[30:33], v[70:85]
    ds_read_b64_tr_b16 v[58:59], v5 offset:3072
    ds_read_b64_tr_b16 v[60:61], v5 offset:3840
    s_waitcnt lgkmcnt(6)
    v_mfma_f32_32x32x16_bf16 v[86:101], v[38:41], v[34:37], v[86:101]
    ds_read_b64_tr_b16 v[50:51], v2 offset:28672
    ds_read_b64_tr_b16 v[52:53], v2 offset:29696
    s_waitcnt lgkmcnt(6)
    v_mfma_f32_32x32x16_bf16 v[102:117], v[42:45], v[30:33], v[102:117]
    ds_read_b64_tr_b16 v[54:55], v3 offset:28672
    ds_read_b64_tr_b16 v[56:57], v3 offset:29696
    v_mfma_f32_32x32x16_bf16 v[118:133], v[42:45], v[34:37], v[118:133]
    ds_read_b64_tr_b16 v[62:63], v5 offset:3104
    ds_read_b64_tr_b16 v[64:65], v5 offset:3872
    s_waitcnt lgkmcnt(8)
    v_mfma_f32_32x32x16_bf16 v[134:149], v[46:49], v[30:33], v[134:149]
    ds_read_b64_tr_b16 v[66:67], v7 offset:3200
    ds_read_b64_tr_b16 v[68:69], v7 offset:3968
    v_mfma_f32_32x32x16_bf16 v[150:165], v[46:49], v[34:37], v[150:165]
    s_waitcnt lgkmcnt(0)
    v_mfma_f32_32x32x16_bf16 v[70:85], v[58:61], v[50:53], v[70:85]
    v_mov_b32 v9, 1
    s_mov_b64 exec, 1
    ds_add_u32 v8, v9 offset:12
    s_mov_b64 exec, -1
    v_mfma_f32_32x32x16_bf16 v[86:101], v[58:61], v[54:57], v[86:101]
    v_mfma_f32_32x32x16_bf16 v[102:117], v[62:65], v[50:53], v[102:117]
    v_mfma_f32_32x32x16_bf16 v[118:133], v[62:65], v[54:57], v[118:133]
    v_mfma_f32_32x32x16_bf16 v[134:149], v[66:69], v[50:53], v[134:149]
    v_mfma_f32_32x32x16_bf16 v[150:165], v[66:69], v[54:57], v[150:165]
    s_cmp_ge_u32 s52, 86
    s_cbranch_scc1 k2_sig0
    s_lshl_b32 s39, s52, 9
    s_add_u32 s39, s39, s42
    s_add_u32 s40, s39, 88064
    v_pk_mul_f32 v[30:31], v[70:71], v[70:71]
    v_pk_mul_f32 v[32:33], v[72:73], v[72:73]
    v_pk_mul_f32 v[34:35], v[74:75], v[74:75]
    v_pk_mul_f32 v[36:37], v[76:77], v[76:77]
    v_pk_fma_f32 v[30:31], v[30:31], v[184:185], v[180:181] op_sel_hi:[1,0,0]
    v_pk_fma_f32 v[32:33], v[32:33], v[184:185], v[180:181] op_sel_hi:[1,0,0]
    v_pk_fma_f32 v[34:35], v[34:35], v[184:185], v[180:181] op_sel_hi:[1,0,0]
    v_pk_fma_f32 v[36:37], v[36:37], v[184:185], v[180:181] op_sel_hi:[1,0,0]
    v_pk_mul_f32 v[30:31], v[30:31], v[70:71]
    v_pk_mul_f32 v[32:33], v[32:33], v[72:73]
    v_pk_mul_f32 v[34:35], v[34:35], v[74:75]
    v_pk_mul_f32 v[36:37], v[36:37], v[76:77]
    v_exp_f32 v30, v30
    v_pk_mul_f32 v[38:39], v[86:87], v[86:87]
    v_exp_f32 v31, v31
    v_pk_mul_f32 v[40:41], v[88:89], v[88:89]
    v_exp_f32 v32, v32
    v_pk_mul_f32 v[42:43], v[90:91], v[90:91]
    v_exp_f32 v33, v33
    v_pk_mul_f32 v[44:45], v[92:93], v[92:93]
    v_exp_f32 v34, v34
    v_pk_fma_f32 v[38:39], v[38:39], v[186:187], v[182:183] op_sel_hi:[1,0,0]
    v_exp_f32 v35, v35
    v_pk_fma_f32 v[40:41], v[40:41], v[186:187], v[182:183] op_sel_hi:[1,0,0]
    v_exp_f32 v36, v36
    v_pk_fma_f32 v[42:43], v[42:43], v[186:187], v[182:183] op_sel_hi:[1,0,0]
    v_exp_f32 v37, v37
    v_pk_fma_f32 v[44:45], v[44:45], v[186:187], v[182:183] op_sel_hi:[1,0,0]
    v_pk_mul_f32 v[38:39], v[38:39], v[86:87]
    v_pk_mul_f32 v[40:41], v[40:41], v[88:89]
    v_pk_mul_f32 v[42:43], v[42:43], v[90:91]
    v_pk_mul_f32 v[44:45], v[44:45], v[92:93]
    v_exp_f32 v38, v38
    v_pk_fma_f32 v[30:31], v[30:31], v[188:189], v[188:189] op_sel_hi:[1,0,0]
    v_exp_f32 v39, v39
    v_pk_fma_f32 v[32:33], v[32:33], v[188:189], v[188:189] op_sel_hi:[1,0,0]
    v_exp_f32 v40, v40
    v_pk_fma_f32 v[34:35], v[34:35], v[188:189], v[188:189] op_sel_hi:[1,0,0]
    v_exp_f32 v41, v41
    v_pk_fma_f32 v[36:37], v[36:37], v[188:189], v[188:189] op_sel_hi:[1,0,0]
    v_exp_f32 v42, v42
    v_pk_mul_f32 v[70:71], v[70:71], v[78:79]
    v_exp_f32 v43, v43
    v_pk_mul_f32 v[72:73], v[72:73], v[80:81]
    v_exp_f32 v44, v44
    v_pk_mul_f32 v[74:75], v[74:75], v[82:83]
    v_exp_f32 v45, v45
    v_pk_mul_f32 v[76:77], v[76:77], v[84:85]
    v_rcp_f32 v30, v30
    v_pk_fma_f32 v[38:39], v[38:39], v[190:191], v[190:191] op_sel_hi:[1,0,0]
    v_rcp_f32 v31, v31
    v_pk_fma_f32 v[40:41], v[40:41], v[190:191], v[190:191] op_sel_hi:[1,0,0]
    v_rcp_f32 v32, v32
    v_pk_fma_f32 v[42:43], v[42:43], v[190:191], v[190:191] op_sel_hi:[1,0,0]
    v_rcp_f32 v33, v33
    v_pk_fma_f32 v[44:45], v[44:45], v[190:191], v[190:191] op_sel_hi:[1,0,0]
    v_rcp_f32 v34, v34
    v_pk_mul_f32 v[86:87], v[86:87], v[94:95]
    v_rcp_f32 v35, v35
    v_pk_mul_f32 v[88:89], v[88:89], v[96:97]
    v_rcp_f32 v36, v36
    v_pk_mul_f32 v[90:91], v[90:91], v[98:99]
    v_rcp_f32 v37, v37
    v_pk_mul_f32 v[92:93], v[92:93], v[100:101]
    v_rcp_f32 v38, v38
    v_pk_mul_f32 v[70:71], v[70:71], v[30:31]
    v_rcp_f32 v39, v39
    v_pk_mul_f32 v[72:73], v[72:73], v[32:33]
    v_rcp_f32 v40, v40
    v_pk_mul_f32 v[74:75], v[74:75], v[34:35]
    v_rcp_f32 v41, v41
    v_pk_mul_f32 v[76:77], v[76:77], v[36:37]
    v_rcp_f32 v42, v42
    v_cvt_pk_bf16_f32 v78, v70, v71
    v_rcp_f32 v43, v43
    v_cvt_pk_bf16_f32 v79, v72, v73
    v_rcp_f32 v44, v44
    v_cvt_pk_bf16_f32 v80, v74, v75
    v_rcp_f32 v45, v45
    v_cvt_pk_bf16_f32 v81, v76, v77
    buffer_store_dwordx4 v[78:81], v12, s[48:51], s39 offen sc0 sc1
    v_pk_mul_f32 v[86:87], v[86:87], v[38:39]
    v_pk_mul_f32 v[88:89], v[88:89], v[40:41]
    v_pk_mul_f32 v[90:91], v[90:91], v[42:43]
    v_pk_mul_f32 v[92:93], v[92:93], v[44:45]
    v_cvt_pk_bf16_f32 v94, v86, v87
    v_cvt_pk_bf16_f32 v95, v88, v89
    v_cvt_pk_bf16_f32 v96, v90, v91
    v_cvt_pk_bf16_f32 v97, v92, v93
    buffer_store_dwordx4 v[94:97], v12, s[48:51], s40 offen sc0 sc1
    s_cmp_ge_u32 s53, 86
    s_cbranch_scc1 k2_sig0
    s_lshl_b32 s39, s53, 9
    s_add_u32 s39, s39, s42
    s_add_u32 s40, s39, 88064
    v_pk_mul_f32 v[30:31], v[102:103], v[102:103]
    v_pk_mul_f32 v[32:33], v[104:105], v[104:105]
    v_pk_mul_f32 v[34:35], v[106:107], v[106:107]
    v_pk_mul_f32 v[36:37], v[108:109], v[108:109]
    v_pk_fma_f32 v[30:31], v[30:31], v[184:185], v[180:181] op_sel_hi:[1,0,0]
    v_pk_fma_f32 v[32:33], v[32:33], v[184:185], v[180:181] op_sel_hi:[1,0,0]
    v_pk_fma_f32 v[34:35], v[34:35], v[184:185], v[180:181] op_sel_hi:[1,0,0]
    v_pk_fma_f32 v[36:37], v[36:37], v[184:185], v[180:181] op_sel_hi:[1,0,0]
    v_pk_mul_f32 v[30:31], v[30:31], v[102:103]
    v_pk_mul_f32 v[32:33], v[32:33], v[104:105]
    v_pk_mul_f32 v[34:35], v[34:35], v[106:107]
    v_pk_mul_f32 v[36:37], v[36:37], v[108:109]
    v_exp_f32 v30, v30
    v_pk_mul_f32 v[38:39], v[118:119], v[118:119]
    v_exp_f32 v31, v31
    v_pk_mul_f32 v[40:41], v[120:121], v[120:121]
    v_exp_f32 v32, v32
    v_pk_mul_f32 v[42:43], v[122:123], v[122:123]
    v_exp_f32 v33, v33
    v_pk_mul_f32 v[44:45], v[124:125], v[124:125]
    v_exp_f32 v34, v34
    v_pk_fma_f32 v[38:39], v[38:39], v[186:187], v[182:183] op_sel_hi:[1,0,0]
    v_exp_f32 v35, v35
    v_pk_fma_f32 v[40:41], v[40:41], v[186:187], v[182:183] op_sel_hi:[1,0,0]
    v_exp_f32 v36, v36
    v_pk_fma_f32 v[42:43], v[42:43], v[186:187], v[182:183] op_sel_hi:[1,0,0]
    v_exp_f32 v37, v37
    v_pk_fma_f32 v[44:45], v[44:45], v[186:187], v[182:183] op_sel_hi:[1,0,0]
    v_pk_mul_f32 v[38:39], v[38:39], v[118:119]
    v_pk_mul_f32 v[40:41], v[40:41], v[120:121]
    v_pk_mul_f32 v[42:43], v[42:43], v[122:123]
    v_pk_mul_f32 v[44:45], v[44:45], v[124:125]
    v_exp_f32 v38, v38
    v_pk_fma_f32 v[30:31], v[30:31], v[188:189], v[188:189] op_sel_hi:[1,0,0]
    v_exp_f32 v39, v39
    v_pk_fma_f32 v[32:33], v[32:33], v[188:189], v[188:189] op_sel_hi:[1,0,0]
    v_exp_f32 v40, v40
    v_pk_fma_f32 v[34:35], v[34:35], v[188:189], v[188:189] op_sel_hi:[1,0,0]
    v_exp_f32 v41, v41
    v_pk_fma_f32 v[36:37], v[36:37], v[188:189], v[188:189] op_sel_hi:[1,0,0]
    v_exp_f32 v42, v42
    v_pk_mul_f32 v[102:103], v[102:103], v[110:111]
    v_exp_f32 v43, v43
    v_pk_mul_f32 v[104:105], v[104:105], v[112:113]
    v_exp_f32 v44, v44
    v_pk_mul_f32 v[106:107], v[106:107], v[114:115]
    v_exp_f32 v45, v45
    v_pk_mul_f32 v[108:109], v[108:109], v[116:117]
    v_rcp_f32 v30, v30
    v_pk_fma_f32 v[38:39], v[38:39], v[190:191], v[190:191] op_sel_hi:[1,0,0]
    v_rcp_f32 v31, v31
    v_pk_fma_f32 v[40:41], v[40:41], v[190:191], v[190:191] op_sel_hi:[1,0,0]
    v_rcp_f32 v32, v32
    v_pk_fma_f32 v[42:43], v[42:43], v[190:191], v[190:191] op_sel_hi:[1,0,0]
    v_rcp_f32 v33, v33
    v_pk_fma_f32 v[44:45], v[44:45], v[190:191], v[190:191] op_sel_hi:[1,0,0]
    v_rcp_f32 v34, v34
    v_pk_mul_f32 v[118:119], v[118:119], v[126:127]
    v_rcp_f32 v35, v35
    v_pk_mul_f32 v[120:121], v[120:121], v[128:129]
    v_rcp_f32 v36, v36
    v_pk_mul_f32 v[122:123], v[122:123], v[130:131]
    v_rcp_f32 v37, v37
    v_pk_mul_f32 v[124:125], v[124:125], v[132:133]
    v_rcp_f32 v38, v38
    v_pk_mul_f32 v[102:103], v[102:103], v[30:31]
    v_rcp_f32 v39, v39
    v_pk_mul_f32 v[104:105], v[104:105], v[32:33]
    v_rcp_f32 v40, v40
    v_pk_mul_f32 v[106:107], v[106:107], v[34:35]
    v_rcp_f32 v41, v41
    v_pk_mul_f32 v[108:109], v[108:109], v[36:37]
    v_rcp_f32 v42, v42
    v_cvt_pk_bf16_f32 v110, v102, v103
    v_rcp_f32 v43, v43
    v_cvt_pk_bf16_f32 v111, v104, v105
    v_rcp_f32 v44, v44
    v_cvt_pk_bf16_f32 v112, v106, v107
    v_rcp_f32 v45, v45
    v_cvt_pk_bf16_f32 v113, v108, v109
    buffer_store_dwordx4 v[110:113], v12, s[48:51], s39 offen sc0 sc1
    v_pk_mul_f32 v[118:119], v[118:119], v[38:39]
    v_pk_mul_f32 v[120:121], v[120:121], v[40:41]
    v_pk_mul_f32 v[122:123], v[122:123], v[42:43]
    v_pk_mul_f32 v[124:125], v[124:125], v[44:45]
    v_cvt_pk_bf16_f32 v126, v118, v119
    v_cvt_pk_bf16_f32 v127, v120, v121
    v_cvt_pk_bf16_f32 v128, v122, v123
    v_cvt_pk_bf16_f32 v129, v124, v125
    buffer_store_dwordx4 v[126:129], v12, s[48:51], s40 offen sc0 sc1
    v_mov_b32 v9, 1
    s_mov_b64 exec, 1
    ds_add_u32 v8, v9 offset:4
    s_mov_b64 exec, -1
    s_lshl_b32 s45, s36, 4
    s_add_u32 s45, s45, s38
    s_cmp_lg_u32 s45, 13
    s_cbranch_scc1 k2_nog
    s_lshl_b32 s45, s37, 7
    s_add_u32 s45, s45, 28672
    v_mov_b32 v166, s45
    v_mov_b32 v167, s34
    s_mov_b64 exec, 1
    global_store_dword v166, v167, s[30:31] sc0 sc1
    s_mov_b64 exec, -1
k2_nog:
    s_cmp_ge_u32 s54, 86
    s_cbranch_scc1 k2_sig
    s_lshl_b32 s39, s54, 9
    s_add_u32 s39, s39, s42
    s_add_u32 s40, s39, 88064
    v_pk_mul_f32 v[30:31], v[134:135], v[134:135]
    v_pk_mul_f32 v[32:33], v[136:137], v[136:137]
    v_pk_mul_f32 v[34:35], v[138:139], v[138:139]
    v_pk_mul_f32 v[36:37], v[140:141], v[140:141]
    v_pk_fma_f32 v[30:31], v[30:31], v[184:185], v[180:181] op_sel_hi:[1,0,0]
    v_pk_fma_f32 v[32:33], v[32:33], v[184:185], v[180:181] op_sel_hi:[1,0,0]
    v_pk_fma_f32 v[34:35], v[34:35], v[184:185], v[180:181] op_sel_hi:[1,0,0]
    v_pk_fma_f32 v[36:37], v[36:37], v[184:185], v[180:181] op_sel_hi:[1,0,0]
    v_pk_mul_f32 v[30:31], v[30:31], v[134:135]
    v_pk_mul_f32 v[32:33], v[32:33], v[136:137]
    v_pk_mul_f32 v[34:35], v[34:35], v[138:139]
    v_pk_mul_f32 v[36:37], v[36:37], v[140:141]
    v_exp_f32 v30, v30
    v_pk_mul_f32 v[38:39], v[150:151], v[150:151]
    v_exp_f32 v31, v31
    v_pk_mul_f32 v[40:41], v[152:153], v[152:153]
    v_exp_f32 v32, v32
    v_pk_mul_f32 v[42:43], v[154:155], v[154:155]
    v_exp_f32 v33, v33
    v_pk_mul_f32 v[44:45], v[156:157], v[156:157]
    v_exp_f32 v34, v34
    v_pk_fma_f32 v[38:39], v[38:39], v[186:187], v[182:183] op_sel_hi:[1,0,0]
    v_exp_f32 v35, v35
    v_pk_fma_f32 v[40:41], v[40:41], v[186:187], v[182:183] op_sel_hi:[1,0,0]
    v_exp_f32 v36, v36
    v_pk_fma_f32 v[42:43], v[42:43], v[186:187], v[182:183] op_sel_hi:[1,0,0]
    v_exp_f32 v37, v37
    v_pk_fma_f32 v[44:45], v[44:45], v[186:187], v[182:183] op_sel_hi:[1,0,0]
    v_pk_mul_f32 v[38:39], v[38:39], v[150:151]
    v_pk_mul_f32 v[40:41], v[40:41], v[152:153]
    v_pk_mul_f32 v[42:43], v[42:43], v[154:155]
    v_pk_mul_f32 v[44:45], v[44:45], v[156:157]
    v_exp_f32 v38, v38
    v_pk_fma_f32 v[30:31], v[30:31], v[188:189], v[188:189] op_sel_hi:[1,0,0]
    v_exp_f32 v39, v39
    v_pk_fma_f32 v[32:33], v[32:33], v[188:189], v[188:189] op_sel_hi:[1,0,0]
    v_exp_f32 v40, v40
    v_pk_fma_f32 v[34:35], v[34:35], v[188:189], v[188:189] op_sel_hi:[1,0,0]
    v_exp_f32 v41, v41
    v_pk_fma_f32 v[36:37], v[36:37], v[188:189], v[188:189] op_sel_hi:[1,0,0]
    v_exp_f32 v42, v42
    v_pk_mul_f32 v[134:135], v[134:135], v[142:143]
    v_exp_f32 v43, v43
    v_pk_mul_f32 v[136:137], v[136:137], v[144:145]
    v_exp_f32 v44, v44
    v_pk_mul_f32 v[138:139], v[138:139], v[146:147]
    v_exp_f32 v45, v45
    v_pk_mul_f32 v[140:141], v[140:141], v[148:149]
    v_rcp_f32 v30, v30
    v_pk_fma_f32 v[38:39], v[38:39], v[190:191], v[190:191] op_sel_hi:[1,0,0]
    v_rcp_f32 v31, v31
    v_pk_fma_f32 v[40:41], v[40:41], v[190:191], v[190:191] op_sel_hi:[1,0,0]
    v_rcp_f32 v32, v32
    v_pk_fma_f32 v[42:43], v[42:43], v[190:191], v[190:191] op_sel_hi:[1,0,0]
    v_rcp_f32 v33, v33
    v_pk_fma_f32 v[44:45], v[44:45], v[190:191], v[190:191] op_sel_hi:[1,0,0]
    v_rcp_f32 v34, v34
    v_pk_mul_f32 v[150:151], v[150:151], v[158:159]
    v_rcp_f32 v35, v35
    v_pk_mul_f32 v[152:153], v[152:153], v[160:161]
    v_rcp_f32 v36, v36
    v_pk_mul_f32 v[154:155], v[154:155], v[162:163]
    v_rcp_f32 v37, v37
    v_pk_mul_f32 v[156:157], v[156:157], v[164:165]
    v_rcp_f32 v38, v38
    v_pk_mul_f32 v[134:135], v[134:135], v[30:31]
    v_rcp_f32 v39, v39
    v_pk_mul_f32 v[136:137], v[136:137], v[32:33]
    v_rcp_f32 v40, v40
    v_pk_mul_f32 v[138:139], v[138:139], v[34:35]
    v_rcp_f32 v41, v41
    v_pk_mul_f32 v[140:141], v[140:141], v[36:37]
    v_rcp_f32 v42, v42
    v_cvt_pk_bf16_f32 v142, v134, v135
    v_rcp_f32 v43, v43
    v_cvt_pk_bf16_f32 v143, v136, v137
    v_rcp_f32 v44, v44
    v_cvt_pk_bf16_f32 v144, v138, v139
    v_rcp_f32 v45, v45
    v_cvt_pk_bf16_f32 v145, v140, v141
    buffer_store_dwordx4 v[142:145], v12, s[48:51], s39 offen sc0 sc1
    v_pk_mul_f32 v[150:151], v[150:151], v[38:39]
    v_pk_mul_f32 v[152:153], v[152:153], v[40:41]
    v_pk_mul_f32 v[154:155], v[154:155], v[42:43]
    v_pk_mul_f32 v[156:157], v[156:157], v[44:45]
    v_cvt_pk_bf16_f32 v158, v150, v151
    v_cvt_pk_bf16_f32 v159, v152, v153
    v_cvt_pk_bf16_f32 v160, v154, v155
    v_cvt_pk_bf16_f32 v161, v156, v157
    buffer_store_dwordx4 v[158:161], v12, s[48:51], s40 offen sc0 sc1
k2_sig:
    s_setprio 0
k2_p2b:
    s_branch k2_cw_5_e
k2_cw_5:
    s_sleep 1
k2_cw_5_e:
    ds_read_b32 v9, v8 offset:0
    s_waitcnt lgkmcnt(0)
    v_cmp_gt_u32 vcc, 4, v9
    s_nop 0
    s_cbranch_vccnz k2_cw_5
    ds_read_b64_tr_b16 v[36:37], v244 offset:20672
    ds_read_b64_tr_b16 v[38:39], v244 offset:21184
    ds_read_b64_tr_b16 v[40:41], v245 offset:20672
    ds_read_b64_tr_b16 v[42:43], v245 offset:21184
    ds_read_b64_tr_b16 v[44:45], v246 offset:20672
    ds_read_b64_tr_b16 v[46:47], v246 offset:21184
    ds_read_b64_tr_b16 v[48:49], v247 offset:20672
    ds_read_b64_tr_b16 v[50:51], v247 offset:21184
    ds_read_b64_tr_b16 v[52:53], v240 offset:24640
    ds_read_b64_tr_b16 v[54:55], v240 offset:25152
    ds_read_b64_tr_b16 v[56:57], v241 offset:24640
    ds_read_b64_tr_b16 v[58:59], v241 offset:25152
    ds_read_b64_tr_b16 v[60:61], v242 offset:24640
    ds_read_b64_tr_b16 v[62:63], v242 offset:25152
    ds_read_b64_tr_b16 v[64:65], v243 offset:24640
    ds_read_b64_tr_b16 v[66:67], v243 offset:25152
    ds_read_b64_tr_b16 v[68:69], v240 offset:28736
    ds_read_b64_tr_b16 v[70:71], v240 offset:29248
    ds_read_b64_tr_b16 v[72:73], v241 offset:28736
    ds_read_b64_tr_b16 v[74:75], v241 offset:29248
    ds_read_b64_tr_b16 v[76:77], v242 offset:28736
    ds_read_b64_tr_b16 v[78:79], v242 offset:29248
    ds_read_b64_tr_b16 v[80:81], v243 offset:28736
    ds_read_b64_tr_b16 v[82:83], v243 offset:29248
    ds_read_b64_tr_b16 v[84:85], v240 offset:32832
    ds_read_b64_tr_b16 v[86:87], v240 offset:33344
    ds_read_b64_tr_b16 v[88:89], v241 offset:32832
    ds_read_b64_tr_b16 v[90:91], v241 offset:33344
    ds_read_b64_tr_b16 v[92:93], v242 offset:32832
    ds_read_b64_tr_b16 v[94:95], v242 offset:33344
    ds_read_b64_tr_b16 v[96:97], v243 offset:32832
    ds_read_b64_tr_b16 v[98:99], v243 offset:33344
    ds_read_b64_tr_b16 v[100:101], v248 offset:320
    ds_read_b64_tr_b16 v[102:103], v248 offset:832
    ds_read_b64_tr_b16 v[104:105], v249 offset:320
    ds_read_b64_tr_b16 v[106:107], v249 offset:832
    ds_read_b64_tr_b16 v[108:109], v250 offset:320
    ds_read_b64_tr_b16 v[110:111], v250 offset:832
    ds_read_b64_tr_b16 v[112:113], v251 offset:320
    ds_read_b64_tr_b16 v[114:115], v251 offset:832
    ds_read_b64_tr_b16 v[116:117], v248 offset:4416
    ds_read_b64_tr_b16 v[118:119], v248 offset:4928
    ds_read_b64_tr_b16 v[120:121], v249 offset:4416
    ds_read_b64_tr_b16 v[122:123], v249 offset:4928
    ds_read_b64_tr_b16 v[124:125], v250 offset:4416
    ds_read_b64_tr_b16 v[126:127], v250 offset:4928
    ds_read_b64_tr_b16 v[128:129], v251 offset:4416
    ds_read_b64_tr_b16 v[130:131], v251 offset:4928
    ds_read_b64_tr_b16 v[132:133], v248 offset:33088
    ds_read_b64_tr_b16 v[134:135], v248 offset:33600
    ds_read_b64_tr_b16 v[136:137], v249 offset:33088
    ds_read_b64_tr_b16 v[138:139], v249 offset:33600
    ds_read_b64_tr_b16 v[140:141], v250 offset:33088
    ds_read_b64_tr_b16 v[142:143], v250 offset:33600
    ds_read_b64_tr_b16 v[144:145], v251 offset:33088
    ds_read_b64_tr_b16 v[146:147], v251 offset:33600
    ds_read_b64_tr_b16 v[148:149], v244 offset:24800
    ds_read_b64_tr_b16 v[150:151], v244 offset:25312
    ds_read_b64_tr_b16 v[152:153], v245 offset:24800
    ds_read_b64_tr_b16 v[154:155], v245 offset:25312
    ds_read_b64_tr_b16 v[156:157], v246 offset:24800
    ds_read_b64_tr_b16 v[158:159], v246 offset:25312
    ds_read_b64_tr_b16 v[160:161], v247 offset:24800
    ds_read_b64_tr_b16 v[162:163], v247 offset:25312
    ds_read_b64_tr_b16 v[164:165], v244 offset:28896
    ds_read_b64_tr_b16 v[166:167], v244 offset:29408
    ds_read_b64_tr_b16 v[168:169], v245 offset:28896
    ds_read_b64_tr_b16 v[170:171], v245 offset:29408
    ds_read_b64_tr_b16 v[172:173], v246 offset:28896
    ds_read_b64_tr_b16 v[174:175], v246 offset:29408
    ds_read_b64_tr_b16 v[176:177], v247 offset:28896
    ds_read_b64_tr_b16 v[178:179], v247 offset:29408
    ds_read_b64_tr_b16 v[180:181], v240 offset:36960
    ds_read_b64_tr_b16 v[182:183], v240 offset:37472
    ds_read_b64_tr_b16 v[184:185], v241 offset:36960
    ds_read_b64_tr_b16 v[186:187], v241 offset:37472
    ds_read_b64_tr_b16 v[188:189], v242 offset:36960
    ds_read_b64_tr_b16 v[190:191], v242 offset:37472
    ds_read_b64_tr_b16 v[192:193], v243 offset:36960
    ds_read_b64_tr_b16 v[194:195], v243 offset:37472
    s_waitcnt lgkmcnt(0)
    s_mov_b32 s17, 0
    s_add_u32 s40, s23, 31744
    s_sub_u32 s39, s40, 43008
    s_cselect_b32 s40, s40, s39
    s_add_u32 s39, s46, s40
    buffer_load_dwordx4 v[212:215], v17, s[48:51], s39 offen
    s_add_u32 s40, s23, 33792
    s_sub_u32 s39, s40, 43008
    s_cselect_b32 s40, s40, s39
    s_add_u32 s39, s46, s40
    buffer_load_dwordx4 v[216:219], v17, s[48:51], s39 offen
    s_add_u32 s40, s23, 34816
    s_sub_u32 s39, s40, 43008
    s_cselect_b32 s40, s40, s39
    s_add_u32 s39, s46, s40
    buffer_load_dwordx4 v[220:223], v17, s[48:51], s39 offen
    s_add_u32 s40, s23, 36864
    s_sub_u32 s39, s40, 43008
    s_cselect_b32 s40, s40, s39
    s_add_u32 s39, s46, s40
    buffer_load_dwordx4 v[224:227], v17, s[48:51], s39 offen
    s_add_u32 s40, s23, 37888
    s_sub_u32 s39, s40, 43008
    s_cselect_b32 s40, s40, s39
    s_add_u32 s39, s46, s40
    buffer_load_dwordx4 v[228:231], v17, s[48:51], s39 offen
    s_add_u32 s40, s23, 39936
    s_sub_u32 s39, s40, 43008
    s_cselect_b32 s40, s40, s39
    s_add_u32 s39, s46, s40
    buffer_load_dwordx4 v[232:235], v17, s[48:51], s39 offen
    s_waitcnt vmcnt(5)
k2_c21:
    v_max3_u32 v10, v212, v213, v214
    v_max_u32 v10, v10, v215
    v_cmp_eq_u32 vcc, -1, v10
    s_nop 0
    s_cbranch_vccnz k2_r21
k2_o21:
    s_add_u32 s40, s23, 40960
    s_sub_u32 s39, s40, 43008
    s_cselect_b32 s40, s40, s39
    s_add_u32 s39, s46, s40
    buffer_load_dwordx4 v[236:239], v17, s[48:51], s39 offen
    v_mfma_f32_16x16x32_bf16 v[20:23], v[36:39], v[212:215], 0
    s_waitcnt lgkmcnt(7)
    ds_read_b64_tr_b16 v[196:197], v240 offset:41056
    ds_read_b64_tr_b16 v[198:199], v240 offset:41568
    v_mfma_f32_16x16x32_bf16 v[24:27], v[40:43], v[212:215], 0
    ds_read_b64_tr_b16 v[200:201], v241 offset:41056
    ds_read_b64_tr_b16 v[202:203], v241 offset:41568
    v_mfma_f32_16x16x32_bf16 v[28:31], v[44:47], v[212:215], 0
    ds_read_b64_tr_b16 v[204:205], v242 offset:41056
    ds_read_b64_tr_b16 v[206:207], v242 offset:41568
    v_mfma_f32_16x16x32_bf16 v[32:35], v[48:51], v[212:215], 0
    ds_read_b64_tr_b16 v[208:209], v243 offset:41056
    ds_read_b64_tr_b16 v[210:211], v243 offset:41568
    s_waitcnt vmcnt(5)
k2_c22:
    v_max3_u32 v10, v216, v217, v218
    v_max_u32 v10, v10, v219
    v_cmp_eq_u32 vcc, -1, v10
    s_nop 0
    s_cbranch_vccnz k2_r22
k2_o22:
    s_mov_b32 s40, 43008
    s_add_u32 s39, s46, s40
    buffer_load_dwordx4 v[212:215], v17, s[48:51], s39 offen
    v_mfma_f32_16x16x32_bf16 v[20:23], v[52:55], v[216:219], v[20:23]
    s_waitcnt lgkmcnt(7)
    ds_read_b64_tr_b16 v[36:37], v240 offset:45152
    ds_read_b64_tr_b16 v[38:39], v240 offset:45664
    v_mfma_f32_16x16x32_bf16 v[24:27], v[56:59], v[216:219], v[24:27]
    ds_read_b64_tr_b16 v[40:41], v241 offset:45152
    ds_read_b64_tr_b16 v[42:43], v241 offset:45664
    v_mfma_f32_16x16x32_bf16 v[28:31], v[60:63], v[216:219], v[28:31]
    ds_read_b64_tr_b16 v[44:45], v242 offset:45152
    ds_read_b64_tr_b16 v[46:47], v242 offset:45664
    v_mfma_f32_16x16x32_bf16 v[32:35], v[64:67], v[216:219], v[32:35]
    ds_read_b64_tr_b16 v[48:49], v243 offset:45152
    ds_read_b64_tr_b16 v[50:51], v243 offset:45664
    s_waitcnt vmcnt(5)
k2_c23:
    v_max3_u32 v10, v220, v221, v222
    v_max_u32 v10, v10, v223
    v_cmp_eq_u32 vcc, -1, v10
    s_nop 0
    s_cbranch_vccnz k2_r23
k2_o23:
    s_add_u32 s40, s23, 2048
    s_sub_u32 s39, s40, 43008
    s_cselect_b32 s40, s40, s39
    s_add_u32 s39, s46, s40
    buffer_load_dwordx4 v[216:219], v17, s[48:51], s39 offen
    v_mfma_f32_16x16x32_bf16 v[20:23], v[68:71], v[220:223], v[20:23]
    s_waitcnt lgkmcnt(7)
    ds_read_b64_tr_b16 v[52:53], v248 offset:8512
    ds_read_b64_tr_b16 v[54:55], v248 offset:9024
    v_mfma_f32_16x16x32_bf16 v[24:27], v[72:75], v[220:223], v[24:27]
    ds_read_b64_tr_b16 v[56:57], v249 offset:8512
    ds_read_b64_tr_b16 v[58:59], v249 offset:9024
    v_mfma_f32_16x16x32_bf16 v[28:31], v[76:79], v[220:223], v[28:31]
    ds_read_b64_tr_b16 v[60:61], v250 offset:8512
    ds_read_b64_tr_b16 v[62:63], v250 offset:9024
    v_mfma_f32_16x16x32_bf16 v[32:35], v[80:83], v[220:223], v[32:35]
    ds_read_b64_tr_b16 v[64:65], v251 offset:8512
    ds_read_b64_tr_b16 v[66:67], v251 offset:9024
    s_waitcnt vmcnt(5)
k2_c24:
    v_max3_u32 v10, v224, v225, v226
    v_max_u32 v10, v10, v227
    v_cmp_eq_u32 vcc, -1, v10
    s_nop 0
    s_cbranch_vccnz k2_r24
k2_o24:
    s_add_u32 s40, s23, 5120
    s_sub_u32 s39, s40, 43008
    s_cselect_b32 s40, s40, s39
    s_add_u32 s39, s46, s40
    buffer_load_dwordx4 v[220:223], v17, s[48:51], s39 offen
    v_mfma_f32_16x16x32_bf16 v[20:23], v[84:87], v[224:227], v[20:23]
    s_waitcnt lgkmcnt(7)
    ds_read_b64_tr_b16 v[68:69], v248 offset:12608
    ds_read_b64_tr_b16 v[70:71], v248 offset:13120
    v_mfma_f32_16x16x32_bf16 v[24:27], v[88:91], v[224:227], v[24:27]
    ds_read_b64_tr_b16 v[72:73], v249 offset:12608
    ds_read_b64_tr_b16 v[74:75], v249 offset:13120
    v_mfma_f32_16x16x32_bf16 v[28:31], v[92:95], v[224:227], v[28:31]
    ds_read_b64_tr_b16 v[76:77], v250 offset:12608
    ds_read_b64_tr_b16 v[78:79], v250 offset:13120
    v_mfma_f32_16x16x32_bf16 v[32:35], v[96:99], v[224:227], v[32:35]
    ds_read_b64_tr_b16 v[80:81], v251 offset:12608
    ds_read_b64_tr_b16 v[82:83], v251 offset:13120
    s_waitcnt vmcnt(5)
k2_c25:
    v_max3_u32 v10, v228, v229, v230
    v_max_u32 v10, v10, v231
    v_cmp_eq_u32 vcc, -1, v10
    s_nop 0
    s_cbranch_vccnz k2_r25
k2_o25:
    s_add_u32 s40, s23, 8192
    s_sub_u32 s39, s40, 43008
    s_cselect_b32 s40, s40, s39
    s_add_u32 s39, s46, s40
    buffer_load_dwordx4 v[224:227], v17, s[48:51], s39 offen
    v_mfma_f32_16x16x32_bf16 v[20:23], v[100:103], v[228:231], v[20:23]
    s_waitcnt lgkmcnt(7)
    ds_read_b64_tr_b16 v[84:85], v244 offset:32992
    ds_read_b64_tr_b16 v[86:87], v244 offset:33504
    v_mfma_f32_16x16x32_bf16 v[24:27], v[104:107], v[228:231], v[24:27]
    ds_read_b64_tr_b16 v[88:89], v245 offset:32992
    ds_read_b64_tr_b16 v[90:91], v245 offset:33504
    v_mfma_f32_16x16x32_bf16 v[28:31], v[108:111], v[228:231], v[28:31]
    ds_read_b64_tr_b16 v[92:93], v246 offset:32992
    ds_read_b64_tr_b16 v[94:95], v246 offset:33504
    v_mfma_f32_16x16x32_bf16 v[32:35], v[112:115], v[228:231], v[32:35]
    ds_read_b64_tr_b16 v[96:97], v247 offset:32992
    ds_read_b64_tr_b16 v[98:99], v247 offset:33504
    s_waitcnt vmcnt(5)
k2_c26:
    v_max3_u32 v10, v232, v233, v234
    v_max_u32 v10, v10, v235
    v_cmp_eq_u32 vcc, -1, v10
    s_nop 0
    s_cbranch_vccnz k2_r26
k2_o26:
    s_add_u32 s40, s23, 11264
    s_sub_u32 s39, s40, 43008
    s_cselect_b32 s40, s40, s39
    s_add_u32 s39, s46, s40
    buffer_load_dwordx4 v[228:231], v17, s[48:51], s39 offen
    v_mfma_f32_16x16x32_bf16 v[20:23], v[116:119], v[232:235], v[20:23]
    s_waitcnt lgkmcnt(7)
    ds_read_b64_tr_b16 v[100:101], v244 offset:37120
    ds_read_b64_tr_b16 v[102:103], v244 offset:37632
    v_mfma_f32_16x16x32_bf16 v[24:27], v[120:123], v[232:235], v[24:27]
    ds_read_b64_tr_b16 v[104:105], v245 offset:37120
    ds_read_b64_tr_b16 v[106:107], v245 offset:37632
    v_mfma_f32_16x16x32_bf16 v[28:31], v[124:127], v[232:235], v[28:31]
    ds_read_b64_tr_b16 v[108:109], v246 offset:37120
    ds_read_b64_tr_b16 v[110:111], v246 offset:37632
    v_mfma_f32_16x16x32_bf16 v[32:35], v[128:131], v[232:235], v[32:35]
    ds_read_b64_tr_b16 v[112:113], v247 offset:37120
    ds_read_b64_tr_b16 v[114:115], v247 offset:37632
    s_waitcnt vmcnt(5)
k2_c27:
    v_max3_u32 v10, v236, v237, v238
    v_max_u32 v10, v10, v239
    v_cmp_eq_u32 vcc, -1, v10
    s_nop 0
    s_cbranch_vccnz k2_r27
k2_o27:
    s_add_u32 s40, s23, 14336
    s_sub_u32 s39, s40, 43008
    s_cselect_b32 s40, s40, s39
    s_add_u32 s39, s46, s40
    buffer_load_dwordx4 v[232:235], v17, s[48:51], s39 offen
    v_mfma_f32_16x16x32_bf16 v[20:23], v[132:135], v[236:239], v[20:23]
    s_waitcnt lgkmcnt(7)
    ds_read_b64_tr_b16 v[116:117], v244 offset:41216
    ds_read_b64_tr_b16 v[118:119], v244 offset:41728
    v_mfma_f32_16x16x32_bf16 v[24:27], v[136:139], v[236:239], v[24:27]
    ds_read_b64_tr_b16 v[120:121], v245 offset:41216
    ds_read_b64_tr_b16 v[122:123], v245 offset:41728
    v_mfma_f32_16x16x32_bf16 v[28:31], v[140:143], v[236:239], v[28:31]
    ds_read_b64_tr_b16 v[124:125], v246 offset:41216
    ds_read_b64_tr_b16 v[126:127], v246 offset:41728
    v_mfma_f32_16x16x32_bf16 v[32:35], v[144:147], v[236:239], v[32:35]
    ds_read_b64_tr_b16 v[128:129], v247 offset:41216
    ds_read_b64_tr_b16 v[130:131], v247 offset:41728
    s_waitcnt vmcnt(5)
k2_c28:
    v_max3_u32 v10, v212, v213, v214
    v_max_u32 v10, v10, v215
    v_cmp_eq_u32 vcc, -1, v10
    s_nop 0
    s_cbranch_vccnz k2_r28
k2_o28:
    s_add_u32 s40, s23, 17408
    s_sub_u32 s39, s40, 43008
    s_cselect_b32 s40, s40, s39
    s_add_u32 s39, s46, s40
    buffer_load_dwordx4 v[236:239], v17, s[48:51], s39 offen
    v_mfma_f32_16x16x32_bf16 v[20:23], v[148:151], v[212:215], v[20:23]
    s_waitcnt lgkmcnt(7)
    ds_read_b64_tr_b16 v[132:133], v240 offset:49280
    ds_read_b64_tr_b16 v[134:135], v240 offset:49792
    v_mfma_f32_16x16x32_bf16 v[24:27], v[152:155], v[212:215], v[24:27]
    ds_read_b64_tr_b16 v[136:137], v241 offset:49280
    ds_read_b64_tr_b16 v[138:139], v241 offset:49792
    v_mfma_f32_16x16x32_bf16 v[28:31], v[156:159], v[212:215], v[28:31]
    ds_read_b64_tr_b16 v[140:141], v242 offset:49280
    ds_read_b64_tr_b16 v[142:143], v242 offset:49792
    v_mfma_f32_16x16x32_bf16 v[32:35], v[160:163], v[212:215], v[32:35]
    ds_read_b64_tr_b16 v[144:145], v243 offset:49280
    ds_read_b64_tr_b16 v[146:147], v243 offset:49792
    s_waitcnt vmcnt(5)
k2_c29:
    v_max3_u32 v10, v216, v217, v218
    v_max_u32 v10, v10, v219
    v_cmp_eq_u32 vcc, -1, v10
    s_nop 0
    s_cbranch_vccnz k2_r29
k2_o29:
    s_add_u32 s40, s23, 20480
    s_sub_u32 s39, s40, 43008
    s_cselect_b32 s40, s40, s39
    s_add_u32 s39, s46, s40
    buffer_load_dwordx4 v[212:215], v17, s[48:51], s39 offen
    v_mfma_f32_16x16x32_bf16 v[20:23], v[164:167], v[216:219], v[20:23]
    s_waitcnt lgkmcnt(7)
    ds_read_b64_tr_b16 v[148:149], v240 offset:53376
    ds_read_b64_tr_b16 v[150:151], v240 offset:53888
    v_mfma_f32_16x16x32_bf16 v[24:27], v[168:171], v[216:219], v[24:27]
    ds_read_b64_tr_b16 v[152:153], v241 offset:53376
    ds_read_b64_tr_b16 v[154:155], v241 offset:53888
    v_mfma_f32_16x16x32_bf16 v[28:31], v[172:175], v[216:219], v[28:31]
    ds_read_b64_tr_b16 v[156:157], v242 offset:53376
    ds_read_b64_tr_b16 v[158:159], v242 offset:53888
    v_mfma_f32_16x16x32_bf16 v[32:35], v[176:179], v[216:219], v[32:35]
    ds_read_b64_tr_b16 v[160:161], v243 offset:53376
    ds_read_b64_tr_b16 v[162:163], v243 offset:53888
    s_waitcnt vmcnt(5)
k2_c30:
    v_max3_u32 v10, v220, v221, v222
    v_max_u32 v10, v10, v223
    v_cmp_eq_u32 vcc, -1, v10
    s_nop 0
    s_cbranch_vccnz k2_r30
k2_o30:
    s_add_u32 s40, s23, 23552
    s_sub_u32 s39, s40, 43008
    s_cselect_b32 s40, s40, s39
    s_add_u32 s39, s46, s40
    buffer_load_dwordx4 v[216:219], v17, s[48:51], s39 offen
    v_mfma_f32_16x16x32_bf16 v[20:23], v[180:183], v[220:223], v[20:23]
    s_waitcnt lgkmcnt(7)
    ds_read_b64_tr_b16 v[164:165], v240 offset:57472
    ds_read_b64_tr_b16 v[166:167], v240 offset:57984
    v_mfma_f32_16x16x32_bf16 v[24:27], v[184:187], v[220:223], v[24:27]
    ds_read_b64_tr_b16 v[168:169], v241 offset:57472
    ds_read_b64_tr_b16 v[170:171], v241 offset:57984
    v_mfma_f32_16x16x32_bf16 v[28:31], v[188:191], v[220:223], v[28:31]
    ds_read_b64_tr_b16 v[172:173], v242 offset:57472
    ds_read_b64_tr_b16 v[174:175], v242 offset:57984
    v_mfma_f32_16x16x32_bf16 v[32:35], v[192:195], v[220:223], v[32:35]
    ds_read_b64_tr_b16 v[176:177], v243 offset:57472
    ds_read_b64_tr_b16 v[178:179], v243 offset:57984
    s_waitcnt vmcnt(5)
k2_c31:
    v_max3_u32 v10, v224, v225, v226
    v_max_u32 v10, v10, v227
    v_cmp_eq_u32 vcc, -1, v10
    s_nop 0
    s_cbranch_vccnz k2_r31
k2_o31:
    s_add_u32 s40, s23, 26624
    s_sub_u32 s39, s40, 43008
    s_cselect_b32 s40, s40, s39
    s_add_u32 s39, s46, s40
    buffer_load_dwordx4 v[220:223], v17, s[48:51], s39 offen
    v_mfma_f32_16x16x32_bf16 v[20:23], v[196:199], v[224:227], v[20:23]
    s_waitcnt lgkmcnt(7)
    ds_read_b64_tr_b16 v[180:181], v248 offset:16704
    ds_read_b64_tr_b16 v[182:183], v248 offset:17216
    v_mfma_f32_16x16x32_bf16 v[24:27], v[200:203], v[224:227], v[24:27]
    ds_read_b64_tr_b16 v[184:185], v249 offset:16704
    ds_read_b64_tr_b16 v[186:187], v249 offset:17216
    v_mfma_f32_16x16x32_bf16 v[28:31], v[204:207], v[224:227], v[28:31]
    ds_read_b64_tr_b16 v[188:189], v250 offset:16704
    ds_read_b64_tr_b16 v[190:191], v250 offset:17216
    v_mfma_f32_16x16x32_bf16 v[32:35], v[208:211], v[224:227], v[32:35]
    ds_read_b64_tr_b16 v[192:193], v251 offset:16704
    ds_read_b64_tr_b16 v[194:195], v251 offset:17216
    s_waitcnt vmcnt(5)
k2_c32:
    v_max3_u32 v10, v228, v229, v230
    v_max_u32 v10, v10, v231
    v_cmp_eq_u32 vcc, -1, v10
    s_nop 0
    s_cbranch_vccnz k2_r32
k2_o32:
    s_add_u32 s40, s23, 29696
    s_sub_u32 s39, s40, 43008
    s_cselect_b32 s40, s40, s39
    s_add_u32 s39, s46, s40
    buffer_load_dwordx4 v[224:227], v17, s[48:51], s39 offen
    v_mfma_f32_16x16x32_bf16 v[20:23], v[36:39], v[228:231], v[20:23]
    s_waitcnt lgkmcnt(7)
    ds_read_b64_tr_b16 v[196:197], v248 offset:20800
    ds_read_b64_tr_b16 v[198:199], v248 offset:21312
    v_mfma_f32_16x16x32_bf16 v[24:27], v[40:43], v[228:231], v[24:27]
    ds_read_b64_tr_b16 v[200:201], v249 offset:20800
    ds_read_b64_tr_b16 v[202:203], v249 offset:21312
    v_mfma_f32_16x16x32_bf16 v[28:31], v[44:47], v[228:231], v[28:31]
    ds_read_b64_tr_b16 v[204:205], v250 offset:20800
    ds_read_b64_tr_b16 v[206:207], v250 offset:21312
    v_mfma_f32_16x16x32_bf16 v[32:35], v[48:51], v[228:231], v[32:35]
    ds_read_b64_tr_b16 v[208:209], v251 offset:20800
    ds_read_b64_tr_b16 v[210:211], v251 offset:21312
    s_waitcnt vmcnt(5)
k2_c33:
    v_max3_u32 v10, v232, v233, v234
    v_max_u32 v10, v10, v235
    v_cmp_eq_u32 vcc, -1, v10
    s_nop 0
    s_cbranch_vccnz k2_r33
k2_o33:
    s_add_u32 s40, s23, 32768
    s_sub_u32 s39, s40, 43008
    s_cselect_b32 s40, s40, s39
    s_add_u32 s39, s46, s40
    buffer_load_dwordx4 v[228:231], v17, s[48:51], s39 offen
    v_mfma_f32_16x16x32_bf16 v[20:23], v[52:55], v[232:235], v[20:23]
    v_mfma_f32_16x16x32_bf16 v[24:27], v[56:59], v[232:235], v[24:27]
    v_mfma_f32_16x16x32_bf16 v[28:31], v[60:63], v[232:235], v[28:31]
    v_mfma_f32_16x16x32_bf16 v[32:35], v[64:67], v[232:235], v[32:35]
    s_waitcnt vmcnt(5)
k2_c34:
    v_max3_u32 v10, v236, v237, v238
    v_max_u32 v10, v10, v239
    v_cmp_eq_u32 vcc, -1, v10
    s_nop 0
    s_cbranch_vccnz k2_r34
k2_o34:
    s_add_u32 s40, s23, 35840
    s_sub_u32 s39, s40, 43008
    s_cselect_b32 s40, s40, s39
    s_add_u32 s39, s46, s40
    buffer_load_dwordx4 v[232:235], v17, s[48:51], s39 offen
    v_mfma_f32_16x16x32_bf16 v[20:23], v[68:71], v[236:239], v[20:23]
    v_mfma_f32_16x16x32_bf16 v[24:27], v[72:75], v[236:239], v[24:27]
    v_mfma_f32_16x16x32_bf16 v[28:31], v[76:79], v[236:239], v[28:31]
    v_mfma_f32_16x16x32_bf16 v[32:35], v[80:83], v[236:239], v[32:35]
    s_waitcnt vmcnt(5)
k2_c35:
    v_max3_u32 v10, v212, v213, v214
    v_max_u32 v10, v10, v215
    v_cmp_eq_u32 vcc, -1, v10
    s_nop 0
    s_cbranch_vccnz k2_r35
k2_o35:
    s_add_u32 s40, s23, 38912
    s_sub_u32 s39, s40, 43008
    s_cselect_b32 s40, s40, s39
    s_add_u32 s39, s46, s40
    buffer_load_dwordx4 v[236:239], v17, s[48:51], s39 offen
    v_mfma_f32_16x16x32_bf16 v[20:23], v[84:87], v[212:215], v[20:23]
    v_mfma_f32_16x16x32_bf16 v[24:27], v[88:91], v[212:215], v[24:27]
    v_mfma_f32_16x16x32_bf16 v[28:31], v[92:95], v[212:215], v[28:31]
    v_mfma_f32_16x16x32_bf16 v[32:35], v[96:99], v[212:215], v[32:35]
    s_waitcnt vmcnt(5)
k2_c36:
    v_max3_u32 v10, v216, v217, v218
    v_max_u32 v10, v10, v219
    v_cmp_eq_u32 vcc, -1, v10
    s_nop 0
    s_cbranch_vccnz k2_r36
k2_o36:
    s_add_u32 s40, s23, 41984
    s_sub_u32 s39, s40, 43008
    s_cselect_b32 s40, s40, s39
    s_add_u32 s39, s46, s40
    buffer_load_dwordx4 v[212:215], v17, s[48:51], s39 offen
    v_mfma_f32_16x16x32_bf16 v[20:23], v[100:103], v[216:219], v[20:23]
    v_mfma_f32_16x16x32_bf16 v[24:27], v[104:107], v[216:219], v[24:27]
    v_mfma_f32_16x16x32_bf16 v[28:31], v[108:111], v[216:219], v[28:31]
    v_mfma_f32_16x16x32_bf16 v[32:35], v[112:115], v[216:219], v[32:35]
    s_waitcnt vmcnt(5)
k2_c37:
    v_max3_u32 v10, v220, v221, v222
    v_max_u32 v10, v10, v223
    v_cmp_eq_u32 vcc, -1, v10
    s_nop 0
    s_cbranch_vccnz k2_r37
k2_o37:
    v_mfma_f32_16x16x32_bf16 v[20:23], v[116:119], v[220:223], v[20:23]
    v_mfma_f32_16x16x32_bf16 v[24:27], v[120:123], v[220:223], v[24:27]
    v_mfma_f32_16x16x32_bf16 v[28:31], v[124:127], v[220:223], v[28:31]
    v_mfma_f32_16x16x32_bf16 v[32:35], v[128:131], v[220:223], v[32:35]
    s_waitcnt vmcnt(4)
k2_c38:
    v_max3_u32 v10, v224, v225, v226
    v_max_u32 v10, v10, v227
    v_cmp_eq_u32 vcc, -1, v10
    s_nop 0
    s_cbranch_vccnz k2_r38
k2_o38:
    v_mfma_f32_16x16x32_bf16 v[20:23], v[132:135], v[224:227], v[20:23]
    v_mfma_f32_16x16x32_bf16 v[24:27], v[136:139], v[224:227], v[24:27]
    v_mfma_f32_16x16x32_bf16 v[28:31], v[140:143], v[224:227], v[28:31]
    v_mfma_f32_16x16x32_bf16 v[32:35], v[144:147], v[224:227], v[32:35]
    s_waitcnt vmcnt(3)
k2_c39:
    v_max3_u32 v10, v228, v229, v230
    v_max_u32 v10, v10, v231
    v_cmp_eq_u32 vcc, -1, v10
    s_nop 0
    s_cbranch_vccnz k2_r39
k2_o39:
    v_mfma_f32_16x16x32_bf16 v[20:23], v[148:151], v[228:231], v[20:23]
    v_mfma_f32_16x16x32_bf16 v[24:27], v[152:155], v[228:231], v[24:27]
    v_mfma_f32_16x16x32_bf16 v[28:31], v[156:159], v[228:231], v[28:31]
    v_mfma_f32_16x16x32_bf16 v[32:35], v[160:163], v[228:231], v[32:35]
    s_waitcnt vmcnt(2)
k2_c40:
    v_max3_u32 v10, v232, v233, v234
    v_max_u32 v10, v10, v235
    v_cmp_eq_u32 vcc, -1, v10
    s_nop 0
    s_cbranch_vccnz k2_r40
k2_o40:
    v_mfma_f32_16x16x32_bf16 v[20:23], v[164:167], v[232:235], v[20:23]
    v_mfma_f32_16x16x32_bf16 v[24:27], v[168:171], v[232:235], v[24:27]
    v_mfma_f32_16x16x32_bf16 v[28:31], v[172:175], v[232:235], v[28:31]
    v_mfma_f32_16x16x32_bf16 v[32:35], v[176:179], v[232:235], v[32:35]
    s_waitcnt vmcnt(1) lgkmcnt(8)
k2_c41:
    v_max3_u32 v10, v236, v237, v238
    v_max_u32 v10, v10, v239
    v_cmp_eq_u32 vcc, -1, v10
    s_nop 0
    s_cbranch_vccnz k2_r41
k2_o41:
    v_mfma_f32_16x16x32_bf16 v[20:23], v[180:183], v[236:239], v[20:23]
    v_mfma_f32_16x16x32_bf16 v[24:27], v[184:187], v[236:239], v[24:27]
    v_mfma_f32_16x16x32_bf16 v[28:31], v[188:191], v[236:239], v[28:31]
    v_mfma_f32_16x16x32_bf16 v[32:35], v[192:195], v[236:239], v[32:35]
    s_waitcnt vmcnt(0) lgkmcnt(0)
k2_c42:
    v_max3_u32 v10, v212, v213, v214
    v_max_u32 v10, v10, v215
    v_cmp_eq_u32 vcc, -1, v10
    s_nop 0
    s_cbranch_vccnz k2_r42
k2_o42:
    v_mfma_f32_16x16x32_bf16 v[20:23], v[196:199], v[212:215], v[20:23]
    v_mfma_f32_16x16x32_bf16 v[24:27], v[200:203], v[212:215], v[24:27]
    v_mfma_f32_16x16x32_bf16 v[28:31], v[204:207], v[212:215], v[28:31]
    v_mfma_f32_16x16x32_bf16 v[32:35], v[208:211], v[212:215], v[32:35]
    s_nop 4
    ds_write_b128 v19, v[20:23] offset:0
    ds_write_b128 v19, v[24:27] offset:1024
    s_waitcnt lgkmcnt(0)
    s_barrier
    ds_read_b128 v[36:39], v19 offset:2048
    ds_read_b128 v[40:43], v19 offset:3072
    s_waitcnt lgkmcnt(1)
    v_pk_add_f32 v[28:29], v[28:29], v[36:37]
    v_pk_add_f32 v[30:31], v[30:31], v[38:39]
    v_cvt_pk_bf16_f32 v44, v28, v29
    v_cvt_pk_bf16_f32 v45, v30, v31
    buffer_store_dwordx2 v[44:45], v18, s[60:63], s44 offen offset:64
    s_waitcnt lgkmcnt(0)
    v_pk_add_f32 v[32:33], v[32:33], v[40:41]
    v_pk_add_f32 v[34:35], v[34:35], v[42:43]
    v_cvt_pk_bf16_f32 v46, v32, v33
    v_cvt_pk_bf16_f32 v47, v34, v35
    buffer_store_dwordx2 v[46:47], v18, s[60:63], s44 offen offset:96
    s_endpgm
k2_sig0:
    v_mov_b32 v9, 1
    s_mov_b64 exec, 1
    ds_add_u32 v8, v9 offset:4
    s_mov_b64 exec, -1
    s_branch k2_cw_6_e
k2_cw_6:
    s_sleep 1
k2_cw_6_e:
    ds_read_b32 v9, v8 offset:4
    s_waitcnt lgkmcnt(0)
    v_cmp_gt_u32 vcc, 4, v9
    s_nop 0
    s_cbranch_vccnz k2_cw_6
    s_branch k2_sig
k2_r0:
    s_add_u32 s17, s17, 1
    s_cmp_ge_u32 s17, 65536
    s_cbranch_scc1 k2_o0
    s_add_u32 s40, s23, 0
    s_sub_u32 s39, s40, 43008
    s_cselect_b32 s40, s40, s39
    s_add_u32 s39, s46, s40
    buffer_load_dwordx4 v[212:215], v17, s[48:51], s39 offen sc0 sc1
    s_add_u32 s40, s23, 1024
    s_sub_u32 s39, s40, 43008
    s_cselect_b32 s40, s40, s39
    s_add_u32 s39, s46, s40
    buffer_load_dwordx4 v[216:219], v17, s[48:51], s39 offen sc0 sc1
    s_waitcnt vmcnt(0)
    s_branch k2_c0
k2_r1:
    s_add_u32 s17, s17, 1
    s_cmp_ge_u32 s17, 65536
    s_cbranch_scc1 k2_o1
    s_add_u32 s40, s23, 1024
    s_sub_u32 s39, s40, 43008
    s_cselect_b32 s40, s40, s39
    s_add_u32 s39, s46, s40
    buffer_load_dwordx4 v[216:219], v17, s[48:51], s39 offen sc0 sc1
    s_add_u32 s40, s23, 3072
    s_sub_u32 s39, s40, 43008
    s_cselect_b32 s40, s40, s39
    s_add_u32 s39, s46, s40
    buffer_load_dwordx4 v[220:223], v17, s[48:51], s39 offen sc0 sc1
    s_waitcnt vmcnt(0)
    s_branch k2_c1
k2_r2:
    s_add_u32 s17, s17, 1
    s_cmp_ge_u32 s17, 65536
    s_cbranch_scc1 k2_o2
    s_add_u32 s40, s23, 3072
    s_sub_u32 s39, s40, 43008
    s_cselect_b32 s40, s40, s39
    s_add_u32 s39, s46, s40
    buffer_load_dwordx4 v[220:223], v17, s[48:51], s39 offen sc0 sc1
    s_add_u32 s40, s23, 4096
    s_sub_u32 s39, s40, 43008
    s_cselect_b32 s40, s40, s39
    s_add_u32 s39, s46, s40
    buffer_load_dwordx4 v[224:227], v17, s[48:51], s39 offen sc0 sc1
    s_waitcnt vmcnt(0)
    s_branch k2_c2
k2_r3:
    s_add_u32 s17, s17, 1
    s_cmp_ge_u32 s17, 65536
    s_cbranch_scc1 k2_o3
    s_add_u32 s40, s23, 4096
    s_sub_u32 s39, s40, 43008
    s_cselect_b32 s40, s40, s39
    s_add_u32 s39, s46, s40
    buffer_load_dwordx4 v[224:227], v17, s[48:51], s39 offen sc0 sc1
    s_add_u32 s40, s23, 6144
    s_sub_u32 s39, s40, 43008
    s_cselect_b32 s40, s40, s39
    s_add_u32 s39, s46, s40
    buffer_load_dwordx4 v[228:231], v17, s[48:51], s39 offen sc0 sc1
    s_waitcnt vmcnt(0)
    s_branch k2_c3
k2_r4:
    s_add_u32 s17, s17, 1
    s_cmp_ge_u32 s17, 65536
    s_cbranch_scc1 k2_o4
    s_add_u32 s40, s23, 6144
    s_sub_u32 s39, s40, 43008
    s_cselect_b32 s40, s40, s39
    s_add_u32 s39, s46, s40
    buffer_load_dwordx4 v[228:231], v17, s[48:51], s39 offen sc0 sc1
    s_add_u32 s40, s23, 7168
    s_sub_u32 s39, s40, 43008
    s_cselect_b32 s40, s40, s39
    s_add_u32 s39, s46, s40
    buffer_load_dwordx4 v[232:235], v17, s[48:51], s39 offen sc0 sc1
    s_waitcnt vmcnt(0)
    s_branch k2_c4
k2_r5:
    s_add_u32 s17, s17, 1
    s_cmp_ge_u32 s17, 65536
    s_cbranch_scc1 k2_o5
    s_add_u32 s40, s23, 7168
    s_sub_u32 s39, s40, 43008
    s_cselect_b32 s40, s40, s39
    s_add_u32 s39, s46, s40
    buffer_load_dwordx4 v[232:235], v17, s[48:51], s39 offen sc0 sc1
    s_add_u32 s40, s23, 9216
    s_sub_u32 s39, s40, 43008
    s_cselect_b32 s40, s40, s39
    s_add_u32 s39, s46, s40
    buffer_load_dwordx4 v[236:239], v17, s[48:51], s39 offen sc0 sc1
    s_waitcnt vmcnt(0)
    s_branch k2_c5
k2_r6:
    s_add_u32 s17, s17, 1
    s_cmp_ge_u32 s17, 65536
    s_cbranch_scc1 k2_o6
    s_add_u32 s40, s23, 9216
    s_sub_u32 s39, s40, 43008
    s_cselect_b32 s40, s40, s39
    s_add_u32 s39, s46, s40
    buffer_load_dwordx4 v[236:239], v17, s[48:51], s39 offen sc0 sc1
    s_add_u32 s40, s23, 10240
    s_sub_u32 s39, s40, 43008
    s_cselect_b32 s40, s40, s39
    s_add_u32 s39, s46, s40
    buffer_load_dwordx4 v[212:215], v17, s[48:51], s39 offen sc0 sc1
    s_waitcnt vmcnt(0)
    s_branch k2_c6
k2_r7:
    s_add_u32 s17, s17, 1
    s_cmp_ge_u32 s17, 65536
    s_cbranch_scc1 k2_o7
    s_add_u32 s40, s23, 10240
    s_sub_u32 s39, s40, 43008
    s_cselect_b32 s40, s40, s39
    s_add_u32 s39, s46, s40
    buffer_load_dwordx4 v[212:215], v17, s[48:51], s39 offen sc0 sc1
    s_add_u32 s40, s23, 12288
    s_sub_u32 s39, s40, 43008
    s_cselect_b32 s40, s40, s39
    s_add_u32 s39, s46, s40
    buffer_load_dwordx4 v[216:219], v17, s[48:51], s39 offen sc0 sc1
    s_waitcnt vmcnt(0)
    s_branch k2_c7
k2_r8:
    s_add_u32 s17, s17, 1
    s_cmp_ge_u32 s17, 65536
    s_cbranch_scc1 k2_o8
    s_add_u32 s40, s23, 12288
    s_sub_u32 s39, s40, 43008
    s_cselect_b32 s40, s40, s39
    s_add_u32 s39, s46, s40
    buffer_load_dwordx4 v[216:219], v17, s[48:51], s39 offen sc0 sc1
    s_add_u32 s40, s23, 13312
    s_sub_u32 s39, s40, 43008
    s_cselect_b32 s40, s40, s39
    s_add_u32 s39, s46, s40
    buffer_load_dwordx4 v[220:223], v17, s[48:51], s39 offen sc0 sc1
    s_waitcnt vmcnt(0)
    s_branch k2_c8
k2_r9:
    s_add_u32 s17, s17, 1
    s_cmp_ge_u32 s17, 65536
    s_cbranch_scc1 k2_o9
    s_add_u32 s40, s23, 13312
    s_sub_u32 s39, s40, 43008
    s_cselect_b32 s40, s40, s39
    s_add_u32 s39, s46, s40
    buffer_load_dwordx4 v[220:223], v17, s[48:51], s39 offen sc0 sc1
    s_add_u32 s40, s23, 15360
    s_sub_u32 s39, s40, 43008
    s_cselect_b32 s40, s40, s39
    s_add_u32 s39, s46, s40
    buffer_load_dwordx4 v[224:227], v17, s[48:51], s39 offen sc0 sc1
    s_waitcnt vmcnt(0)
    s_branch k2_c9
k2_r10:
    s_add_u32 s17, s17, 1
    s_cmp_ge_u32 s17, 65536
    s_cbranch_scc1 k2_o10
    s_add_u32 s40, s23, 15360
    s_sub_u32 s39, s40, 43008
    s_cselect_b32 s40, s40, s39
    s_add_u32 s39, s46, s40
    buffer_load_dwordx4 v[224:227], v17, s[48:51], s39 offen sc0 sc1
    s_add_u32 s40, s23, 16384
    s_sub_u32 s39, s40, 43008
    s_cselect_b32 s40, s40, s39
    s_add_u32 s39, s46, s40
    buffer_load_dwordx4 v[228:231], v17, s[48:51], s39 offen sc0 sc1
    s_waitcnt vmcnt(0)
    s_branch k2_c10
k2_r11:
    s_add_u32 s17, s17, 1
    s_cmp_ge_u32 s17, 65536
    s_cbranch_scc1 k2_o11
    s_add_u32 s40, s23, 16384
    s_sub_u32 s39, s40, 43008
    s_cselect_b32 s40, s40, s39
    s_add_u32 s39, s46, s40
    buffer_load_dwordx4 v[228:231], v17, s[48:51], s39 offen sc0 sc1
    s_add_u32 s40, s23, 18432
    s_sub_u32 s39, s40, 43008
    s_cselect_b32 s40, s40, s39
    s_add_u32 s39, s46, s40
    buffer_load_dwordx4 v[232:235], v17, s[48:51], s39 offen sc0 sc1
    s_waitcnt vmcnt(0)
    s_branch k2_c11
k2_r12:
    s_add_u32 s17, s17, 1
    s_cmp_ge_u32 s17, 65536
    s_cbranch_scc1 k2_o12
    s_add_u32 s40, s23, 18432
    s_sub_u32 s39, s40, 43008
    s_cselect_b32 s40, s40, s39
    s_add_u32 s39, s46, s40
    buffer_load_dwordx4 v[232:235], v17, s[48:51], s39 offen sc0 sc1
    s_add_u32 s40, s23, 19456
    s_sub_u32 s39, s40, 43008
    s_cselect_b32 s40, s40, s39
    s_add_u32 s39, s46, s40
    buffer_load_dwordx4 v[236:239], v17, s[48:51], s39 offen sc0 sc1
    s_waitcnt vmcnt(0)
    s_branch k2_c12
k2_r13:
    s_add_u32 s17, s17, 1
    s_cmp_ge_u32 s17, 65536
    s_cbranch_scc1 k2_o13
    s_add_u32 s40, s23, 19456
    s_sub_u32 s39, s40, 43008
    s_cselect_b32 s40, s40, s39
    s_add_u32 s39, s46, s40
    buffer_load_dwordx4 v[236:239], v17, s[48:51], s39 offen sc0 sc1
    s_add_u32 s40, s23, 21504
    s_sub_u32 s39, s40, 43008
    s_cselect_b32 s40, s40, s39
    s_add_u32 s39, s46, s40
    buffer_load_dwordx4 v[212:215], v17, s[48:51], s39 offen sc0 sc1
    s_waitcnt vmcnt(0)
    s_branch k2_c13
k2_r14:
    s_add_u32 s17, s17, 1
    s_cmp_ge_u32 s17, 65536
    s_cbranch_scc1 k2_o14
    s_add_u32 s40, s23, 21504
    s_sub_u32 s39, s40, 43008
    s_cselect_b32 s40, s40, s39
    s_add_u32 s39, s46, s40
    buffer_load_dwordx4 v[212:215], v17, s[48:51], s39 offen sc0 sc1
    s_add_u32 s40, s23, 22528
    s_sub_u32 s39, s40, 43008
    s_cselect_b32 s40, s40, s39
    s_add_u32 s39, s46, s40
    buffer_load_dwordx4 v[216:219], v17, s[48:51], s39 offen sc0 sc1
    s_waitcnt vmcnt(0)
    s_branch k2_c14
k2_r15:
    s_add_u32 s17, s17, 1
    s_cmp_ge_u32 s17, 65536
    s_cbranch_scc1 k2_o15
    s_add_u32 s40, s23, 22528
    s_sub_u32 s39, s40, 43008
    s_cselect_b32 s40, s40, s39
    s_add_u32 s39, s46, s40
    buffer_load_dwordx4 v[216:219], v17, s[48:51], s39 offen sc0 sc1
    s_add_u32 s40, s23, 24576
    s_sub_u32 s39, s40, 43008
    s_cselect_b32 s40, s40, s39
    s_add_u32 s39, s46, s40
    buffer_load_dwordx4 v[220:223], v17, s[48:51], s39 offen sc0 sc1
    s_waitcnt vmcnt(0)
    s_branch k2_c15
k2_r16:
    s_add_u32 s17, s17, 1
    s_cmp_ge_u32 s17, 65536
    s_cbranch_scc1 k2_o16
    s_add_u32 s40, s23, 24576
    s_sub_u32 s39, s40, 43008
    s_cselect_b32 s40, s40, s39
    s_add_u32 s39, s46, s40
    buffer_load_dwordx4 v[220:223], v17, s[48:51], s39 offen sc0 sc1
    s_add_u32 s40, s23, 25600
    s_sub_u32 s39, s40, 43008
    s_cselect_b32 s40, s40, s39
    s_add_u32 s39, s46, s40
    buffer_load_dwordx4 v[224:227], v17, s[48:51], s39 offen sc0 sc1
    s_waitcnt vmcnt(0)
    s_branch k2_c16
k2_r17:
    s_add_u32 s17, s17, 1
    s_cmp_ge_u32 s17, 65536
    s_cbranch_scc1 k2_o17
    s_add_u32 s40, s23, 25600
    s_sub_u32 s39, s40, 43008
    s_cselect_b32 s40, s40, s39
    s_add_u32 s39, s46, s40
    buffer_load_dwordx4 v[224:227], v17, s[48:51], s39 offen sc0 sc1
    s_add_u32 s40, s23, 27648
    s_sub_u32 s39, s40, 43008
    s_cselect_b32 s40, s40, s39
    s_add_u32 s39, s46, s40
    buffer_load_dwordx4 v[228:231], v17, s[48:51], s39 offen sc0 sc1
    s_waitcnt vmcnt(0)
    s_branch k2_c17
k2_r18:
    s_add_u32 s17, s17, 1
    s_cmp_ge_u32 s17, 65536
    s_cbranch_scc1 k2_o18
    s_add_u32 s40, s23, 27648
    s_sub_u32 s39, s40, 43008
    s_cselect_b32 s40, s40, s39
    s_add_u32 s39, s46, s40
    buffer_load_dwordx4 v[228:231], v17, s[48:51], s39 offen sc0 sc1
    s_add_u32 s40, s23, 28672
    s_sub_u32 s39, s40, 43008
    s_cselect_b32 s40, s40, s39
    s_add_u32 s39, s46, s40
    buffer_load_dwordx4 v[232:235], v17, s[48:51], s39 offen sc0 sc1
    s_waitcnt vmcnt(0)
    s_branch k2_c18
k2_r19:
    s_add_u32 s17, s17, 1
    s_cmp_ge_u32 s17, 65536
    s_cbranch_scc1 k2_o19
    s_add_u32 s40, s23, 28672
    s_sub_u32 s39, s40, 43008
    s_cselect_b32 s40, s40, s39
    s_add_u32 s39, s46, s40
    buffer_load_dwordx4 v[232:235], v17, s[48:51], s39 offen sc0 sc1
    s_add_u32 s40, s23, 30720
    s_sub_u32 s39, s40, 43008
    s_cselect_b32 s40, s40, s39
    s_add_u32 s39, s46, s40
    buffer_load_dwordx4 v[236:239], v17, s[48:51], s39 offen sc0 sc1
    s_waitcnt vmcnt(0)
    s_branch k2_c19
k2_r20:
    s_add_u32 s17, s17, 1
    s_cmp_ge_u32 s17, 65536
    s_cbranch_scc1 k2_o20
    s_add_u32 s40, s23, 30720
    s_sub_u32 s39, s40, 43008
    s_cselect_b32 s40, s40, s39
    s_add_u32 s39, s46, s40
    buffer_load_dwordx4 v[236:239], v17, s[48:51], s39 offen sc0 sc1
    s_waitcnt vmcnt(0)
    s_branch k2_c20
k2_r21:
    s_add_u32 s17, s17, 1
    s_cmp_ge_u32 s17, 65536
    s_cbranch_scc1 k2_o21
    s_add_u32 s40, s23, 31744
    s_sub_u32 s39, s40, 43008
    s_cselect_b32 s40, s40, s39
    s_add_u32 s39, s46, s40
    buffer_load_dwordx4 v[212:215], v17, s[48:51], s39 offen sc0 sc1
    s_add_u32 s40, s23, 33792
    s_sub_u32 s39, s40, 43008
    s_cselect_b32 s40, s40, s39
    s_add_u32 s39, s46, s40
    buffer_load_dwordx4 v[216:219], v17, s[48:51], s39 offen sc0 sc1
    s_waitcnt vmcnt(0)
    s_branch k2_c21
k2_r22:
    s_add_u32 s17, s17, 1
    s_cmp_ge_u32 s17, 65536
    s_cbranch_scc1 k2_o22
    s_add_u32 s40, s23, 33792
    s_sub_u32 s39, s40, 43008
    s_cselect_b32 s40, s40, s39
    s_add_u32 s39, s46, s40
    buffer_load_dwordx4 v[216:219], v17, s[48:51], s39 offen sc0 sc1
    s_add_u32 s40, s23, 34816
    s_sub_u32 s39, s40, 43008
    s_cselect_b32 s40, s40, s39
    s_add_u32 s39, s46, s40
    buffer_load_dwordx4 v[220:223], v17, s[48:51], s39 offen sc0 sc1
    s_waitcnt vmcnt(0)
    s_branch k2_c22
k2_r23:
    s_add_u32 s17, s17, 1
    s_cmp_ge_u32 s17, 65536
    s_cbranch_scc1 k2_o23
    s_add_u32 s40, s23, 34816
    s_sub_u32 s39, s40, 43008
    s_cselect_b32 s40, s40, s39
    s_add_u32 s39, s46, s40
    buffer_load_dwordx4 v[220:223], v17, s[48:51], s39 offen sc0 sc1
    s_add_u32 s40, s23, 36864
    s_sub_u32 s39, s40, 43008
    s_cselect_b32 s40, s40, s39
    s_add_u32 s39, s46, s40
    buffer_load_dwordx4 v[224:227], v17, s[48:51], s39 offen sc0 sc1
    s_waitcnt vmcnt(0)
    s_branch k2_c23
k2_r24:
    s_add_u32 s17, s17, 1
    s_cmp_ge_u32 s17, 65536
    s_cbranch_scc1 k2_o24
    s_add_u32 s40, s23, 36864
    s_sub_u32 s39, s40, 43008
    s_cselect_b32 s40, s40, s39
    s_add_u32 s39, s46, s40
    buffer_load_dwordx4 v[224:227], v17, s[48:51], s39 offen sc0 sc1
    s_add_u32 s40, s23, 37888
    s_sub_u32 s39, s40, 43008
    s_cselect_b32 s40, s40, s39
    s_add_u32 s39, s46, s40
    buffer_load_dwordx4 v[228:231], v17, s[48:51], s39 offen sc0 sc1
    s_waitcnt vmcnt(0)
    s_branch k2_c24
k2_r25:
    s_add_u32 s17, s17, 1
    s_cmp_ge_u32 s17, 65536
    s_cbranch_scc1 k2_o25
    s_add_u32 s40, s23, 37888
    s_sub_u32 s39, s40, 43008
    s_cselect_b32 s40, s40, s39
    s_add_u32 s39, s46, s40
    buffer_load_dwordx4 v[228:231], v17, s[48:51], s39 offen sc0 sc1
    s_add_u32 s40, s23, 39936
    s_sub_u32 s39, s40, 43008
    s_cselect_b32 s40, s40, s39
    s_add_u32 s39, s46, s40
    buffer_load_dwordx4 v[232:235], v17, s[48:51], s39 offen sc0 sc1
    s_waitcnt vmcnt(0)
    s_branch k2_c25
k2_r26:
    s_add_u32 s17, s17, 1
    s_cmp_ge_u32 s17, 65536
    s_cbranch_scc1 k2_o26
    s_add_u32 s40, s23, 39936
    s_sub_u32 s39, s40, 43008
    s_cselect_b32 s40, s40, s39
    s_add_u32 s39, s46, s40
    buffer_load_dwordx4 v[232:235], v17, s[48:51], s39 offen sc0 sc1
    s_add_u32 s40, s23, 40960
    s_sub_u32 s39, s40, 43008
    s_cselect_b32 s40, s40, s39
    s_add_u32 s39, s46, s40
    buffer_load_dwordx4 v[236:239], v17, s[48:51], s39 offen sc0 sc1
    s_waitcnt vmcnt(0)
    s_branch k2_c26
k2_r27:
    s_add_u32 s17, s17, 1
    s_cmp_ge_u32 s17, 65536
    s_cbranch_scc1 k2_o27
    s_add_u32 s40, s23, 40960
    s_sub_u32 s39, s40, 43008
    s_cselect_b32 s40, s40, s39
    s_add_u32 s39, s46, s40
    buffer_load_dwordx4 v[236:239], v17, s[48:51], s39 offen sc0 sc1
    s_mov_b32 s40, 43008
    s_add_u32 s39, s46, s40
    buffer_load_dwordx4 v[212:215], v17, s[48:51], s39 offen sc0 sc1
    s_waitcnt vmcnt(0)
    s_branch k2_c27
k2_r28:
    s_add_u32 s17, s17, 1
    s_cmp_ge_u32 s17, 65536
    s_cbranch_scc1 k2_o28
    s_mov_b32 s40, 43008
    s_add_u32 s39, s46, s40
    buffer_load_dwordx4 v[212:215], v17, s[48:51], s39 offen sc0 sc1
    s_add_u32 s40, s23, 2048
    s_sub_u32 s39, s40, 43008
    s_cselect_b32 s40, s40, s39
    s_add_u32 s39, s46, s40
    buffer_load_dwordx4 v[216:219], v17, s[48:51], s39 offen sc0 sc1
    s_waitcnt vmcnt(0)
    s_branch k2_c28
k2_r29:
    s_add_u32 s17, s17, 1
    s_cmp_ge_u32 s17, 65536
    s_cbranch_scc1 k2_o29
    s_add_u32 s40, s23, 2048
    s_sub_u32 s39, s40, 43008
    s_cselect_b32 s40, s40, s39
    s_add_u32 s39, s46, s40
    buffer_load_dwordx4 v[216:219], v17, s[48:51], s39 offen sc0 sc1
    s_add_u32 s40, s23, 5120
    s_sub_u32 s39, s40, 43008
    s_cselect_b32 s40, s40, s39
    s_add_u32 s39, s46, s40
    buffer_load_dwordx4 v[220:223], v17, s[48:51], s39 offen sc0 sc1
    s_waitcnt vmcnt(0)
    s_branch k2_c29
k2_r30:
    s_add_u32 s17, s17, 1
    s_cmp_ge_u32 s17, 65536
    s_cbranch_scc1 k2_o30
    s_add_u32 s40, s23, 5120
    s_sub_u32 s39, s40, 43008
    s_cselect_b32 s40, s40, s39
    s_add_u32 s39, s46, s40
    buffer_load_dwordx4 v[220:223], v17, s[48:51], s39 offen sc0 sc1
    s_add_u32 s40, s23, 8192
    s_sub_u32 s39, s40, 43008
    s_cselect_b32 s40, s40, s39
    s_add_u32 s39, s46, s40
    buffer_load_dwordx4 v[224:227], v17, s[48:51], s39 offen sc0 sc1
    s_waitcnt vmcnt(0)
    s_branch k2_c30
k2_r31:
    s_add_u32 s17, s17, 1
    s_cmp_ge_u32 s17, 65536
    s_cbranch_scc1 k2_o31
    s_add_u32 s40, s23, 8192
    s_sub_u32 s39, s40, 43008
    s_cselect_b32 s40, s40, s39
    s_add_u32 s39, s46, s40
    buffer_load_dwordx4 v[224:227], v17, s[48:51], s39 offen sc0 sc1
    s_add_u32 s40, s23, 11264
    s_sub_u32 s39, s40, 43008
    s_cselect_b32 s40, s40, s39
    s_add_u32 s39, s46, s40
    buffer_load_dwordx4 v[228:231], v17, s[48:51], s39 offen sc0 sc1
    s_waitcnt vmcnt(0)
    s_branch k2_c31
k2_r32:
    s_add_u32 s17, s17, 1
    s_cmp_ge_u32 s17, 65536
    s_cbranch_scc1 k2_o32
    s_add_u32 s40, s23, 11264
    s_sub_u32 s39, s40, 43008
    s_cselect_b32 s40, s40, s39
    s_add_u32 s39, s46, s40
    buffer_load_dwordx4 v[228:231], v17, s[48:51], s39 offen sc0 sc1
    s_add_u32 s40, s23, 14336
    s_sub_u32 s39, s40, 43008
    s_cselect_b32 s40, s40, s39
    s_add_u32 s39, s46, s40
    buffer_load_dwordx4 v[232:235], v17, s[48:51], s39 offen sc0 sc1
    s_waitcnt vmcnt(0)
    s_branch k2_c32
k2_r33:
    s_add_u32 s17, s17, 1
    s_cmp_ge_u32 s17, 65536
    s_cbranch_scc1 k2_o33
    s_add_u32 s40, s23, 14336
    s_sub_u32 s39, s40, 43008
    s_cselect_b32 s40, s40, s39
    s_add_u32 s39, s46, s40
    buffer_load_dwordx4 v[232:235], v17, s[48:51], s39 offen sc0 sc1
    s_add_u32 s40, s23, 17408
    s_sub_u32 s39, s40, 43008
    s_cselect_b32 s40, s40, s39
    s_add_u32 s39, s46, s40
    buffer_load_dwordx4 v[236:239], v17, s[48:51], s39 offen sc0 sc1
    s_waitcnt vmcnt(0)
    s_branch k2_c33
k2_r34:
    s_add_u32 s17, s17, 1
    s_cmp_ge_u32 s17, 65536
    s_cbranch_scc1 k2_o34
    s_add_u32 s40, s23, 17408
    s_sub_u32 s39, s40, 43008
    s_cselect_b32 s40, s40, s39
    s_add_u32 s39, s46, s40
    buffer_load_dwordx4 v[236:239], v17, s[48:51], s39 offen sc0 sc1
    s_add_u32 s40, s23, 20480
    s_sub_u32 s39, s40, 43008
    s_cselect_b32 s40, s40, s39
    s_add_u32 s39, s46, s40
    buffer_load_dwordx4 v[212:215], v17, s[48:51], s39 offen sc0 sc1
    s_waitcnt vmcnt(0)
    s_branch k2_c34
k2_r35:
    s_add_u32 s17, s17, 1
    s_cmp_ge_u32 s17, 65536
    s_cbranch_scc1 k2_o35
    s_add_u32 s40, s23, 20480
    s_sub_u32 s39, s40, 43008
    s_cselect_b32 s40, s40, s39
    s_add_u32 s39, s46, s40
    buffer_load_dwordx4 v[212:215], v17, s[48:51], s39 offen sc0 sc1
    s_add_u32 s40, s23, 23552
    s_sub_u32 s39, s40, 43008
    s_cselect_b32 s40, s40, s39
    s_add_u32 s39, s46, s40
    buffer_load_dwordx4 v[216:219], v17, s[48:51], s39 offen sc0 sc1
    s_waitcnt vmcnt(0)
    s_branch k2_c35
k2_r36:
    s_add_u32 s17, s17, 1
    s_cmp_ge_u32 s17, 65536
    s_cbranch_scc1 k2_o36
    s_add_u32 s40, s23, 23552
    s_sub_u32 s39, s40, 43008
    s_cselect_b32 s40, s40, s39
    s_add_u32 s39, s46, s40
    buffer_load_dwordx4 v[216:219], v17, s[48:51], s39 offen sc0 sc1
    s_add_u32 s40, s23, 26624
    s_sub_u32 s39, s40, 43008
    s_cselect_b32 s40, s40, s39
    s_add_u32 s39, s46, s40
    buffer_load_dwordx4 v[220:223], v17, s[48:51], s39 offen sc0 sc1
    s_waitcnt vmcnt(0)
    s_branch k2_c36
k2_r37:
    s_add_u32 s17, s17, 1
    s_cmp_ge_u32 s17, 65536
    s_cbranch_scc1 k2_o37
    s_add_u32 s40, s23, 26624
    s_sub_u32 s39, s40, 43008
    s_cselect_b32 s40, s40, s39
    s_add_u32 s39, s46, s40
    buffer_load_dwordx4 v[220:223], v17, s[48:51], s39 offen sc0 sc1
    s_add_u32 s40, s23, 29696
    s_sub_u32 s39, s40, 43008
    s_cselect_b32 s40, s40, s39
    s_add_u32 s39, s46, s40
    buffer_load_dwordx4 v[224:227], v17, s[48:51], s39 offen sc0 sc1
    s_waitcnt vmcnt(0)
    s_branch k2_c37
k2_r38:
    s_add_u32 s17, s17, 1
    s_cmp_ge_u32 s17, 65536
    s_cbranch_scc1 k2_o38
    s_add_u32 s40, s23, 29696
    s_sub_u32 s39, s40, 43008
    s_cselect_b32 s40, s40, s39
    s_add_u32 s39, s46, s40
    buffer_load_dwordx4 v[224:227], v17, s[48:51], s39 offen sc0 sc1
    s_add_u32 s40, s23, 32768
    s_sub_u32 s39, s40, 43008
    s_cselect_b32 s40, s40, s39
    s_add_u32 s39, s46, s40
    buffer_load_dwordx4 v[228:231], v17, s[48:51], s39 offen sc0 sc1
    s_waitcnt vmcnt(0)
    s_branch k2_c38
k2_r39:
    s_add_u32 s17, s17, 1
    s_cmp_ge_u32 s17, 65536
    s_cbranch_scc1 k2_o39
    s_add_u32 s40, s23, 32768
    s_sub_u32 s39, s40, 43008
    s_cselect_b32 s40, s40, s39
    s_add_u32 s39, s46, s40
    buffer_load_dwordx4 v[228:231], v17, s[48:51], s39 offen sc0 sc1
    s_add_u32 s40, s23, 35840
    s_sub_u32 s39, s40, 43008
    s_cselect_b32 s40, s40, s39
    s_add_u32 s39, s46, s40
    buffer_load_dwordx4 v[232:235], v17, s[48:51], s39 offen sc0 sc1
    s_waitcnt vmcnt(0)
    s_branch k2_c39
k2_r40:
    s_add_u32 s17, s17, 1
    s_cmp_ge_u32 s17, 65536
    s_cbranch_scc1 k2_o40
    s_add_u32 s40, s23, 35840
    s_sub_u32 s39, s40, 43008
    s_cselect_b32 s40, s40, s39
    s_add_u32 s39, s46, s40
    buffer_load_dwordx4 v[232:235], v17, s[48:51], s39 offen sc0 sc1
    s_add_u32 s40, s23, 38912
    s_sub_u32 s39, s40, 43008
    s_cselect_b32 s40, s40, s39
    s_add_u32 s39, s46, s40
    buffer_load_dwordx4 v[236:239], v17, s[48:51], s39 offen sc0 sc1
    s_waitcnt vmcnt(0)
    s_branch k2_c40
k2_r41:
    s_add_u32 s17, s17, 1
    s_cmp_ge_u32 s17, 65536
    s_cbranch_scc1 k2_o41
    s_add_u32 s40, s23, 38912
    s_sub_u32 s39, s40, 43008
    s_cselect_b32 s40, s40, s39
    s_add_u32 s39, s46, s40
    buffer_load_dwordx4 v[236:239], v17, s[48:51], s39 offen sc0 sc1
    s_add_u32 s40, s23, 41984
    s_sub_u32 s39, s40, 43008
    s_cselect_b32 s40, s40, s39
    s_add_u32 s39, s46, s40
    buffer_load_dwordx4 v[212:215], v17, s[48:51], s39 offen sc0 sc1
    s_waitcnt vmcnt(0)
    s_branch k2_c41
k2_r42:
    s_add_u32 s17, s17, 1
    s_cmp_ge_u32 s17, 65536
    s_cbranch_scc1 k2_o42
    s_add_u32 s40, s23, 41984
    s_sub_u32 s39, s40, 43008
    s_cselect_b32 s40, s40, s39
    s_add_u32 s39, s46, s40
    buffer_load_dwordx4 v[212:215], v17, s[48:51], s39 offen sc0 sc1
    s_waitcnt vmcnt(0)
    s_branch k2_c42
k2_stretry:
    s_add_u32 s17, s17, 1
    s_cmp_ge_u32 s17, 65536
    s_cbranch_scc1 k2_stok
    global_load_dwordx2 v[166:167], v170, s[30:31] sc0 sc1
    global_load_dwordx2 v[168:169], v170, s[30:31] offset:256 sc0 sc1
    buffer_load_dwordx4 v[208:211], v15, s[48:51], s20 offen sc0 sc1
    buffer_load_dwordx4 v[212:215], v15, s[48:51], s21 offen sc0 sc1
    buffer_load_dwordx4 v[216:219], v15, s[48:51], s22 offen sc0 sc1
    s_branch k2_stchk
k2_stats:
    s_sub_u32 s36, s36, 4
    s_mov_b32 s39, s55
    s_lshl_b32 s16, s36, 10
    v_bfe_u32 v10, v1, 4, 2
    v_lshlrev_b32 v10, 1, v10
    v_and_b32 v11, 7, v1
    v_xor_b32 v10, v10, v11
    v_lshlrev_b32 v10, 4, v10
    v_lshrrev_b32 v12, 3, v1
    v_lshl_add_u32 v7, v12, 8, v10
    s_lshl_b32 s47, s39, 7
    s_lshl_b32 s40, s36, 13
    s_add_u32 s47, s47, s40
    v_bfe_u32 v10, v1, 4, 1
    s_and_b32 s39, s36, 1
    s_lshl_b32 s39, s39, 1
    v_or_b32 v10, s39, v10
    v_lshlrev_b32 v10, 1, v10
    v_xor_b32 v10, v10, v11
    v_lshlrev_b32 v10, 4, v10
    v_lshl_add_u32 v3, v12, 10, v10
    s_mov_b32 s4, s24
    s_mov_b32 s5, s25
    s_mov_b32 s6, 1409024
    s_mov_b32 s7, 0x20000
    v_bfe_u32 v10, v1, 2, 2
    v_lshrrev_b32 v11, 4, v1
    v_lshl_add_u32 v12, v11, 3, v10
    v_lshlrev_b32 v12, 7, v12
    v_and_b32 v13, 3, v1
    v_lshl_add_u32 v12, v13, 3, v12
    v_lshrrev_b32 v14, 1, v10
    v_and_b32 v16, 1, v11
    v_lshl_or_b32 v14, v16, 1, v14
    v_xor_b32 v16, 0, v14
    v_lshl_add_u32 v240, v16, 5, v12
    v_add_u32 v244, 0xf000, v240
    v_add_u32 v248, 0x1e000, v240
    v_xor_b32 v16, 1, v14
    v_lshl_add_u32 v241, v16, 5, v12
    v_add_u32 v245, 0xf000, v241
    v_add_u32 v249, 0x1e000, v241
    v_xor_b32 v16, 2, v14
    v_lshl_add_u32 v242, v16, 5, v12
    v_add_u32 v246, 0xf000, v242
    v_add_u32 v250, 0x1e000, v242
    v_xor_b32 v16, 3, v14
    v_lshl_add_u32 v243, v16, 5, v12
    v_add_u32 v247, 0xf000, v243
    v_add_u32 v251, 0x1e000, v243
    v_lshl_add_u32 v15, v11, 2, v10
    v_lshlrev_b32 v15, 7, v15
    v_lshl_add_u32 v15, v13, 3, v15
    v_xor_b32 v16, s36, v14
    v_lshl_add_u32 v15, v16, 5, v15
    v_add_u32 v15, 73920, v15
    v_lshlrev_b32 v17, 4, v1
    v_and_b32 v18, 15, v1
    v_lshlrev_b32 v18, 10, v18
    v_lshl_add_u32 v18, v11, 3, v18
    s_mov_b32 s39, 61600
    s_cmp_eq_u32 s36, 1
    s_cselect_b32 s39, 65696, s39
    s_cmp_eq_u32 s36, 2
    s_cselect_b32 s39, 69792, s39
    s_cmp_eq_u32 s36, 3
    s_cselect_b32 s39, 147776, s39
    v_add_u32 v19, s39, v17
    s_mov_b32 s60, s26
    s_mov_b32 s61, s27
    s_mov_b32 s62, 2097152
    s_mov_b32 s63, 0x20000
    s_lshl_b32 s39, s37, 1
    s_mov_b32 s40, s41
    s_add_u32 s39, s39, s40
    s_lshl_b32 s39, s39, 2
    s_add_u32 s39, s39, s36
    s_mul_i32 s46, s39, 44032
    s_add_u32 s46, s46, 4194304
    s_lshl_b32 s44, s39, 14
    s_mov_b32 s40, s55
    s_lshl_b32 s40, s40, 7
    s_add_u32 s44, s44, s40
    s_add_u32 s40, s23, 0
    s_sub_u32 s39, s40, 43008
    s_cselect_b32 s40, s40, s39
    s_lshl_b32 s40, s40, 5
    s_add_u32 m0, s16, 98560
    s_add_u32 s39, s47, s40
    buffer_load_dwordx4 v3, s[4:7], s39 offen lds
    s_add_u32 s40, s23, 1024
    s_sub_u32 s39, s40, 43008
    s_cselect_b32 s40, s40, s39
    s_lshl_b32 s40, s40, 5
    s_add_u32 m0, s16, 102656
    s_add_u32 s39, s47, s40
    buffer_load_dwordx4 v3, s[4:7], s39 offen lds
    s_add_u32 s40, s23, 3072
    s_sub_u32 s39, s40, 43008
    s_cselect_b32 s40, s40, s39
    s_lshl_b32 s40, s40, 5
    s_add_u32 m0, s16, 106752
    s_add_u32 s39, s47, s40
    buffer_load_dwordx4 v3, s[4:7], s39 offen lds
    s_add_u32 s40, s23, 4096
    s_sub_u32 s39, s40, 43008
    s_cselect_b32 s40, s40, s39
    s_lshl_b32 s40, s40, 5
    s_add_u32 m0, s16, 110848
    s_add_u32 s39, s47, s40
    buffer_load_dwordx4 v3, s[4:7], s39 offen lds
    s_add_u32 s40, s23, 6144
    s_sub_u32 s39, s40, 43008
    s_cselect_b32 s40, s40, s39
    s_lshl_b32 s40, s40, 5
    s_add_u32 m0, s16, 114944
    s_add_u32 s39, s47, s40
    buffer_load_dwordx4 v3, s[4:7], s39 offen lds
    s_add_u32 s40, s23, 7168
    s_sub_u32 s39, s40, 43008
    s_cselect_b32 s40, s40, s39
    s_lshl_b32 s40, s40, 5
    s_add_u32 m0, s16, 119040
    s_add_u32 s39, s47, s40
    buffer_load_dwordx4 v3, s[4:7], s39 offen lds
    s_add_u32 s40, s23, 9216
    s_sub_u32 s39, s40, 43008
    s_cselect_b32 s40, s40, s39
    s_lshl_b32 s40, s40, 5
    s_add_u32 m0, s16, 123136
    s_add_u32 s39, s47, s40
    buffer_load_dwordx4 v3, s[4:7], s39 offen lds
    s_add_u32 s40, s23, 10240
    s_sub_u32 s39, s40, 43008
    s_cselect_b32 s40, s40, s39
    s_lshl_b32 s40, s40, 5
    s_add_u32 m0, s16, 127232
    s_add_u32 s39, s47, s40
    buffer_load_dwordx4 v3, s[4:7], s39 offen lds
    s_add_u32 s40, s23, 12288
    s_sub_u32 s39, s40, 43008
    s_cselect_b32 s40, s40, s39
    s_lshl_b32 s40, s40, 5
    s_add_u32 m0, s16, 131328
    s_add_u32 s39, s47, s40
    buffer_load_dwordx4 v3, s[4:7], s39 offen lds
    s_add_u32 s40, s23, 13312
    s_sub_u32 s39, s40, 43008
    s_cselect_b32 s40, s40, s39
    s_lshl_b32 s40, s40, 5
    s_add_u32 m0, s16, 135424
    s_add_u32 s39, s47, s40
    buffer_load_dwordx4 v3, s[4:7], s39 offen lds
    s_waitcnt vmcnt(0)
    v_mov_b32 v9, 1
    s_mov_b64 exec, 1
    ds_add_u32 v8, v9 offset:8
    s_mov_b64 exec, -1
    s_branch k2_cw_7_e
k2_cw_7:
    s_sleep 1
k2_cw_7_e:
    ds_read_b32 v9, v8 offset:8
    s_waitcnt lgkmcnt(0)
    v_cmp_gt_u32 vcc, 4, v9
    s_nop 0
    s_cbranch_vccnz k2_cw_7
    ds_read_b64_tr_b16 v[36:37], v244 offset:37120
    ds_read_b64_tr_b16 v[38:39], v244 offset:37632
    ds_read_b64_tr_b16 v[40:41], v245 offset:37120
    ds_read_b64_tr_b16 v[42:43], v245 offset:37632
    ds_read_b64_tr_b16 v[44:45], v246 offset:37120
    ds_read_b64_tr_b16 v[46:47], v246 offset:37632
    ds_read_b64_tr_b16 v[48:49], v247 offset:37120
    ds_read_b64_tr_b16 v[50:51], v247 offset:37632
    ds_read_b64_tr_b16 v[52:53], v244 offset:41216
    ds_read_b64_tr_b16 v[54:55], v244 offset:41728
    ds_read_b64_tr_b16 v[56:57], v245 offset:41216
    ds_read_b64_tr_b16 v[58:59], v245 offset:41728
    ds_read_b64_tr_b16 v[60:61], v246 offset:41216
    ds_read_b64_tr_b16 v[62:63], v246 offset:41728
    ds_read_b64_tr_b16 v[64:65], v247 offset:41216
    ds_read_b64_tr_b16 v[66:67], v247 offset:41728
    ds_read_b64_tr_b16 v[68:69], v244 offset:45312
    ds_read_b64_tr_b16 v[70:71], v244 offset:45824
    ds_read_b64_tr_b16 v[72:73], v245 offset:45312
    ds_read_b64_tr_b16 v[74:75], v245 offset:45824
    ds_read_b64_tr_b16 v[76:77], v246 offset:45312
    ds_read_b64_tr_b16 v[78:79], v246 offset:45824
    ds_read_b64_tr_b16 v[80:81], v247 offset:45312
    ds_read_b64_tr_b16 v[82:83], v247 offset:45824
    ds_read_b64_tr_b16 v[84:85], v244 offset:49408
    ds_read_b64_tr_b16 v[86:87], v244 offset:49920
    ds_read_b64_tr_b16 v[88:89], v245 offset:49408
    ds_read_b64_tr_b16 v[90:91], v245 offset:49920
    ds_read_b64_tr_b16 v[92:93], v246 offset:49408
    ds_read_b64_tr_b16 v[94:95], v246 offset:49920
    ds_read_b64_tr_b16 v[96:97], v247 offset:49408
    ds_read_b64_tr_b16 v[98:99], v247 offset:49920
    ds_read_b64_tr_b16 v[100:101], v244 offset:53504
    ds_read_b64_tr_b16 v[102:103], v244 offset:54016
    ds_read_b64_tr_b16 v[104:105], v245 offset:53504
    ds_read_b64_tr_b16 v[106:107], v245 offset:54016
    ds_read_b64_tr_b16 v[108:109], v246 offset:53504
    ds_read_b64_tr_b16 v[110:111], v246 offset:54016
    ds_read_b64_tr_b16 v[112:113], v247 offset:53504
    ds_read_b64_tr_b16 v[114:115], v247 offset:54016
    ds_read_b64_tr_b16 v[116:117], v244 offset:57600
    ds_read_b64_tr_b16 v[118:119], v244 offset:58112
    ds_read_b64_tr_b16 v[120:121], v245 offset:57600
    ds_read_b64_tr_b16 v[122:123], v245 offset:58112
    ds_read_b64_tr_b16 v[124:125], v246 offset:57600
    ds_read_b64_tr_b16 v[126:127], v246 offset:58112
    ds_read_b64_tr_b16 v[128:129], v247 offset:57600
    ds_read_b64_tr_b16 v[130:131], v247 offset:58112
    ds_read_b64_tr_b16 v[132:133], v248 offset:256
    ds_read_b64_tr_b16 v[134:135], v248 offset:768
    ds_read_b64_tr_b16 v[136:137], v249 offset:256
    ds_read_b64_tr_b16 v[138:139], v249 offset:768
    ds_read_b64_tr_b16 v[140:141], v250 offset:256
    ds_read_b64_tr_b16 v[142:143], v250 offset:768
    ds_read_b64_tr_b16 v[144:145], v251 offset:256
    ds_read_b64_tr_b16 v[146:147], v251 offset:768
    ds_read_b64_tr_b16 v[148:149], v248 offset:4352
    ds_read_b64_tr_b16 v[150:151], v248 offset:4864
    ds_read_b64_tr_b16 v[152:153], v249 offset:4352
    ds_read_b64_tr_b16 v[154:155], v249 offset:4864
    ds_read_b64_tr_b16 v[156:157], v250 offset:4352
    ds_read_b64_tr_b16 v[158:159], v250 offset:4864
    ds_read_b64_tr_b16 v[160:161], v251 offset:4352
    ds_read_b64_tr_b16 v[162:163], v251 offset:4864
    ds_read_b64_tr_b16 v[164:165], v248 offset:8448
    ds_read_b64_tr_b16 v[166:167], v248 offset:8960
    ds_read_b64_tr_b16 v[168:169], v249 offset:8448
    ds_read_b64_tr_b16 v[170:171], v249 offset:8960
    ds_read_b64_tr_b16 v[172:173], v250 offset:8448
    ds_read_b64_tr_b16 v[174:175], v250 offset:8960
    ds_read_b64_tr_b16 v[176:177], v251 offset:8448
    ds_read_b64_tr_b16 v[178:179], v251 offset:8960
    ds_read_b64_tr_b16 v[180:181], v248 offset:12544
    ds_read_b64_tr_b16 v[182:183], v248 offset:13056
    ds_read_b64_tr_b16 v[184:185], v249 offset:12544
    ds_read_b64_tr_b16 v[186:187], v249 offset:13056
    ds_read_b64_tr_b16 v[188:189], v250 offset:12544
    ds_read_b64_tr_b16 v[190:191], v250 offset:13056
    ds_read_b64_tr_b16 v[192:193], v251 offset:12544
    ds_read_b64_tr_b16 v[194:195], v251 offset:13056
    s_waitcnt lgkmcnt(0)
    s_cmp_lg_u32 s36, 0
    s_cbranch_scc1 k2_hq_d
    s_lshr_b32 s39, s37, 1
    s_lshl_b32 s39, s39, 10
    s_add_u32 s39, s39, 212992
    v_lshl_add_u32 v204, v1, 4, s39
    s_mov_b32 s17, 0
k2_hq:
    global_load_dwordx4 v[200:203], v204, s[30:31] sc0 sc1
    s_add_u32 s17, s17, 1
    s_cmp_ge_u32 s17, 65536
    s_cbranch_scc1 k2_hq_d
    s_waitcnt vmcnt(0)
    v_xor_b32 v200, s34, v200
    v_xor_b32 v201, s34, v201
    v_xor_b32 v202, s34, v202
    v_xor_b32 v203, s34, v203
    v_or3_b32 v200, v200, v201, v202
    v_or_b32 v200, v200, v203
    v_cmp_ne_u32 vcc, 0, v200
    s_nop 0
    s_mov_b64 exec, vcc
    s_cbranch_vccnz k2_hq
k2_hq_d:
    s_mov_b64 exec, -1
    s_add_u32 s36, s36, 4
k2_stats_lo:
    s_setprio 0
    s_lshl_b32 s39, s37, 17
    s_lshl_b32 s40, s36, 14
    s_add_u32 s39, s39, s40
    s_add_u32 s39, s39, 1048576
    v_lshlrev_b32 v2, 4, v1
    s_barrier
    buffer_load_dwordx4 v[196:199], v2, s[48:51], s39 offen offset:0
    buffer_load_dwordx4 v[200:203], v2, s[48:51], s39 offen offset:1024
    buffer_load_dwordx4 v[204:207], v2, s[48:51], s39 offen offset:2048
    buffer_load_dwordx4 v[208:211], v2, s[48:51], s39 offen offset:3072
    s_add_u32 s39, s39, 4096
    buffer_load_dwordx4 v[212:215], v2, s[48:51], s39 offen offset:0
    buffer_load_dwordx4 v[216:219], v2, s[48:51], s39 offen offset:1024
    buffer_load_dwordx4 v[220:223], v2, s[48:51], s39 offen offset:2048
    buffer_load_dwordx4 v[224:227], v2, s[48:51], s39 offen offset:3072
    s_add_u32 s39, s39, 4096
    v_mov_b32 v228, 0
    v_mov_b32 v229, 0
    v_mov_b32 v230, 0
    v_mov_b32 v231, 0
    v_mov_b32 v232, 0
    v_mov_b32 v233, 0
    v_mov_b32 v234, 0
    v_mov_b32 v235, 0
    v_mov_b32 v236, 0
    v_mov_b32 v237, 0
    v_mov_b32 v238, 0
    v_mov_b32 v239, 0
    v_mov_b32 v240, 0
    v_mov_b32 v241, 0
    v_mov_b32 v242, 0
    v_mov_b32 v243, 0
    s_waitcnt vmcnt(7)
    v_lshlrev_b32 v244, 16, v196
    v_and_b32 v245, 0xffff0000, v196
    v_lshlrev_b32 v246, 16, v197
    v_and_b32 v247, 0xffff0000, v197
    v_lshlrev_b32 v248, 16, v198
    v_and_b32 v249, 0xffff0000, v198
    v_lshlrev_b32 v250, 16, v199
    v_and_b32 v251, 0xffff0000, v199
    buffer_load_dwordx4 v[196:199], v2, s[48:51], s39 offen offset:0
    v_pk_add_f32 v[228:229], v[228:229], v[244:245]
    v_pk_fma_f32 v[236:237], v[244:245], v[244:245], v[236:237]
    v_pk_add_f32 v[230:231], v[230:231], v[246:247]
    v_pk_fma_f32 v[238:239], v[246:247], v[246:247], v[238:239]
    v_pk_add_f32 v[232:233], v[232:233], v[248:249]
    v_pk_fma_f32 v[240:241], v[248:249], v[248:249], v[240:241]
    v_pk_add_f32 v[234:235], v[234:235], v[250:251]
    v_pk_fma_f32 v[242:243], v[250:251], v[250:251], v[242:243]
    s_waitcnt vmcnt(7)
    v_lshlrev_b32 v244, 16, v200
    v_and_b32 v245, 0xffff0000, v200
    v_lshlrev_b32 v246, 16, v201
    v_and_b32 v247, 0xffff0000, v201
    v_lshlrev_b32 v248, 16, v202
    v_and_b32 v249, 0xffff0000, v202
    v_lshlrev_b32 v250, 16, v203
    v_and_b32 v251, 0xffff0000, v203
    buffer_load_dwordx4 v[200:203], v2, s[48:51], s39 offen offset:1024
    v_pk_add_f32 v[228:229], v[228:229], v[244:245]
    v_pk_fma_f32 v[236:237], v[244:245], v[244:245], v[236:237]
    v_pk_add_f32 v[230:231], v[230:231], v[246:247]
    v_pk_fma_f32 v[238:239], v[246:247], v[246:247], v[238:239]
    v_pk_add_f32 v[232:233], v[232:233], v[248:249]
    v_pk_fma_f32 v[240:241], v[248:249], v[248:249], v[240:241]
    v_pk_add_f32 v[234:235], v[234:235], v[250:251]
    v_pk_fma_f32 v[242:243], v[250:251], v[250:251], v[242:243]
    s_waitcnt vmcnt(7)
    v_lshlrev_b32 v244, 16, v204
    v_and_b32 v245, 0xffff0000, v204
    v_lshlrev_b32 v246, 16, v205
    v_and_b32 v247, 0xffff0000, v205
    v_lshlrev_b32 v248, 16, v206
    v_and_b32 v249, 0xffff0000, v206
    v_lshlrev_b32 v250, 16, v207
    v_and_b32 v251, 0xffff0000, v207
    buffer_load_dwordx4 v[204:207], v2, s[48:51], s39 offen offset:2048
    v_pk_add_f32 v[228:229], v[228:229], v[244:245]
    v_pk_fma_f32 v[236:237], v[244:245], v[244:245], v[236:237]
    v_pk_add_f32 v[230:231], v[230:231], v[246:247]
    v_pk_fma_f32 v[238:239], v[246:247], v[246:247], v[238:239]
    v_pk_add_f32 v[232:233], v[232:233], v[248:249]
    v_pk_fma_f32 v[240:241], v[248:249], v[248:249], v[240:241]
    v_pk_add_f32 v[234:235], v[234:235], v[250:251]
    v_pk_fma_f32 v[242:243], v[250:251], v[250:251], v[242:243]
    s_waitcnt vmcnt(7)
    v_lshlrev_b32 v244, 16, v208
    v_and_b32 v245, 0xffff0000, v208
    v_lshlrev_b32 v246, 16, v209
    v_and_b32 v247, 0xffff0000, v209
    v_lshlrev_b32 v248, 16, v210
    v_and_b32 v249, 0xffff0000, v210
    v_lshlrev_b32 v250, 16, v211
    v_and_b32 v251, 0xffff0000, v211
    buffer_load_dwordx4 v[208:211], v2, s[48:51], s39 offen offset:3072
    s_add_u32 s39, s39, 4096
    v_pk_add_f32 v[228:229], v[228:229], v[244:245]
    v_pk_fma_f32 v[236:237], v[244:245], v[244:245], v[236:237]
    v_pk_add_f32 v[230:231], v[230:231], v[246:247]
    v_pk_fma_f32 v[238:239], v[246:247], v[246:247], v[238:239]
    v_pk_add_f32 v[232:233], v[232:233], v[248:249]
    v_pk_fma_f32 v[240:241], v[248:249], v[248:249], v[240:241]
    v_pk_add_f32 v[234:235], v[234:235], v[250:251]
    v_pk_fma_f32 v[242:243], v[250:251], v[250:251], v[242:243]
    s_waitcnt vmcnt(7)
    v_lshlrev_b32 v244, 16, v212
    v_and_b32 v245, 0xffff0000, v212
    v_lshlrev_b32 v246, 16, v213
    v_and_b32 v247, 0xffff0000, v213
    v_lshlrev_b32 v248, 16, v214
    v_and_b32 v249, 0xffff0000, v214
    v_lshlrev_b32 v250, 16, v215
    v_and_b32 v251, 0xffff0000, v215
    buffer_load_dwordx4 v[212:215], v2, s[48:51], s39 offen offset:0
    v_pk_add_f32 v[228:229], v[228:229], v[244:245]
    v_pk_fma_f32 v[236:237], v[244:245], v[244:245], v[236:237]
    v_pk_add_f32 v[230:231], v[230:231], v[246:247]
    v_pk_fma_f32 v[238:239], v[246:247], v[246:247], v[238:239]
    v_pk_add_f32 v[232:233], v[232:233], v[248:249]
    v_pk_fma_f32 v[240:241], v[248:249], v[248:249], v[240:241]
    v_pk_add_f32 v[234:235], v[234:235], v[250:251]
    v_pk_fma_f32 v[242:243], v[250:251], v[250:251], v[242:243]
    s_waitcnt vmcnt(7)
    v_lshlrev_b32 v244, 16, v216
    v_and_b32 v245, 0xffff0000, v216
    v_lshlrev_b32 v246, 16, v217
    v_and_b32 v247, 0xffff0000, v217
    v_lshlrev_b32 v248, 16, v218
    v_and_b32 v249, 0xffff0000, v218
    v_lshlrev_b32 v250, 16, v219
    v_and_b32 v251, 0xffff0000, v219
    buffer_load_dwordx4 v[216:219], v2, s[48:51], s39 offen offset:1024
    v_pk_add_f32 v[228:229], v[228:229], v[244:245]
    v_pk_fma_f32 v[236:237], v[244:245], v[244:245], v[236:237]
    v_pk_add_f32 v[230:231], v[230:231], v[246:247]
    v_pk_fma_f32 v[238:239], v[246:247], v[246:247], v[238:239]
    v_pk_add_f32 v[232:233], v[232:233], v[248:249]
    v_pk_fma_f32 v[240:241], v[248:249], v[248:249], v[240:241]
    v_pk_add_f32 v[234:235], v[234:235], v[250:251]
    v_pk_fma_f32 v[242:243], v[250:251], v[250:251], v[242:243]
    s_waitcnt vmcnt(7)
    v_lshlrev_b32 v244, 16, v220
    v_and_b32 v245, 0xffff0000, v220
    v_lshlrev_b32 v246, 16, v221
    v_and_b32 v247, 0xffff0000, v221
    v_lshlrev_b32 v248, 16, v222
    v_and_b32 v249, 0xffff0000, v222
    v_lshlrev_b32 v250, 16, v223
    v_and_b32 v251, 0xffff0000, v223
    buffer_load_dwordx4 v[220:223], v2, s[48:51], s39 offen offset:2048
    v_pk_add_f32 v[228:229], v[228:229], v[244:245]
    v_pk_fma_f32 v[236:237], v[244:245], v[244:245], v[236:237]
    v_pk_add_f32 v[230:231], v[230:231], v[246:247]
    v_pk_fma_f32 v[238:239], v[246:247], v[246:247], v[238:239]
    v_pk_add_f32 v[232:233], v[232:233], v[248:249]
    v_pk_fma_f32 v[240:241], v[248:249], v[248:249], v[240:241]
    v_pk_add_f32 v[234:235], v[234:235], v[250:251]
    v_pk_fma_f32 v[242:243], v[250:251], v[250:251], v[242:243]
    s_waitcnt vmcnt(7)
    v_lshlrev_b32 v244, 16, v224
    v_and_b32 v245, 0xffff0000, v224
    v_lshlrev_b32 v246, 16, v225
    v_and_b32 v247, 0xffff0000, v225
    v_lshlrev_b32 v248, 16, v226
    v_and_b32 v249, 0xffff0000, v226
    v_lshlrev_b32 v250, 16, v227
    v_and_b32 v251, 0xffff0000, v227
    buffer_load_dwordx4 v[224:227], v2, s[48:51], s39 offen offset:3072
    v_pk_add_f32 v[228:229], v[228:229], v[244:245]
    v_pk_fma_f32 v[236:237], v[244:245], v[244:245], v[236:237]
    v_pk_add_f32 v[230:231], v[230:231], v[246:247]
    v_pk_fma_f32 v[238:239], v[246:247], v[246:247], v[238:239]
    v_pk_add_f32 v[232:233], v[232:233], v[248:249]
    v_pk_fma_f32 v[240:241], v[248:249], v[248:249], v[240:241]
    v_pk_add_f32 v[234:235], v[234:235], v[250:251]
    v_pk_fma_f32 v[242:243], v[250:251], v[250:251], v[242:243]
    s_waitcnt vmcnt(7)
    v_lshlrev_b32 v244, 16, v196
    v_and_b32 v245, 0xffff0000, v196
    v_lshlrev_b32 v246, 16, v197
    v_and_b32 v247, 0xffff0000, v197
    v_lshlrev_b32 v248, 16, v198
    v_and_b32 v249, 0xffff0000, v198
    v_lshlrev_b32 v250, 16, v199
    v_and_b32 v251, 0xffff0000, v199
    v_pk_add_f32 v[228:229], v[228:229], v[244:245]
    v_pk_fma_f32 v[236:237], v[244:245], v[244:245], v[236:237]
    v_pk_add_f32 v[230:231], v[230:231], v[246:247]
    v_pk_fma_f32 v[238:239], v[246:247], v[246:247], v[238:239]
    v_pk_add_f32 v[232:233], v[232:233], v[248:249]
    v_pk_fma_f32 v[240:241], v[248:249], v[248:249], v[240:241]
    v_pk_add_f32 v[234:235], v[234:235], v[250:251]
    v_pk_fma_f32 v[242:243], v[250:251], v[250:251], v[242:243]
    s_waitcnt vmcnt(6)
    v_lshlrev_b32 v244, 16, v200
    v_and_b32 v245, 0xffff0000, v200
    v_lshlrev_b32 v246, 16, v201
    v_and_b32 v247, 0xffff0000, v201
    v_lshlrev_b32 v248, 16, v202
    v_and_b32 v249, 0xffff0000, v202
    v_lshlrev_b32 v250, 16, v203
    v_and_b32 v251, 0xffff0000, v203
    v_pk_add_f32 v[228:229], v[228:229], v[244:245]
    v_pk_fma_f32 v[236:237], v[244:245], v[244:245], v[236:237]
    v_pk_add_f32 v[230:231], v[230:231], v[246:247]
    v_pk_fma_f32 v[238:239], v[246:247], v[246:247], v[238:239]
    v_pk_add_f32 v[232:233], v[232:233], v[248:249]
    v_pk_fma_f32 v[240:241], v[248:249], v[248:249], v[240:241]
    v_pk_add_f32 v[234:235], v[234:235], v[250:251]
    v_pk_fma_f32 v[242:243], v[250:251], v[250:251], v[242:243]
    s_waitcnt vmcnt(5)
    v_lshlrev_b32 v244, 16, v204
    v_and_b32 v245, 0xffff0000, v204
    v_lshlrev_b32 v246, 16, v205
    v_and_b32 v247, 0xffff0000, v205
    v_lshlrev_b32 v248, 16, v206
    v_and_b32 v249, 0xffff0000, v206
    v_lshlrev_b32 v250, 16, v207
    v_and_b32 v251, 0xffff0000, v207
    v_pk_add_f32 v[228:229], v[228:229], v[244:245]
    v_pk_fma_f32 v[236:237], v[244:245], v[244:245], v[236:237]
    v_pk_add_f32 v[230:231], v[230:231], v[246:247]
    v_pk_fma_f32 v[238:239], v[246:247], v[246:247], v[238:239]
    v_pk_add_f32 v[232:233], v[232:233], v[248:249]
    v_pk_fma_f32 v[240:241], v[248:249], v[248:249], v[240:241]
    v_pk_add_f32 v[234:235], v[234:235], v[250:251]
    v_pk_fma_f32 v[242:243], v[250:251], v[250:251], v[242:243]
    s_waitcnt vmcnt(4)
    v_lshlrev_b32 v244, 16, v208
    v_and_b32 v245, 0xffff0000, v208
    v_lshlrev_b32 v246, 16, v209
    v_and_b32 v247, 0xffff0000, v209
    v_lshlrev_b32 v248, 16, v210
    v_and_b32 v249, 0xffff0000, v210
    v_lshlrev_b32 v250, 16, v211
    v_and_b32 v251, 0xffff0000, v211
    v_pk_add_f32 v[228:229], v[228:229], v[244:245]
    v_pk_fma_f32 v[236:237], v[244:245], v[244:245], v[236:237]
    v_pk_add_f32 v[230:231], v[230:231], v[246:247]
    v_pk_fma_f32 v[238:239], v[246:247], v[246:247], v[238:239]
    v_pk_add_f32 v[232:233], v[232:233], v[248:249]
    v_pk_fma_f32 v[240:241], v[248:249], v[248:249], v[240:241]
    v_pk_add_f32 v[234:235], v[234:235], v[250:251]
    v_pk_fma_f32 v[242:243], v[250:251], v[250:251], v[242:243]
    s_waitcnt vmcnt(3)
    v_lshlrev_b32 v244, 16, v212
    v_and_b32 v245, 0xffff0000, v212
    v_lshlrev_b32 v246, 16, v213
    v_and_b32 v247, 0xffff0000, v213
    v_lshlrev_b32 v248, 16, v214
    v_and_b32 v249, 0xffff0000, v214
    v_lshlrev_b32 v250, 16, v215
    v_and_b32 v251, 0xffff0000, v215
    v_pk_add_f32 v[228:229], v[228:229], v[244:245]
    v_pk_fma_f32 v[236:237], v[244:245], v[244:245], v[236:237]
    v_pk_add_f32 v[230:231], v[230:231], v[246:247]
    v_pk_fma_f32 v[238:239], v[246:247], v[246:247], v[238:239]
    v_pk_add_f32 v[232:233], v[232:233], v[248:249]
    v_pk_fma_f32 v[240:241], v[248:249], v[248:249], v[240:241]
    v_pk_add_f32 v[234:235], v[234:235], v[250:251]
    v_pk_fma_f32 v[242:243], v[250:251], v[250:251], v[242:243]
    s_waitcnt vmcnt(2)
    v_lshlrev_b32 v244, 16, v216
    v_and_b32 v245, 0xffff0000, v216
    v_lshlrev_b32 v246, 16, v217
    v_and_b32 v247, 0xffff0000, v217
    v_lshlrev_b32 v248, 16, v218
    v_and_b32 v249, 0xffff0000, v218
    v_lshlrev_b32 v250, 16, v219
    v_and_b32 v251, 0xffff0000, v219
    v_pk_add_f32 v[228:229], v[228:229], v[244:245]
    v_pk_fma_f32 v[236:237], v[244:245], v[244:245], v[236:237]
    v_pk_add_f32 v[230:231], v[230:231], v[246:247]
    v_pk_fma_f32 v[238:239], v[246:247], v[246:247], v[238:239]
    v_pk_add_f32 v[232:233], v[232:233], v[248:249]
    v_pk_fma_f32 v[240:241], v[248:249], v[248:249], v[240:241]
    v_pk_add_f32 v[234:235], v[234:235], v[250:251]
    v_pk_fma_f32 v[242:243], v[250:251], v[250:251], v[242:243]
    s_waitcnt vmcnt(1)
    v_lshlrev_b32 v244, 16, v220
    v_and_b32 v245, 0xffff0000, v220
    v_lshlrev_b32 v246, 16, v221
    v_and_b32 v247, 0xffff0000, v221
    v_lshlrev_b32 v248, 16, v222
    v_and_b32 v249, 0xffff0000, v222
    v_lshlrev_b32 v250, 16, v223
    v_and_b32 v251, 0xffff0000, v223
    v_pk_add_f32 v[228:229], v[228:229], v[244:245]
    v_pk_fma_f32 v[236:237], v[244:245], v[244:245], v[236:237]
    v_pk_add_f32 v[230:231], v[230:231], v[246:247]
    v_pk_fma_f32 v[238:239], v[246:247], v[246:247], v[238:239]
    v_pk_add_f32 v[232:233], v[232:233], v[248:249]
    v_pk_fma_f32 v[240:241], v[248:249], v[248:249], v[240:241]
    v_pk_add_f32 v[234:235], v[234:235], v[250:251]
    v_pk_fma_f32 v[242:243], v[250:251], v[250:251], v[242:243]
    s_waitcnt vmcnt(0)
    v_lshlrev_b32 v244, 16, v224
    v_and_b32 v245, 0xffff0000, v224
    v_lshlrev_b32 v246, 16, v225
    v_and_b32 v247, 0xffff0000, v225
    v_lshlrev_b32 v248, 16, v226
    v_and_b32 v249, 0xffff0000, v226
    v_lshlrev_b32 v250, 16, v227
    v_and_b32 v251, 0xffff0000, v227
    v_pk_add_f32 v[228:229], v[228:229], v[244:245]
    v_pk_fma_f32 v[236:237], v[244:245], v[244:245], v[236:237]
    v_pk_add_f32 v[230:231], v[230:231], v[246:247]
    v_pk_fma_f32 v[238:239], v[246:247], v[246:247], v[238:239]
    v_pk_add_f32 v[232:233], v[232:233], v[248:249]
    v_pk_fma_f32 v[240:241], v[248:249], v[248:249], v[240:241]
    v_pk_add_f32 v[234:235], v[234:235], v[250:251]
    v_pk_fma_f32 v[242:243], v[250:251], v[250:251], v[242:243]
    v_permlane32_swap_b32 v228, v236
    v_permlane32_swap_b32 v229, v237
    v_permlane32_swap_b32 v230, v238
    v_permlane32_swap_b32 v231, v239
    v_permlane32_swap_b32 v232, v240
    v_permlane32_swap_b32 v233, v241
    v_permlane32_swap_b32 v234, v242
    v_permlane32_swap_b32 v235, v243
    v_add_f32 v228, v228, v236
    v_add_f32 v229, v229, v237
    v_add_f32 v230, v230, v238
    v_add_f32 v231, v231, v239
    v_add_f32 v232, v232, v240
    v_add_f32 v233, v233, v241
    v_add_f32 v234, v234, v242
    v_add_f32 v235, v235, v243
    v_permlane16_swap_b32 v228, v232
    v_permlane16_swap_b32 v229, v233
    v_permlane16_swap_b32 v230, v234
    v_permlane16_swap_b32 v231, v235
    v_and_b32 v10, 15, v1
    v_lshlrev_b32 v10, 5, v10
    v_and_b32 v11, 16, v1
    v_add_u32 v10, v10, v11
    v_and_b32 v11, 32, v1
    v_lshl_add_u32 v10, v11, 4, v10
    s_lshl_b32 s39, s36, 10
    v_add_u32 v10, s39, v10
    v_add_f32 v228, v228, v232
    v_add_f32 v229, v229, v233
    v_add_f32 v230, v230, v234
    v_add_f32 v231, v231, v235
    ds_write_b128 v10, v[228:231]
    s_waitcnt lgkmcnt(0)
    s_barrier
    s_cmp_ge_u32 s36, 4
    s_cbranch_scc1 k2_st_p2
    s_cmp_ge_u32 s36, 2
    s_cbranch_scc1 k2_st_exit
    v_lshlrev_b32 v10, 2, v0
    ds_read_b32 v196, v10 offset:0
    ds_read_b32 v204, v10 offset:512
    ds_read_b32 v197, v10 offset:1024
    ds_read_b32 v205, v10 offset:1536
    ds_read_b32 v198, v10 offset:2048
    ds_read_b32 v206, v10 offset:2560
    ds_read_b32 v199, v10 offset:3072
    ds_read_b32 v207, v10 offset:3584
    ds_read_b32 v200, v10 offset:4096
    ds_read_b32 v208, v10 offset:4608
    ds_read_b32 v201, v10 offset:5120
    ds_read_b32 v209, v10 offset:5632
    ds_read_b32 v202, v10 offset:6144
    ds_read_b32 v210, v10 offset:6656
    ds_read_b32 v203, v10 offset:7168
    ds_read_b32 v211, v10 offset:7680
    s_waitcnt lgkmcnt(0)
    v_add_f32 v196, v196, v200
    v_add_f32 v204, v204, v208
    v_add_f32 v197, v197, v201
    v_add_f32 v205, v205, v209
    v_add_f32 v198, v198, v202
    v_add_f32 v206, v206, v210
    v_add_f32 v199, v199, v203
    v_add_f32 v207, v207, v211
    v_add_f32 v196, v196, v198
    v_add_f32 v204, v204, v206
    v_add_f32 v197, v197, v199
    v_add_f32 v205, v205, v207
    v_add_f32 v196, v196, v197
    v_add_f32 v204, v204, v205
    v_mul_f32 v196, 0x3b000000, v196
    v_mul_f32 v197, v196, v196
    v_fma_f32 v204, v204, s90, -v197
    v_max_f32 v204, 0, v204
    v_cvt_pk_bf16_f32 v204, v204, v204
    v_and_b32 v204, 0xffff0000, v204
    v_add_f32 v204, 0x3727c5ac, v204
    v_cvt_pk_bf16_f32 v204, v204, v204
    v_and_b32 v204, 0xffff0000, v204
    v_sqrt_f32 v204, v204
    s_nop 0
    v_cvt_pk_bf16_f32 v196, v196, v204
    v_mov_b32 v197, s34
    s_lshl_b32 s39, s37, 10
    s_add_u32 s39, s39, 196608
    v_lshl_add_u32 v10, v0, 3, s39
    global_store_dwordx2 v10, v[196:197], s[30:31] sc0 sc1
k2_st_exit:
    s_barrier
    v_bfe_u32 v10, v1, 2, 2
    v_lshrrev_b32 v11, 4, v1
    v_lshl_add_u32 v12, v11, 3, v10
    v_lshlrev_b32 v12, 7, v12
    v_and_b32 v13, 3, v1
    v_lshl_add_u32 v12, v13, 3, v12
    v_lshrrev_b32 v14, 1, v10
    v_and_b32 v16, 1, v11
    v_lshl_or_b32 v14, v16, 1, v14
    v_xor_b32 v16, 0, v14
    v_lshl_add_u32 v240, v16, 5, v12
    v_add_u32 v244, 0xf000, v240
    v_add_u32 v248, 0x1e000, v240
    v_xor_b32 v16, 1, v14
    v_lshl_add_u32 v241, v16, 5, v12
    v_add_u32 v245, 0xf000, v241
    v_add_u32 v249, 0x1e000, v241
    v_xor_b32 v16, 2, v14
    v_lshl_add_u32 v242, v16, 5, v12
    v_add_u32 v246, 0xf000, v242
    v_add_u32 v250, 0x1e000, v242
    v_xor_b32 v16, 3, v14
    v_lshl_add_u32 v243, v16, 5, v12
    v_add_u32 v247, 0xf000, v243
    v_add_u32 v251, 0x1e000, v243
    v_lshlrev_b32 v17, 4, v1
    v_and_b32 v18, 15, v1
    v_lshlrev_b32 v18, 10, v18
    v_lshl_add_u32 v18, v11, 3, v18
    s_mov_b32 s39, 61600
    s_cmp_eq_u32 s36, 1
    s_cselect_b32 s39, 65696, s39
    s_cmp_eq_u32 s36, 2
    s_cselect_b32 s39, 69792, s39
    s_cmp_eq_u32 s36, 3
    s_cselect_b32 s39, 147776, s39
    v_add_u32 v19, s39, v17
    s_mov_b32 s60, s26
    s_mov_b32 s61, s27
    s_mov_b32 s62, 2097152
    s_mov_b32 s63, 0x20000
    s_lshl_b32 s39, s37, 1
    s_mov_b32 s40, s41
    s_add_u32 s39, s39, s40
    s_lshl_b32 s39, s39, 2
    s_add_u32 s39, s39, s36
    s_mul_i32 s46, s39, 44032
    s_add_u32 s46, s46, 4194304
    s_lshl_b32 s44, s39, 14
    s_mov_b32 s40, s55
    s_lshl_b32 s40, s40, 7
    s_add_u32 s44, s44, s40
    s_cmp_lg_u32 s36, 0
    s_cbranch_scc1 k2_gd
    s_lshl_b32 s45, s37, 7
    s_add_u32 s45, s45, 28672
    v_mov_b32 v16, s45
    s_mov_b32 s17, 0
k2_g:
    global_load_dword v10, v16, s[30:31] sc0 sc1
    s_add_u32 s17, s17, 1
    s_cmp_ge_u32 s17, 65536
    s_cbranch_scc1 k2_gd
    s_waitcnt vmcnt(0)
    v_cmp_ne_u32 vcc, s34, v10
    s_nop 0
    s_cbranch_vccnz k2_g
k2_gd:
    v_mov_b32 v9, 1
    s_mov_b64 exec, 1
    ds_add_u32 v8, v9 offset:4
    s_mov_b64 exec, -1
    s_branch k2_cw_8_e
k2_cw_8:
    s_sleep 1
k2_cw_8_e:
    ds_read_b32 v9, v8 offset:4
    s_waitcnt lgkmcnt(0)
    v_cmp_gt_u32 vcc, 4, v9
    s_nop 0
    s_cbranch_vccnz k2_cw_8
    s_branch k2_p2b
k2_st_p2:
    s_barrier
    s_sub_u32 s36, s36, 4
    s_mov_b32 s39, s55
    s_lshl_b32 s39, s39, 14
    s_lshl_b32 s40, s36, 12
    s_add_u32 s39, s39, s40
    s_lshl_b32 s40, s37, 17
    s_add_u32 s39, s39, s40
    s_mov_b32 s40, s41
    s_lshl_b32 s40, s40, 7
    s_add_u32 s39, s39, s40
    s_add_u32 s39, s39, 1048576
    s_lshl_b32 s40, s36, 11
    s_add_u32 m0, s40, 73920
    s_add_u32 s40, s39, 2048
    buffer_load_dwordx4 v7, s[48:51], s39 offen lds
    s_add_u32 m0, m0, 1024
    s_nop 0
    buffer_load_dwordx4 v7, s[48:51], s40 offen lds
    s_add_u32 s40, s23, 15360
    s_sub_u32 s39, s40, 43008
    s_cselect_b32 s40, s40, s39
    s_lshl_b32 s40, s40, 5
    s_add_u32 m0, s16, 110880
    s_add_u32 s39, s47, s40
    buffer_load_dwordx4 v3, s[4:7], s39 offen lds
    s_add_u32 s40, s23, 16384
    s_sub_u32 s39, s40, 43008
    s_cselect_b32 s40, s40, s39
    s_lshl_b32 s40, s40, 5
    s_add_u32 m0, s16, 114976
    s_add_u32 s39, s47, s40
    buffer_load_dwordx4 v3, s[4:7], s39 offen lds
    s_add_u32 s40, s23, 18432
    s_sub_u32 s39, s40, 43008
    s_cselect_b32 s40, s40, s39
    s_lshl_b32 s40, s40, 5
    s_add_u32 m0, s16, 119072
    s_add_u32 s39, s47, s40
    buffer_load_dwordx4 v3, s[4:7], s39 offen lds
    s_add_u32 s40, s23, 19456
    s_sub_u32 s39, s40, 43008
    s_cselect_b32 s40, s40, s39
    s_lshl_b32 s40, s40, 5
    s_add_u32 m0, s16, 0
    s_add_u32 s39, s47, s40
    buffer_load_dwordx4 v3, s[4:7], s39 offen lds
    s_add_u32 s40, s23, 21504
    s_sub_u32 s39, s40, 43008
    s_cselect_b32 s40, s40, s39
    s_lshl_b32 s40, s40, 5
    s_add_u32 m0, s16, 4096
    s_add_u32 s39, s47, s40
    buffer_load_dwordx4 v3, s[4:7], s39 offen lds
    s_add_u32 s40, s23, 22528
    s_sub_u32 s39, s40, 43008
    s_cselect_b32 s40, s40, s39
    s_lshl_b32 s40, s40, 5
    s_add_u32 m0, s16, 8192
    s_add_u32 s39, s47, s40
    buffer_load_dwordx4 v3, s[4:7], s39 offen lds
    s_add_u32 s40, s23, 24576
    s_sub_u32 s39, s40, 43008
    s_cselect_b32 s40, s40, s39
    s_lshl_b32 s40, s40, 5
    s_add_u32 m0, s16, 12320
    s_add_u32 s39, s47, s40
    buffer_load_dwordx4 v3, s[4:7], s39 offen lds
    s_add_u32 s40, s23, 25600
    s_sub_u32 s39, s40, 43008
    s_cselect_b32 s40, s40, s39
    s_lshl_b32 s40, s40, 5
    s_add_u32 m0, s16, 16416
    s_add_u32 s39, s47, s40
    buffer_load_dwordx4 v3, s[4:7], s39 offen lds
    s_add_u32 s40, s23, 27648
    s_sub_u32 s39, s40, 43008
    s_cselect_b32 s40, s40, s39
    s_lshl_b32 s40, s40, 5
    s_add_u32 m0, s16, 20512
    s_add_u32 s39, s47, s40
    buffer_load_dwordx4 v3, s[4:7], s39 offen lds
    s_add_u32 s40, s23, 31744
    s_sub_u32 s39, s40, 43008
    s_cselect_b32 s40, s40, s39
    s_lshl_b32 s40, s40, 5
    s_add_u32 m0, s16, 82112
    s_add_u32 s39, s47, s40
    buffer_load_dwordx4 v3, s[4:7], s39 offen lds
    s_add_u32 s40, s23, 33792
    s_sub_u32 s39, s40, 43008
    s_cselect_b32 s40, s40, s39
    s_lshl_b32 s40, s40, 5
    s_add_u32 m0, s16, 24640
    s_add_u32 s39, s47, s40
    buffer_load_dwordx4 v3, s[4:7], s39 offen lds
    s_add_u32 s40, s23, 34816
    s_sub_u32 s39, s40, 43008
    s_cselect_b32 s40, s40, s39
    s_lshl_b32 s40, s40, 5
    s_add_u32 m0, s16, 28736
    s_add_u32 s39, s47, s40
    buffer_load_dwordx4 v3, s[4:7], s39 offen lds
    s_add_u32 s40, s23, 36864
    s_sub_u32 s39, s40, 43008
    s_cselect_b32 s40, s40, s39
    s_lshl_b32 s40, s40, 5
    s_add_u32 m0, s16, 32832
    s_add_u32 s39, s47, s40
    buffer_load_dwordx4 v3, s[4:7], s39 offen lds
    s_add_u32 s40, s23, 37888
    s_sub_u32 s39, s40, 43008
    s_cselect_b32 s40, s40, s39
    s_lshl_b32 s40, s40, 5
    s_add_u32 m0, s16, 123200
    s_add_u32 s39, s47, s40
    buffer_load_dwordx4 v3, s[4:7], s39 offen lds
    s_add_u32 s40, s23, 39936
    s_sub_u32 s39, s40, 43008
    s_cselect_b32 s40, s40, s39
    s_lshl_b32 s40, s40, 5
    s_add_u32 m0, s16, 127296
    s_add_u32 s39, s47, s40
    buffer_load_dwordx4 v3, s[4:7], s39 offen lds
    s_add_u32 s40, s23, 40960
    s_sub_u32 s39, s40, 43008
    s_cselect_b32 s40, s40, s39
    s_lshl_b32 s40, s40, 5
    s_add_u32 m0, s16, 155968
    s_add_u32 s39, s47, s40
    buffer_load_dwordx4 v3, s[4:7], s39 offen lds
    s_mov_b32 s40, 43008
    s_lshl_b32 s40, s40, 5
    s_add_u32 m0, s16, 86240
    s_add_u32 s39, s47, s40
    buffer_load_dwordx4 v3, s[4:7], s39 offen lds
    s_add_u32 s40, s23, 2048
    s_sub_u32 s39, s40, 43008
    s_cselect_b32 s40, s40, s39
    s_lshl_b32 s40, s40, 5
    s_add_u32 m0, s16, 90336
    s_add_u32 s39, s47, s40
    buffer_load_dwordx4 v3, s[4:7], s39 offen lds
    s_add_u32 s40, s23, 5120
    s_sub_u32 s39, s40, 43008
    s_cselect_b32 s40, s40, s39
    s_lshl_b32 s40, s40, 5
    s_add_u32 m0, s16, 36960
    s_add_u32 s39, s47, s40
    buffer_load_dwordx4 v3, s[4:7], s39 offen lds
    s_add_u32 s40, s23, 8192
    s_sub_u32 s39, s40, 43008
    s_cselect_b32 s40, s40, s39
    s_lshl_b32 s40, s40, 5
    s_add_u32 m0, s16, 41056
    s_add_u32 s39, s47, s40
    buffer_load_dwordx4 v3, s[4:7], s39 offen lds
    s_add_u32 s40, s23, 11264
    s_sub_u32 s39, s40, 43008
    s_cselect_b32 s40, s40, s39
    s_lshl_b32 s40, s40, 5
    s_add_u32 m0, s16, 45152
    s_add_u32 s39, s47, s40
    buffer_load_dwordx4 v3, s[4:7], s39 offen lds
    s_add_u32 s40, s23, 14336
    s_sub_u32 s39, s40, 43008
    s_cselect_b32 s40, s40, s39
    s_lshl_b32 s40, s40, 5
    s_add_u32 m0, s16, 131392
    s_add_u32 s39, s47, s40
    buffer_load_dwordx4 v3, s[4:7], s39 offen lds
    s_add_u32 s40, s23, 17408
    s_sub_u32 s39, s40, 43008
    s_cselect_b32 s40, s40, s39
    s_lshl_b32 s40, s40, 5
    s_add_u32 m0, s16, 135488
    s_add_u32 s39, s47, s40
    buffer_load_dwordx4 v3, s[4:7], s39 offen lds
    s_add_u32 s40, s23, 20480
    s_sub_u32 s39, s40, 43008
    s_cselect_b32 s40, s40, s39
    s_lshl_b32 s40, s40, 5
    s_add_u32 m0, s16, 94432
    s_add_u32 s39, s47, s40
    buffer_load_dwordx4 v3, s[4:7], s39 offen lds
    s_add_u32 s40, s23, 23552
    s_sub_u32 s39, s40, 43008
    s_cselect_b32 s40, s40, s39
    s_lshl_b32 s40, s40, 5
    s_add_u32 m0, s16, 98560
    s_add_u32 s39, s47, s40
    buffer_load_dwordx4 v3, s[4:7], s39 offen lds
    s_add_u32 s40, s23, 26624
    s_sub_u32 s39, s40, 43008
    s_cselect_b32 s40, s40, s39
    s_lshl_b32 s40, s40, 5
    s_add_u32 m0, s16, 102656
    s_add_u32 s39, s47, s40
    buffer_load_dwordx4 v3, s[4:7], s39 offen lds
    s_add_u32 s40, s23, 29696
    s_sub_u32 s39, s40, 43008
    s_cselect_b32 s40, s40, s39
    s_lshl_b32 s40, s40, 5
    s_add_u32 m0, s16, 49280
    s_add_u32 s39, s47, s40
    buffer_load_dwordx4 v3, s[4:7], s39 offen lds
    s_add_u32 s40, s23, 32768
    s_sub_u32 s39, s40, 43008
    s_cselect_b32 s40, s40, s39
    s_lshl_b32 s40, s40, 5
    s_add_u32 m0, s16, 53376
    s_add_u32 s39, s47, s40
    buffer_load_dwordx4 v3, s[4:7], s39 offen lds
    s_add_u32 s40, s23, 35840
    s_sub_u32 s39, s40, 43008
    s_cselect_b32 s40, s40, s39
    s_lshl_b32 s40, s40, 5
    s_add_u32 m0, s16, 57472
    s_add_u32 s39, s47, s40
    buffer_load_dwordx4 v3, s[4:7], s39 offen lds
    s_add_u32 s40, s23, 38912
    s_sub_u32 s39, s40, 43008
    s_cselect_b32 s40, s40, s39
    s_lshl_b32 s40, s40, 5
    s_add_u32 m0, s16, 139584
    s_add_u32 s39, s47, s40
    buffer_load_dwordx4 v3, s[4:7], s39 offen lds
    s_add_u32 s40, s23, 41984
    s_sub_u32 s39, s40, 43008
    s_cselect_b32 s40, s40, s39
    s_lshl_b32 s40, s40, 5
    s_add_u32 m0, s16, 143680
    s_add_u32 s39, s47, s40
    buffer_load_dwordx4 v3, s[4:7], s39 offen lds
    v_bfe_u32 v10, v1, 2, 2
    v_lshrrev_b32 v11, 4, v1
    v_lshl_add_u32 v12, v11, 3, v10
    v_lshlrev_b32 v12, 7, v12
    v_and_b32 v13, 3, v1
    v_lshl_add_u32 v12, v13, 3, v12
    v_lshrrev_b32 v14, 1, v10
    v_and_b32 v16, 1, v11
    v_lshl_or_b32 v14, v16, 1, v14
    v_xor_b32 v16, 0, v14
    v_lshl_add_u32 v240, v16, 5, v12
    v_add_u32 v244, 0xf000, v240
    v_add_u32 v248, 0x1e000, v240
    v_xor_b32 v16, 1, v14
    v_lshl_add_u32 v241, v16, 5, v12
    v_add_u32 v245, 0xf000, v241
    v_add_u32 v249, 0x1e000, v241
    v_xor_b32 v16, 2, v14
    v_lshl_add_u32 v242, v16, 5, v12
    v_add_u32 v246, 0xf000, v242
    v_add_u32 v250, 0x1e000, v242
    v_xor_b32 v16, 3, v14
    v_lshl_add_u32 v243, v16, 5, v12
    v_add_u32 v247, 0xf000, v243
    v_add_u32 v251, 0x1e000, v243
    v_lshl_add_u32 v15, v11, 2, v10
    v_lshlrev_b32 v15, 7, v15
    v_lshl_add_u32 v15, v13, 3, v15
    v_xor_b32 v16, s36, v14
    v_lshl_add_u32 v15, v16, 5, v15
    v_add_u32 v15, 73920, v15
    v_lshlrev_b32 v17, 4, v1
    v_and_b32 v18, 15, v1
    v_lshlrev_b32 v18, 10, v18
    v_lshl_add_u32 v18, v11, 3, v18
    s_mov_b32 s39, 61600
    s_cmp_eq_u32 s36, 1
    s_cselect_b32 s39, 65696, s39
    s_cmp_eq_u32 s36, 2
    s_cselect_b32 s39, 69792, s39
    s_cmp_eq_u32 s36, 3
    s_cselect_b32 s39, 147776, s39
    v_add_u32 v19, s39, v17
    s_mov_b32 s60, s26
    s_mov_b32 s61, s27
    s_mov_b32 s62, 2097152
    s_mov_b32 s63, 0x20000
    s_lshl_b32 s39, s37, 1
    s_mov_b32 s40, s41
    s_add_u32 s39, s39, s40
    s_lshl_b32 s39, s39, 2
    s_add_u32 s39, s39, s36
    s_mul_i32 s46, s39, 44032
    s_add_u32 s46, s46, 4194304
    s_lshl_b32 s44, s39, 14
    s_mov_b32 s40, s55
    s_lshl_b32 s40, s40, 7
    s_add_u32 s44, s44, s40
    s_waitcnt vmcnt(31)
    v_mov_b32 v9, 1
    s_mov_b64 exec, 1
    ds_add_u32 v8, v9 offset:8
    s_mov_b64 exec, -1
    s_branch k2_cw_9_e
k2_cw_9:
    s_sleep 1
k2_cw_9_e:
    ds_read_b32 v9, v8 offset:8
    s_waitcnt lgkmcnt(0)
    v_cmp_gt_u32 vcc, 8, v9
    s_nop 0
    s_cbranch_vccnz k2_cw_9
    ds_read_b64_tr_b16 v[196:197], v15 offset:0
    ds_read_b64_tr_b16 v[198:199], v15 offset:2048
    ds_read_b64_tr_b16 v[200:201], v15 offset:4096
    ds_read_b64_tr_b16 v[202:203], v15 offset:6144
    s_waitcnt lgkmcnt(0)
    v_lshlrev_b32 v20, 16, v196
    v_and_b32 v21, 0xffff0000, v196
    v_lshlrev_b32 v22, 16, v197
    v_and_b32 v23, 0xffff0000, v197
    v_lshlrev_b32 v24, 16, v198
    v_and_b32 v25, 0xffff0000, v198
    v_lshlrev_b32 v26, 16, v199
    v_and_b32 v27, 0xffff0000, v199
    v_lshlrev_b32 v28, 16, v200
    v_and_b32 v29, 0xffff0000, v200
    v_lshlrev_b32 v30, 16, v201
    v_and_b32 v31, 0xffff0000, v201
    v_lshlrev_b32 v32, 16, v202
    v_and_b32 v33, 0xffff0000, v202
    v_lshlrev_b32 v34, 16, v203
    v_and_b32 v35, 0xffff0000, v203
    v_mov_b32 v9, 1
    s_mov_b64 exec, 1
    ds_add_u32 v8, v9 offset:8
    s_mov_b64 exec, -1
    s_branch k2_cw_10_e
k2_cw_10:
    s_sleep 1
k2_cw_10_e:
    ds_read_b32 v9, v8 offset:8
    s_waitcnt lgkmcnt(0)
    v_cmp_gt_u32 vcc, 12, v9
    s_nop 0
    s_cbranch_vccnz k2_cw_10
    s_add_u32 s40, s23, 28672
    s_sub_u32 s39, s40, 43008
    s_cselect_b32 s40, s40, s39
    s_lshl_b32 s40, s40, 5
    s_add_u32 m0, s16, 73920
    s_add_u32 s39, s47, s40
    buffer_load_dwordx4 v3, s[4:7], s39 offen lds
    s_add_u32 s40, s23, 30720
    s_sub_u32 s39, s40, 43008
    s_cselect_b32 s40, s40, s39
    s_lshl_b32 s40, s40, 5
    s_add_u32 m0, s16, 78016
    s_add_u32 s39, s47, s40
    buffer_load_dwordx4 v3, s[4:7], s39 offen lds
    s_branch k2_p2
m_end:
    s_endpgm
code_end:
    s_endpgm
.section .rodata,"a"
.p2align 6
.amdhsa_kernel sequential_preLN__ssm_conv_s4d__glu_gated_geglu__prompt_kernel
  .amdhsa_next_free_vgpr 256
  .amdhsa_next_free_sgpr 96
  .amdhsa_accum_offset 256
  .amdhsa_group_segment_fixed_size 0
  .amdhsa_kernarg_size 112
  .amdhsa_user_sgpr_count 2
  .amdhsa_user_sgpr_kernarg_segment_ptr 1
  .amdhsa_system_sgpr_workgroup_id_x 1
  .amdhsa_float_denorm_mode_32 3
.end_amdhsa_kernel
```
